```python
import torch

def _softmax(x, axis=-1):
    return torch.softmax(x, dim=axis)

def _gelu(x):
    return torch.nn.functional.gelu(x, approximate='tanh')

def _silu(x):
    return torch.nn.functional.silu(x)

def _sigmoid(x):
    return torch.sigmoid(x)

def _layernorm(x, axis=-1, eps=1e-05):
    m = x.mean(dim=axis, keepdim=True)
    v = x.var(dim=axis, keepdim=True, unbiased=False)
    return (x - m) / torch.sqrt(v + eps)

def _scatter_add(tgt, idx, src, axis=0):
    return tgt.clone().index_add_(axis, idx, src)

def _segment_sum(src, seg, n):
    out = torch.zeros((n,) + src.shape[1:], dtype=src.dtype)
    return out.index_add_(0, seg, src)

def _pad(x, pw):
    flat = tuple((v for pair in reversed(pw) for v in pair))
    return torch.nn.functional.pad(x, flat)
kernel_name = 'gated_mix__grouped_kv_mqa__mixer_gmlp__prompt'

def setup_inputs():

    _w = lambda a: (lambda t: t.to(torch.bfloat16) if t.is_floating_point() else t)(torch.as_tensor(a))

    def _A_setup():
        B, S, D, H = (1, 2048, 640, 32)
        Dh = D // H
        return {'x': _w((lambda *s: torch.randn(*s, dtype=torch.bfloat16) * 0.05)(B, S, D)), 'wq': _w((lambda *s: torch.randn(*s, dtype=torch.bfloat16) * 1.6)(D, H * Dh)), 'wk': _w((lambda *s: torch.randn(*s, dtype=torch.bfloat16) * 1.6)(D, Dh)), 'wv': _w((lambda *s: torch.randn(*s, dtype=torch.bfloat16) * 0.2)(D, Dh)), 'wo': _w((lambda *s: torch.randn(*s, dtype=torch.bfloat16) * 0.2)(H * Dh, D))}
    _A_in = _A_setup()

    def _B_setup():
        B, S, D, F = (1, 2048, 640, 1536)
        Fh = F // 2
        return {'x': _w((lambda *s: torch.randn(*s, dtype=torch.bfloat16) * 0.05)(B, S, D)), 'w_in': _w((lambda *s: torch.randn(*s, dtype=torch.bfloat16) * 0.8)(D, 2 * Fh)), 'w_sp': _w(0.01 * (lambda *s: torch.randn(*s, dtype=torch.bfloat16) * 0.8)(S, S)), 'b_sp': _w(1.0 + 0.01 * (lambda *s: torch.randn(*s, dtype=torch.bfloat16) * 0.05)(S)), 'w_out': _w((lambda *s: torch.randn(*s, dtype=torch.bfloat16) * 0.05)(Fh, D))}
    _B_in = _B_setup()
    return {'A_x': _A_in['x'], 'A_wq': _A_in['wq'], 'A_wk': _A_in['wk'], 'A_wv': _A_in['wv'], 'A_wo': _A_in['wo'], 'B_x': _B_in['x'], 'B_w_in': _B_in['w_in'], 'B_w_sp': _B_in['w_sp'], 'B_b_sp': _B_in['b_sp'], 'B_w_out': _B_in['w_out'], 'gate_w': _w((lambda *s: torch.randn(*s, dtype=torch.bfloat16) * 0.05)(640) * 16.0)}

def reference(A_x, A_wq, A_wk, A_wv, A_wo, B_x, B_w_in, B_w_sp, B_b_sp, B_w_out, gate_w):

    def _A_ref(x, wq, wk, wv, wo):
        B, S, D = x.shape
        H = 32
        Dh = D // H
        q = (lambda x, *d: x.permute(*d))((x @ wq).reshape(B, S, H, Dh), 0, 2, 1, 3)
        k = x @ wk
        v = x @ wv
        scores = torch.einsum('bhqd,bkd->bhqk', q, k) * Dh ** (-0.5)
        p = _softmax(scores, axis=-1)
        o = torch.einsum('bhqk,bkd->bhqd', p, v)
        return (lambda x, *d: x.permute(*d))(o, 0, 2, 1, 3).reshape(B, S, H * Dh) @ wo

    def _B_ref(x, w_in, w_sp, b_sp, w_out):
        B, S, D = x.shape
        F = w_in.shape[-1]
        Fh = F // 2
        z = _gelu(torch.einsum('bsd,df->bsf', x, w_in))
        z1 = z[..., :Fh].clone()
        z2 = _layernorm(z[..., Fh:], axis=-1)
        g = torch.einsum('ts,bsf->btf', w_sp, z2) + b_sp[None, :, None]
        return torch.einsum('bsf,fd->bsd', z1 * g, w_out)
    x = A_x
    g = _sigmoid((x * gate_w).sum(-1, keepdims=True))
    a = _A_ref(x, A_wq, A_wk, A_wv, A_wo)
    b = _B_ref(x, B_w_in, B_w_sp, B_b_sp, B_w_out)
    return g * a + (1 - g) * b
```

```asm
; @launch grid=(256,1,1) block=(512,1,1) lds=163840
.amdgcn_target "amdgcn-amd-amdhsa--gfx950"
.text
.globl gated_mix__grouped_kv_mqa__mixer_gmlp__prompt_kernel
.p2align 8
.type gated_mix__grouped_kv_mqa__mixer_gmlp__prompt_kernel,@function
gated_mix__grouped_kv_mqa__mixer_gmlp__prompt_kernel:
    s_cmp_lt_u32 s2, 256
    s_cbranch_scc1 gated_mix__grouped_kv_mqa__mixer_gmlp__prompt_kernel_go
    s_endpgm
gated_mix__grouped_kv_mqa__mixer_gmlp__prompt_kernel_go:
    s_load_dwordx2 s[12:13], s[0:1], 0
    s_mov_b32 s14, 0x280000
    s_mov_b32 s15, 0x00020000
    s_load_dwordx2 s[8:9], s[0:1], 104
    s_mov_b32 s10, 0x2000000
    s_mov_b32 s11, 0x00020000
    v_lshrrev_b32 v1, 6, v0
    s_getpc_b64 s[4:5]
F_pc:
    s_and_b32 s44, s2, 0xf8
    v_and_b32 v3, 1, v0
    v_add_lshl_u32 v2, s44, v1, 7
    v_lshl_add_u32 v2, v3, 15, v2
    v_mov_b32 v3, 0
    v_min_u32 v2, F_end-F_pc-4, v2
    v_lshl_add_u64 v[2:3], v[2:3], 0, s[4:5]
    global_load_dword v106, v[2:3], off
    v_readfirstlane_b32 s42, v1
    s_and_b32 s41, s2, 1
    s_lshl_b32 s41, s41, 2
    s_bfe_u32 s44, s2, 0x20003
    s_or_b32 s41, s41, s44
    s_bfe_u32 s40, s2, 0x20001
    s_lshl_b32 s40, s40, 3
    s_lshr_b32 s44, s2, 5
    s_or_b32 s40, s40, s44
    s_cmp_ge_u32 s42, 4
    s_cbranch_scc0 F_A
    v_and_b32 v0, 63, v0
    s_branch F_G
F_A:
    s_and_b32 s44, s41, 3
    s_lshl2_add_u32 s44, s40, s44
    s_mul_i32 s44, s44, 20480
    v_min_u32 v2, 159, v0
    v_lshlrev_b32 v2, 7, v2
    v_and_b32 v0, 63, v0
    s_waitcnt lgkmcnt(0)
    s_cmp_eq_u32 s42, 3
    s_cbranch_scc1 F_p3
    buffer_load_dword v106, v2, s[12:15], s44 offen
F_p3:
    s_load_dwordx2 s[20:21], s[0:1], 16
    s_mov_b32 s22, 0x6400
    s_mov_b32 s23, 0x00020000
    s_load_dwordx2 s[4:5], s[0:1], 24
    s_load_dwordx2 s[16:17], s[0:1], 8
    s_mov_b32 s18, 0xc8000
    s_mov_b32 s19, 0x00020000
    s_load_dwordx2 s[24:25], s[0:1], 80
    s_mov_b32 s26, 0x500
    s_mov_b32 s27, 0x00020000
    s_movk_i32 s44, 960
    v_mul_u32_u24 v6, 3277, v0
    v_lshrrev_b32 v6, 16, v6
    v_bfe_u32 v7, v6, 2, 2
    v_xor_b32 v7, v7, v0
    v_lshlrev_b32 v7, 4, v7
    v_mad_u32_u24 v126, v6, s44, v7
    v_add_u32 v6, 64, v0
    v_mul_u32_u24 v6, 3277, v6
    v_lshrrev_b32 v6, 16, v6
    v_bfe_u32 v7, v6, 2, 2
    v_xor_b32 v7, v7, v0
    v_lshlrev_b32 v7, 4, v7
    v_mad_u32_u24 v127, v6, s44, v7
    v_add_u32 v6, 128, v0
    v_mul_u32_u24 v6, 3277, v6
    v_lshrrev_b32 v6, 16, v6
    v_bfe_u32 v7, v6, 2, 2
    v_xor_b32 v7, v7, v0
    v_lshlrev_b32 v7, 4, v7
    v_mad_u32_u24 v128, v6, s44, v7
    v_add_u32 v6, 192, v0
    v_mul_u32_u24 v6, 3277, v6
    v_lshrrev_b32 v6, 16, v6
    v_bfe_u32 v7, v6, 2, 2
    v_xor_b32 v7, v7, v0
    v_lshlrev_b32 v7, 4, v7
    v_mad_u32_u24 v129, v6, s44, v7
    v_add_u32 v6, 256, v0
    v_mul_u32_u24 v6, 3277, v6
    v_lshrrev_b32 v6, 16, v6
    v_bfe_u32 v7, v6, 2, 2
    v_xor_b32 v7, v7, v0
    v_lshlrev_b32 v7, 4, v7
    v_mad_u32_u24 v130, v6, s44, v7
    s_mul_i32 s53, s42, 20480
    s_mul_i32 s44, s40, 81920
    s_mul_i32 s45, s42, 320
    s_add_u32 s46, s44, s45
    v_add_u32 v130, 4096, v130
    s_and_b32 s49, s41, 3
    v_lshlrev_b32 v1, 4, v0
    s_mul_i32 s48, s42, 7168
    s_add_u32 s48, s48, 131072
    s_load_dwordx2 s[28:29], s[0:1], 48
    s_mov_b32 s30, 0x1e0000
    s_mov_b32 s31, 0x00020000
    v_lshrrev_b32 v246, 3, v0
    v_and_b32 v7, 7, v0
    v_min_u32 v246, 4, v246
    v_min_u32 v7, 5, v7
    v_mul_u32_u24 v246, 3072, v246
    v_lshl_add_u32 v246, v7, 7, v246
    s_lshr_b32 s51, s2, 3
    s_lshl2_add_u32 s51, s51, s42
    s_mul_i32 s37, s51, 15360
    s_bitcmp1_b32 s41, 2
    s_cselect_b32 s44, 768, 0
    s_add_u32 s37, s37, s44
    v_lshrrev_b32 v249, 3, v0
    v_and_b32 v7, 7, v0
    v_min_u32 v249, 4, v249
    v_min_u32 v7, 4, v7
    v_mul_u32_u24 v249, 1280, v249
    v_lshl_add_u32 v249, v7, 7, v249
    s_lshr_b32 s51, s2, 3
    s_lshl2_add_u32 s51, s51, s42
    s_mul_i32 s36, s51, 6400
    s_bitcmp1_b32 s41, 2
    s_cselect_b32 s44, 640, 0
    s_add_u32 s36, s36, s44
    v_and_b32 v247, 1, v0
    v_lshlrev_b32 v247, 7, v247
    s_lshl_b32 s51, s51, 8
    s_xor_b32 s44, s49, 0
    s_xor_b32 s45, s44, s42
    s_mul_i32 s44, s44, 20480
    s_mul_i32 s45, s45, 5120
    s_add_u32 m0, s53, s45
    s_add_u32 s44, s44, s46
    s_waitcnt lgkmcnt(0)
    s_barrier
    s_bitcmp1_b32 s41, 2
    s_cselect_b64 vcc, -1, 0
    s_cselect_b32 s20, s4, s20
    s_cselect_b32 s21, s5, s21
    buffer_load_dword v247, v247, s[20:23], s51 offen
    buffer_load_dwordx4 v126, s[12:15], s44 offen offset:0 lds
    buffer_load_dwordx4 v127, s[12:15], s44 offen offset:1024 lds
    buffer_load_dwordx4 v128, s[12:15], s44 offen offset:2048 lds
    buffer_load_dwordx4 v129, s[12:15], s44 offen offset:3072 lds
    s_add_u32 m0, m0, 4096
    s_nop 0
    buffer_load_dwordx4 v130, s[12:15], s44 offen offset:0 lds
    s_add_u32 s52, s45, s53
    s_mul_i32 s44, s42, 6400
    s_add_u32 s45, s44, 4096
    s_mov_b32 m0, s48
    s_load_dword s43, s[8:9], 196608
    buffer_load_dword v246, v246, s[28:31], s37 offen offset:1536
    v_and_b32 v6, 3, v0
    v_bfe_u32 v7, v0, 2, 1
    v_lshl_or_b32 v6, v7, 3, v6
    v_bfe_u32 v7, v0, 3, 1
    v_lshl_or_b32 v6, v7, 2, v6
    v_and_b32 v7, 15, v0
    v_lshrrev_b32 v152, 4, v0
    v_cndmask_b32 v6, v7, v6, vcc
    s_lshl2_add_u32 s49, s40, s49
    v_lshrrev_b32 v8, 2, v6
    v_mul_u32_u24 v6, 320, v6
    v_xor_b32 v8, v8, v152
    v_lshl_add_u32 v6, v8, 4, v6
    v_add_u32 v151, s52, v6
    v_bfe_u32 v5, v0, 2, 2
    v_lshl_or_b32 v150, v152, 3, v5
    v_mad_u32_u24 v150, v150, 40, s48
    v_and_b32 v6, 1, v0
    v_lshl_add_u32 v150, v6, 3, v150
    v_bfe_u32 v6, v0, 1, 1
    v_lshl_add_u32 v150, v6, 5, v150
    v_add_u32 v53, s48, v1
    v_sub_u32 v153, 0, v152
    v_and_b32 v153, 3, v153
    v_lshlrev_b32 v19, 4, v153
    v_xor_b32 v153, v153, v5
    v_mul_u32_u24 v6, 320, v7
    v_lshl_add_u32 v20, v153, 4, v6
    v_add_u32 v20, s53, v20
    s_lshl_b32 s44, s42, 2
    s_add_u32 s44, s44, 159744
    v_mov_b32 v254, s44
    v_and_b32 v255, 3, v0
    v_lshlrev_b32 v255, 2, v255
    v_add_u32 v255, 159744, v255
    s_lshr_b32 s44, s42, 1
    s_mul_i32 s44, s44, 1536
    s_add_u32 s44, s44, 131072
    s_and_b32 s46, s42, 1
    s_lshl_b32 s45, s46, 4
    v_mul_u32_u24 v49, 3072, v152
    v_add_u32 v51, s45, v7
    v_add_u32 v49, s44, v49
    s_lshl_b32 s44, s42, 6
    s_add_u32 s44, s44, 160000
    v_lshl_add_u32 v52, v7, 2, s44
    v_lshl_add_u32 v50, v51, 3, v49
    v_lshl_add_u32 v49, v51, 4, v49
    s_movk_i32 s44, 1280
    v_bfe_u32 v21, v0, 2, 3
    v_lshrrev_b32 v5, 5, v0
    v_lshl_or_b32 v21, v5, 4, v21
    v_and_b32 v5, 3, v0
    v_lshl_add_u32 v21, v21, 2, v5
    v_mad_u32_u24 v21, v21, 40, s48
    v_mul_u32_u24 v153, 6554, v0
    v_lshrrev_b32 v153, 16, v153
    v_mul_u32_u24 v154, 160, v153
    v_bfe_u32 v155, v153, 2, 1
    v_sub_u32 v154, v1, v154
    v_mul_u32_u24 v155, 28, v155
    v_bfe_u32 v5, v153, 3, 1
    v_xor_b32 v153, v153, v155
    v_mul_u32_u24 v5, 12, v5
    v_add_u32 v154, 0, v154
    v_xor_b32 v153, v153, v5
    v_mad_u32_u24 v12, v153, s44, v154
    v_add_u32 v153, 64, v0
    v_mul_u32_u24 v153, 6554, v153
    v_lshrrev_b32 v153, 16, v153
    v_mul_u32_u24 v154, 160, v153
    v_bfe_u32 v155, v153, 2, 1
    v_sub_u32 v154, v1, v154
    v_mul_u32_u24 v155, 28, v155
    v_bfe_u32 v5, v153, 3, 1
    v_xor_b32 v153, v153, v155
    v_mul_u32_u24 v5, 12, v5
    v_add_u32 v154, 1024, v154
    v_xor_b32 v153, v153, v5
    v_mad_u32_u24 v13, v153, s44, v154
    v_add_u32 v153, 128, v0
    v_mul_u32_u24 v153, 6554, v153
    v_lshrrev_b32 v153, 16, v153
    v_mul_u32_u24 v154, 160, v153
    v_bfe_u32 v155, v153, 2, 1
    v_sub_u32 v154, v1, v154
    v_mul_u32_u24 v155, 28, v155
    v_bfe_u32 v5, v153, 3, 1
    v_xor_b32 v153, v153, v155
    v_mul_u32_u24 v5, 12, v5
    v_add_u32 v154, 2048, v154
    v_xor_b32 v153, v153, v5
    v_mad_u32_u24 v14, v153, s44, v154
    v_add_u32 v153, 192, v0
    v_mul_u32_u24 v153, 6554, v153
    v_lshrrev_b32 v153, 16, v153
    v_mul_u32_u24 v154, 160, v153
    v_bfe_u32 v155, v153, 2, 1
    v_sub_u32 v154, v1, v154
    v_mul_u32_u24 v155, 28, v155
    v_bfe_u32 v5, v153, 3, 1
    v_xor_b32 v153, v153, v155
    v_mul_u32_u24 v5, 12, v5
    v_add_u32 v154, 3072, v154
    v_xor_b32 v153, v153, v5
    v_mad_u32_u24 v15, v153, s44, v154
    v_add_u32 v153, 256, v0
    v_mul_u32_u24 v153, 6554, v153
    v_lshrrev_b32 v153, 16, v153
    v_mul_u32_u24 v154, 160, v153
    v_bfe_u32 v155, v153, 2, 1
    v_sub_u32 v154, v1, v154
    v_mul_u32_u24 v155, 28, v155
    v_bfe_u32 v5, v153, 3, 1
    v_xor_b32 v153, v153, v155
    v_mul_u32_u24 v5, 12, v5
    v_add_u32 v154, 4096, v154
    v_xor_b32 v153, v153, v5
    v_mad_u32_u24 v18, v153, s44, v154
    v_lshlrev_b32 v1, 4, v0
    v_lshlrev_b32 v2, 3, v0
    v_lshrrev_b32 v6, 5, v0
    v_and_b32 v7, 31, v0
    v_mul_u32_u24 v6, 320, v6
    v_lshl_add_u32 v3, v7, 4, v6
    v_cmp_eq_u32 vcc, 20, v7
    v_mov_b32 v6, 0x3f803f80
    v_mov_b32 v4, 0xdddddddd
    s_mov_b32 s54, 0xfffff
    s_mov_b32 s55, 0xfffff
    v_mov_b32 v16, v6
    v_mov_b32 v17, 0x3f80
    v_cndmask_b32 v24, 0, v6, vcc
    v_cndmask_b32 v25, 0, v6, vcc
    v_cndmask_b32 v26, 0, v6, vcc
    v_cndmask_b32 v27, 0, v6, vcc
    v_cndmask_b32 v28, 0, v6, vcc
    v_cndmask_b32 v29, 0, v6, vcc
    v_cndmask_b32 v30, 0, v6, vcc
    v_cndmask_b32 v31, 0, v6, vcc
    v_mov_b32 v22, v6
    v_mov_b32 v23, 0x3f80
    v_cndmask_b32 v32, 0, v6, vcc
    v_cndmask_b32 v33, 0, v6, vcc
    v_cndmask_b32 v34, 0, v6, vcc
    v_cndmask_b32 v35, 0, v6, vcc
    v_cndmask_b32 v36, 0, v6, vcc
    v_cndmask_b32 v37, 0, v6, vcc
    v_cndmask_b32 v38, 0, v6, vcc
    v_cndmask_b32 v39, 0, v6, vcc
    s_mul_i32 s52, s42, 204800
    s_mul_i32 s45, s41, 160
    s_add_u32 s52, s52, s45
    s_mul_i32 s53, s42, 320
    v_mov_b32 v144, 0
    v_mov_b32 v146, 2146435072
    v_mov_b64 v[10:11], 0
    s_mov_b32 s60, 0x3ea52b5c
    s_lshl_b32 s63, s42, 9
    s_add_u32 s63, s63, 200704
    s_mul_i32 s50, s42, 40960
    s_and_b32 s51, s40, 15
    s_mul_i32 s51, s51, 2560
    s_lshl_b32 s44, s46, 7
    s_add_u32 s44, s44, 160000
    v_lshl_add_u32 v48, v7, 2, s44
    s_xor_b32 s44, s42, 0
    s_mul_i32 s45, s44, 1536
    s_mul_i32 s32, s44, 20480
    s_mul_i32 s28, s44, 18432
    s_add_u32 s45, s45, 131072
    v_add_u32 v40, s45, v1
    v_add_u32 v41, s45, v2
    s_xor_b32 s44, s42, 1
    s_mul_i32 s45, s44, 1536
    s_mul_i32 s33, s44, 20480
    s_mul_i32 s29, s44, 18432
    s_add_u32 s45, s45, 131072
    v_add_u32 v42, s45, v1
    v_add_u32 v43, s45, v2
    s_xor_b32 s44, s42, 2
    s_mul_i32 s45, s44, 1536
    s_mul_i32 s34, s44, 20480
    s_mul_i32 s30, s44, 18432
    s_add_u32 s45, s45, 131072
    v_add_u32 v44, s45, v1
    v_add_u32 v45, s45, v2
    s_xor_b32 s44, s42, 3
    s_mul_i32 s45, s44, 1536
    s_mul_i32 s35, s44, 20480
    s_mul_i32 s31, s44, 18432
    s_add_u32 s45, s45, 131072
    v_add_u32 v46, s45, v1
    v_add_u32 v47, s45, v2
    s_lshl_b32 s44, s40, 3
    s_and_b32 s45, s41, 6
    s_add_u32 s44, s44, s45
    s_add_u32 s44, s44, s46
    s_mul_i32 s44, s44, 22528
    s_add_u32 s44, s44, 16777216
    s_and_b32 s45, s41, 1
    s_lshl_b32 s57, s45, 10
    s_lshl_b32 s56, s45, 12
    s_lshr_b32 s45, s42, 1
    s_lshl_b32 s46, s45, 10
    s_add_u32 s56, s56, s46
    s_add_u32 s56, s56, s44
    s_lshl3_add_u32 s57, s45, s57
    s_add_u32 s57, s57, s44
    s_add_u32 s57, s57, 8192
    s_add_u32 s58, s56, 2048
    s_add_u32 s59, s57, 512
    s_waitcnt lgkmcnt(0)
    s_waitcnt vmcnt(1)
    v_mov_b32 v5, 1
    s_mov_b64 exec, 1
    ds_write_b32 v254, v5 offset:32
    s_mov_b64 exec, -1
    s_mul_i32 s44, s42, 6400
    s_add_u32 s45, s44, 4096
    s_mov_b32 s47, 0x40000
sbw_1:
    ds_read_b32 v5, v254 offset:16
    s_sub_u32 s47, s47, 1
    s_waitcnt lgkmcnt(0)
    v_cmp_gt_u32 vcc, 1, v5
    s_cbranch_scc1 sbw_1_x
    s_cbranch_vccnz sbw_1
sbw_1_x:
    buffer_load_dwordx4 v1, s[20:23], s44 offen offset:0 lds
    buffer_load_dwordx4 v1, s[20:23], s44 offen offset:1024 lds
    buffer_load_dwordx4 v1, s[20:23], s44 offen offset:2048 lds
    buffer_load_dwordx4 v1, s[20:23], s44 offen offset:3072 lds
    s_add_u32 m0, s48, 4096
    s_nop 0
    buffer_load_dwordx4 v1, s[20:23], s45 offen offset:0 lds
    buffer_load_dwordx4 v1, s[20:23], s45 offen offset:1024 lds
    buffer_load_dwordx4 v1, s[20:23], s45 offen offset:2048 lds
    s_waitcnt vmcnt(0)
    s_setprio 2
    ds_read_b128 v[160:163], v151 offset:0
    ds_read_b64_tr_b16 v[180:181], v150 offset:0
    ds_read_b64_tr_b16 v[182:183], v150 offset:160
    ds_read_b64_tr_b16 v[184:185], v150 offset:16
    ds_read_b64_tr_b16 v[186:187], v150 offset:176
    ds_read_b128 v[164:167], v151 offset:64
    ds_read_b64_tr_b16 v[188:189], v150 offset:1280
    ds_read_b64_tr_b16 v[190:191], v150 offset:1440
    ds_read_b64_tr_b16 v[192:193], v150 offset:1296
    ds_read_b64_tr_b16 v[194:195], v150 offset:1456
    ds_read_b128 v[168:171], v151 offset:128
    ds_read_b64_tr_b16 v[196:197], v150 offset:2560
    ds_read_b64_tr_b16 v[198:199], v150 offset:2720
    ds_read_b64_tr_b16 v[200:201], v150 offset:2576
    ds_read_b64_tr_b16 v[202:203], v150 offset:2736
    ds_read_b128 v[172:175], v151 offset:192
    ds_read_b64_tr_b16 v[204:205], v150 offset:3840
    ds_read_b64_tr_b16 v[206:207], v150 offset:4000
    ds_read_b64_tr_b16 v[208:209], v150 offset:3856
    ds_read_b64_tr_b16 v[210:211], v150 offset:4016
    ds_read_b128 v[176:179], v151 offset:256
    ds_read_b64_tr_b16 v[212:213], v150 offset:5120
    ds_read_b64_tr_b16 v[214:215], v150 offset:5280
    ds_read_b64_tr_b16 v[216:217], v150 offset:5136
    ds_read_b64_tr_b16 v[218:219], v150 offset:5296
    s_add_u32 s43, s43, 0x9e3779b1
    s_bitcmp1_b32 s41, 2
    s_cbranch_scc1 A_kvv
    s_waitcnt lgkmcnt(15)
    v_mfma_f32_16x16x32_bf16 v[132:135], v[180:183], v[160:163], 0
    v_mfma_f32_16x16x32_bf16 v[136:139], v[184:187], v[160:163], 0
    v_mfma_f32_16x16x32_bf16 v[132:135], v[188:191], v[164:167], v[132:135]
    v_mfma_f32_16x16x32_bf16 v[136:139], v[192:195], v[164:167], v[136:139]
    s_waitcnt lgkmcnt(10)
    v_mfma_f32_16x16x32_bf16 v[132:135], v[196:199], v[168:171], v[132:135]
    v_mfma_f32_16x16x32_bf16 v[136:139], v[200:203], v[168:171], v[136:139]
    s_waitcnt lgkmcnt(5)
    v_mfma_f32_16x16x32_bf16 v[132:135], v[204:207], v[172:175], v[132:135]
    v_mfma_f32_16x16x32_bf16 v[136:139], v[208:211], v[172:175], v[136:139]
    s_waitcnt lgkmcnt(0)
    v_mfma_f32_16x16x32_bf16 v[132:135], v[212:215], v[176:179], v[132:135]
    v_mfma_f32_16x16x32_bf16 v[136:139], v[216:219], v[176:179], v[136:139]
    s_branch A_kvj
A_kvv:
    s_waitcnt lgkmcnt(15)
    v_mfma_f32_16x16x32_bf16 v[132:135], v[160:163], v[180:183], 0
    v_mfma_f32_16x16x32_bf16 v[136:139], v[160:163], v[184:187], 0
    v_mfma_f32_16x16x32_bf16 v[132:135], v[164:167], v[188:191], v[132:135]
    v_mfma_f32_16x16x32_bf16 v[136:139], v[164:167], v[192:195], v[136:139]
    s_waitcnt lgkmcnt(10)
    v_mfma_f32_16x16x32_bf16 v[132:135], v[168:171], v[196:199], v[132:135]
    v_mfma_f32_16x16x32_bf16 v[136:139], v[168:171], v[200:203], v[136:139]
    s_waitcnt lgkmcnt(5)
    v_mfma_f32_16x16x32_bf16 v[132:135], v[172:175], v[204:207], v[132:135]
    v_mfma_f32_16x16x32_bf16 v[136:139], v[172:175], v[208:211], v[136:139]
    s_waitcnt lgkmcnt(0)
    v_mfma_f32_16x16x32_bf16 v[132:135], v[176:179], v[212:215], v[132:135]
    v_mfma_f32_16x16x32_bf16 v[136:139], v[176:179], v[216:219], v[136:139]
A_kvj:
    v_mov_b32 v145, s43
    s_cmp_eq_u32 s42, 0
    s_cbranch_scc1 A_k0
    s_nop 4
    ds_write_b128 v53, v[132:135] offset:5120
    ds_write_b128 v53, v[136:139] offset:6144
    v_mov_b32 v5, 1
    s_mov_b64 exec, 1
    ds_write_b32 v254, v5 offset:0
    s_mov_b64 exec, -1
    s_branch A_wq
A_k0:
    v_mov_b32 v5, 1
    s_mov_b64 exec, 1
    ds_write_b32 v254, v5 offset:0
    s_mov_b64 exec, -1
    s_lshr_b32 s44, s49, 1
    s_mul_i32 s44, s44, 2560
    s_and_b32 s45, s49, 1
    v_and_b32 v147, 15, v0
    v_bfe_u32 v148, v0, 4, 1
    v_mov_b32 v146, 0
    s_mov_b32 s47, 0x40000
sbw_2:
    ds_read_b32 v5, v255 offset:0
    s_sub_u32 s47, s47, 1
    s_waitcnt lgkmcnt(0)
    v_cmp_gt_u32 vcc, 1, v5
    s_cbranch_scc1 sbw_2_x
    s_cbranch_vccnz sbw_2
sbw_2_x:
    ds_read_b128 v[188:191], v53 offset:12288
    ds_read_b128 v[192:195], v53 offset:13312
    ds_read_b128 v[196:199], v53 offset:19456
    ds_read_b128 v[200:203], v53 offset:20480
    ds_read_b128 v[204:207], v53 offset:26624
    ds_read_b128 v[208:211], v53 offset:27648
    s_waitcnt lgkmcnt(4)
    v_add_f32 v132, v188, v132
    v_add_f32 v133, v189, v133
    v_add_f32 v134, v190, v134
    v_add_f32 v135, v191, v135
    v_add_f32 v136, v192, v136
    v_add_f32 v137, v193, v137
    v_add_f32 v138, v194, v138
    v_add_f32 v139, v195, v139
    s_waitcnt lgkmcnt(2)
    v_add_f32 v132, v196, v132
    v_add_f32 v133, v197, v133
    v_add_f32 v134, v198, v134
    v_add_f32 v135, v199, v135
    v_add_f32 v136, v200, v136
    v_add_f32 v137, v201, v137
    v_add_f32 v138, v202, v138
    v_add_f32 v139, v203, v139
    s_waitcnt lgkmcnt(0)
    v_add_f32 v132, v204, v132
    v_add_f32 v133, v205, v133
    v_add_f32 v134, v206, v134
    v_add_f32 v135, v207, v135
    v_add_f32 v136, v208, v136
    v_add_f32 v137, v209, v137
    v_add_f32 v138, v210, v138
    v_add_f32 v139, v211, v139
    v_cvt_pk_bf16_f32 v140, v132, v133
    v_cvt_pk_bf16_f32 v141, v134, v135
    v_cvt_pk_bf16_f32 v142, v136, v137
    v_cvt_pk_bf16_f32 v143, v138, v139
    s_bitcmp1_b32 s41, 2
    s_cbranch_scc0 A_kfin
    s_mul_i32 s45, s45, 640
    s_add_u32 s44, s44, s45
    v_lshrrev_b32 v149, 2, v0
    v_or_b32 v149, v149, v0
    v_and_b32 v149, 8, v149
    v_add_u32 v147, v147, v149
    v_mul_u32_u24 v148, 320, v148
    v_permlane32_swap_b32 v140, v142
    v_permlane32_swap_b32 v141, v143
    v_lshl_add_u32 v147, v147, 4, v148
    s_mov_b32 exec_lo, 0x0fff0fff
    s_mov_b32 exec_hi, 0x00ff00ff
    buffer_store_dwordx4 v[140:143], v147, s[8:11], s44 offen offset:1280 sc1
    s_mov_b64 exec, -1
    s_branch A_wq
A_kfin:
    s_lshl_b32 s45, s45, 4
    v_add_u32 v147, s45, v147
    v_lshl_add_u32 v148, v148, 5, v147
    v_lshlrev_b32 v147, 3, v147
    v_lshlrev_b32 v148, 4, v148
    s_mov_b32 exec_hi, 0
    buffer_store_dwordx4 v[140:143], v148, s[8:11], s44 offen sc1
    v_mul_f32 v144, v136, v136
    v_fmac_f32 v144, v137, v137
    v_fmac_f32 v144, v138, v138
    v_fmac_f32 v144, v139, v139
    s_mov_b32 exec_lo, 0
    s_mov_b32 exec_hi, 0xffff
    buffer_store_dwordx2 v[140:141], v147, s[8:11], s44 offen offset:1024 sc1
    s_mov_b32 exec_lo, -1
    v_fmac_f32 v144, v132, v132
    v_fmac_f32 v144, v133, v133
    v_fmac_f32 v144, v134, v134
    v_fmac_f32 v144, v135, v135
    s_mov_b64 exec, -1
    v_mov_b32 v147, v144
    s_nop 1
    v_permlane32_swap_b32 v144, v147
    v_add_f32 v144, v144, v147
    v_mov_b32 v147, v144
    s_nop 1
    v_permlane16_swap_b32 v144, v147
    v_add_f32 v144, v144, v147
    s_nop 1
    v_max_f32_dpp v144, v144, v144 quad_perm:[1,0,3,2] row_mask:0xf bank_mask:0xf
    s_nop 1
    v_max_f32_dpp v144, v144, v144 quad_perm:[2,3,0,1] row_mask:0xf bank_mask:0xf
    s_nop 1
    v_max_f32_dpp v144, v144, v144 row_half_mirror row_mask:0xf bank_mask:0xf
    s_nop 1
    v_max_f32_dpp v144, v144, v144 row_mirror row_mask:0xf bank_mask:0xf
A_wq:
    s_lshl3_add_u32 s44, s40, s41
    s_lshl_b32 s44, s44, 3
    s_add_u32 s44, s44, 200704
    s_mov_b64 exec, 1
    s_waitcnt vmcnt(0)
    buffer_store_dwordx2 v[144:145], v146, s[8:11], s44 offen sc1
    s_mov_b64 exec, -1
    s_mov_b32 s47, 0x40000
sbw_3:
    ds_read_b32 v5, v254 offset:16
    s_sub_u32 s47, s47, 1
    s_waitcnt lgkmcnt(0)
    v_cmp_gt_u32 vcc, 2, v5
    s_cbranch_scc1 sbw_3_x
    s_cbranch_vccnz sbw_3
sbw_3_x:
    buffer_load_dword v249, v249, s[16:19], s36 offen
    buffer_load_dwordx4 v[54:57], v12, s[16:19], s52 offen
    buffer_load_dwordx4 v[58:61], v13, s[16:19], s52 offen
    buffer_load_dwordx4 v[62:65], v14, s[16:19], s52 offen
    buffer_load_dwordx4 v[66:69], v15, s[16:19], s52 offen
    buffer_load_dwordx4 v[70:73], v18, s[16:19], s52 offen
    buffer_load_dwordx4 v[114:117], v19, s[24:27], s53 offen offset:0
    s_add_u32 s52, s52, 40960
    buffer_load_dwordx4 v[74:77], v12, s[16:19], s52 offen
    buffer_load_dwordx4 v[78:81], v13, s[16:19], s52 offen
    buffer_load_dwordx4 v[82:85], v14, s[16:19], s52 offen
    buffer_load_dwordx4 v[86:89], v15, s[16:19], s52 offen
    buffer_load_dwordx4 v[90:93], v18, s[16:19], s52 offen
    buffer_load_dwordx4 v[118:121], v19, s[24:27], s53 offen offset:64
    s_add_u32 s52, s52, 40960
    ds_read_b128 v[222:225], v20 offset:0
    s_waitcnt vmcnt(6)
    ds_write_b128 v53, v[54:57] offset:0
    ds_read_b128 v[226:229], v20 offset:5120
    ds_write_b128 v53, v[58:61] offset:1024
    ds_read_b128 v[230:233], v20 offset:10240
    ds_write_b128 v53, v[62:65] offset:2048
    ds_read_b128 v[234:237], v20 offset:15360
    ds_write_b128 v53, v[66:69] offset:3072
    ds_write_b128 v53, v[70:73] offset:4096
    ds_read_b64_tr_b16 v[54:55], v21 offset:0
    ds_read_b64_tr_b16 v[56:57], v21 offset:1280
    ds_read_b64_tr_b16 v[58:59], v21 offset:8
    ds_read_b64_tr_b16 v[60:61], v21 offset:1288
    ds_read_b64_tr_b16 v[62:63], v21 offset:16
    ds_read_b64_tr_b16 v[64:65], v21 offset:1296
    ds_read_b64_tr_b16 v[66:67], v21 offset:24
    ds_read_b64_tr_b16 v[68:69], v21 offset:1304
    ds_read_b64_tr_b16 v[70:71], v21 offset:32
    ds_read_b64_tr_b16 v[72:73], v21 offset:1312
    s_waitcnt lgkmcnt(12)
    v_mfma_f32_16x16x32_bf16 v[146:149], v[114:117], v[222:225], 0
    buffer_load_dwordx4 v[94:97], v12, s[16:19], s52 offen
    v_mfma_f32_16x16x32_bf16 v[170:173], v[114:117], v[226:229], 0
    buffer_load_dwordx4 v[98:101], v13, s[16:19], s52 offen
    v_mfma_f32_16x16x32_bf16 v[194:197], v[114:117], v[230:233], 0
    buffer_load_dwordx4 v[102:105], v14, s[16:19], s52 offen
    v_mfma_f32_16x16x32_bf16 v[218:221], v[114:117], v[234:237], 0
    buffer_load_dwordx4 v[106:109], v15, s[16:19], s52 offen
    s_waitcnt lgkmcnt(8)
    v_mfma_f32_16x16x32_bf16 v[126:129], v[54:57], v[222:225], 0
    buffer_load_dwordx4 v[110:113], v18, s[16:19], s52 offen
    v_mfma_f32_16x16x32_bf16 v[150:153], v[54:57], v[226:229], 0
    buffer_load_dwordx4 v[122:125], v19, s[24:27], s53 offen offset:128
    s_add_u32 s52, s52, 40960
    ds_read_b128 v[238:241], v20 offset:64
    v_mfma_f32_16x16x32_bf16 v[174:177], v[54:57], v[230:233], 0
    s_waitcnt vmcnt(6)
    ds_write_b128 v53, v[74:77] offset:0
    v_mfma_f32_16x16x32_bf16 v[198:201], v[54:57], v[234:237], 0
    ds_read_b128 v[242:245], v20 offset:5184
    s_waitcnt lgkmcnt(9)
    v_mfma_f32_16x16x32_bf16 v[130:133], v[58:61], v[222:225], 0
    ds_write_b128 v53, v[78:81] offset:1024
    v_mfma_f32_16x16x32_bf16 v[154:157], v[58:61], v[226:229], 0
    ds_read_b128 v[246:249], v20 offset:10304
    v_mfma_f32_16x16x32_bf16 v[178:181], v[58:61], v[230:233], 0
    ds_write_b128 v53, v[82:85] offset:2048
    v_mfma_f32_16x16x32_bf16 v[202:205], v[58:61], v[234:237], 0
    ds_read_b128 v[250:253], v20 offset:15424
    s_waitcnt lgkmcnt(11)
    v_mfma_f32_16x16x32_bf16 v[134:137], v[62:65], v[222:225], 0
    ds_write_b128 v53, v[86:89] offset:3072
    v_mfma_f32_16x16x32_bf16 v[158:161], v[62:65], v[226:229], 0
    v_mfma_f32_16x16x32_bf16 v[182:185], v[62:65], v[230:233], 0
    ds_write_b128 v53, v[90:93] offset:4096
    v_mfma_f32_16x16x32_bf16 v[206:209], v[62:65], v[234:237], 0
    ds_read_b64_tr_b16 v[74:75], v21 offset:0
    s_waitcnt lgkmcnt(12)
    v_mfma_f32_16x16x32_bf16 v[138:141], v[66:69], v[222:225], 0
    ds_read_b64_tr_b16 v[76:77], v21 offset:1280
    v_mfma_f32_16x16x32_bf16 v[162:165], v[66:69], v[226:229], 0
    ds_read_b64_tr_b16 v[78:79], v21 offset:8
    v_mfma_f32_16x16x32_bf16 v[186:189], v[66:69], v[230:233], 0
    ds_read_b64_tr_b16 v[80:81], v21 offset:1288
    v_mfma_f32_16x16x32_bf16 v[210:213], v[66:69], v[234:237], 0
    ds_read_b64_tr_b16 v[82:83], v21 offset:16
    s_waitcnt lgkmcnt(14)
    v_mfma_f32_16x16x32_bf16 v[142:145], v[70:73], v[222:225], 0
    ds_read_b64_tr_b16 v[84:85], v21 offset:1296
    v_mfma_f32_16x16x32_bf16 v[166:169], v[70:73], v[226:229], 0
    ds_read_b64_tr_b16 v[86:87], v21 offset:24
    v_mfma_f32_16x16x32_bf16 v[190:193], v[70:73], v[230:233], 0
    ds_read_b64_tr_b16 v[88:89], v21 offset:1304
    v_mfma_f32_16x16x32_bf16 v[214:217], v[70:73], v[234:237], 0
    ds_read_b64_tr_b16 v[90:91], v21 offset:32
    ds_read_b64_tr_b16 v[92:93], v21 offset:1312
    s_waitcnt lgkmcnt(12)
    v_mfma_f32_16x16x32_bf16 v[146:149], v[118:121], v[238:241], v[146:149]
    buffer_load_dwordx4 v[54:57], v12, s[16:19], s52 offen
    v_mfma_f32_16x16x32_bf16 v[170:173], v[118:121], v[242:245], v[170:173]
    buffer_load_dwordx4 v[58:61], v13, s[16:19], s52 offen
    v_mfma_f32_16x16x32_bf16 v[194:197], v[118:121], v[246:249], v[194:197]
    buffer_load_dwordx4 v[62:65], v14, s[16:19], s52 offen
    v_mfma_f32_16x16x32_bf16 v[218:221], v[118:121], v[250:253], v[218:221]
    buffer_load_dwordx4 v[66:69], v15, s[16:19], s52 offen
    s_waitcnt lgkmcnt(8)
    v_mfma_f32_16x16x32_bf16 v[126:129], v[74:77], v[238:241], v[126:129]
    buffer_load_dwordx4 v[70:73], v18, s[16:19], s52 offen
    v_mfma_f32_16x16x32_bf16 v[150:153], v[74:77], v[242:245], v[150:153]
    buffer_load_dwordx4 v[114:117], v19, s[24:27], s53 offen offset:192
    s_add_u32 s52, s52, 40960
    ds_read_b128 v[222:225], v20 offset:128
    v_mfma_f32_16x16x32_bf16 v[174:177], v[74:77], v[246:249], v[174:177]
    s_waitcnt vmcnt(6)
    ds_write_b128 v53, v[94:97] offset:0
    v_mfma_f32_16x16x32_bf16 v[198:201], v[74:77], v[250:253], v[198:201]
    ds_read_b128 v[226:229], v20 offset:5248
    s_waitcnt lgkmcnt(9)
    v_mfma_f32_16x16x32_bf16 v[130:133], v[78:81], v[238:241], v[130:133]
    ds_write_b128 v53, v[98:101] offset:1024
    v_mfma_f32_16x16x32_bf16 v[154:157], v[78:81], v[242:245], v[154:157]
    ds_read_b128 v[230:233], v20 offset:10368
    v_mfma_f32_16x16x32_bf16 v[178:181], v[78:81], v[246:249], v[178:181]
    ds_write_b128 v53, v[102:105] offset:2048
    v_mfma_f32_16x16x32_bf16 v[202:205], v[78:81], v[250:253], v[202:205]
    ds_read_b128 v[234:237], v20 offset:15488
    s_waitcnt lgkmcnt(11)
    v_mfma_f32_16x16x32_bf16 v[134:137], v[82:85], v[238:241], v[134:137]
    ds_write_b128 v53, v[106:109] offset:3072
    v_mfma_f32_16x16x32_bf16 v[158:161], v[82:85], v[242:245], v[158:161]
    v_mfma_f32_16x16x32_bf16 v[182:185], v[82:85], v[246:249], v[182:185]
    ds_write_b128 v53, v[110:113] offset:4096
    v_mfma_f32_16x16x32_bf16 v[206:209], v[82:85], v[250:253], v[206:209]
    ds_read_b64_tr_b16 v[94:95], v21 offset:0
    s_waitcnt lgkmcnt(12)
    v_mfma_f32_16x16x32_bf16 v[138:141], v[86:89], v[238:241], v[138:141]
    ds_read_b64_tr_b16 v[96:97], v21 offset:1280
    v_mfma_f32_16x16x32_bf16 v[162:165], v[86:89], v[242:245], v[162:165]
    ds_read_b64_tr_b16 v[98:99], v21 offset:8
    v_mfma_f32_16x16x32_bf16 v[186:189], v[86:89], v[246:249], v[186:189]
    ds_read_b64_tr_b16 v[100:101], v21 offset:1288
    v_mfma_f32_16x16x32_bf16 v[210:213], v[86:89], v[250:253], v[210:213]
    ds_read_b64_tr_b16 v[102:103], v21 offset:16
    s_waitcnt lgkmcnt(14)
    v_mfma_f32_16x16x32_bf16 v[142:145], v[90:93], v[238:241], v[142:145]
    ds_read_b64_tr_b16 v[104:105], v21 offset:1296
    v_mfma_f32_16x16x32_bf16 v[166:169], v[90:93], v[242:245], v[166:169]
    ds_read_b64_tr_b16 v[106:107], v21 offset:24
    v_mfma_f32_16x16x32_bf16 v[190:193], v[90:93], v[246:249], v[190:193]
    ds_read_b64_tr_b16 v[108:109], v21 offset:1304
    v_mfma_f32_16x16x32_bf16 v[214:217], v[90:93], v[250:253], v[214:217]
    ds_read_b64_tr_b16 v[110:111], v21 offset:32
    ds_read_b64_tr_b16 v[112:113], v21 offset:1312
    s_waitcnt lgkmcnt(12)
    v_mfma_f32_16x16x32_bf16 v[146:149], v[122:125], v[222:225], v[146:149]
    buffer_load_dwordx4 v[74:77], v12, s[16:19], s52 offen
    v_mfma_f32_16x16x32_bf16 v[170:173], v[122:125], v[226:229], v[170:173]
    buffer_load_dwordx4 v[78:81], v13, s[16:19], s52 offen
    v_mfma_f32_16x16x32_bf16 v[194:197], v[122:125], v[230:233], v[194:197]
    buffer_load_dwordx4 v[82:85], v14, s[16:19], s52 offen
    v_mfma_f32_16x16x32_bf16 v[218:221], v[122:125], v[234:237], v[218:221]
    buffer_load_dwordx4 v[86:89], v15, s[16:19], s52 offen
    s_waitcnt lgkmcnt(8)
    v_mfma_f32_16x16x32_bf16 v[126:129], v[94:97], v[222:225], v[126:129]
    buffer_load_dwordx4 v[90:93], v18, s[16:19], s52 offen
    v_mfma_f32_16x16x32_bf16 v[150:153], v[94:97], v[226:229], v[150:153]
    buffer_load_dwordx4 v[118:121], v19, s[24:27], s53 offen offset:256
    s_add_u32 s52, s52, 40960
    ds_read_b128 v[238:241], v20 offset:192
    v_mfma_f32_16x16x32_bf16 v[174:177], v[94:97], v[230:233], v[174:177]
    s_waitcnt vmcnt(6)
    ds_write_b128 v53, v[54:57] offset:0
    v_mfma_f32_16x16x32_bf16 v[198:201], v[94:97], v[234:237], v[198:201]
    ds_read_b128 v[242:245], v20 offset:5312
    s_waitcnt lgkmcnt(9)
    v_mfma_f32_16x16x32_bf16 v[130:133], v[98:101], v[222:225], v[130:133]
    ds_write_b128 v53, v[58:61] offset:1024
    v_mfma_f32_16x16x32_bf16 v[154:157], v[98:101], v[226:229], v[154:157]
    ds_read_b128 v[246:249], v20 offset:10432
    v_mfma_f32_16x16x32_bf16 v[178:181], v[98:101], v[230:233], v[178:181]
    ds_write_b128 v53, v[62:65] offset:2048
    v_mfma_f32_16x16x32_bf16 v[202:205], v[98:101], v[234:237], v[202:205]
    ds_read_b128 v[250:253], v20 offset:15552
    s_waitcnt lgkmcnt(11)
    v_mfma_f32_16x16x32_bf16 v[134:137], v[102:105], v[222:225], v[134:137]
    ds_write_b128 v53, v[66:69] offset:3072
    v_mfma_f32_16x16x32_bf16 v[158:161], v[102:105], v[226:229], v[158:161]
    v_mfma_f32_16x16x32_bf16 v[182:185], v[102:105], v[230:233], v[182:185]
    ds_write_b128 v53, v[70:73] offset:4096
    v_mfma_f32_16x16x32_bf16 v[206:209], v[102:105], v[234:237], v[206:209]
    ds_read_b64_tr_b16 v[54:55], v21 offset:0
    s_waitcnt lgkmcnt(12)
    v_mfma_f32_16x16x32_bf16 v[138:141], v[106:109], v[222:225], v[138:141]
    ds_read_b64_tr_b16 v[56:57], v21 offset:1280
    v_mfma_f32_16x16x32_bf16 v[162:165], v[106:109], v[226:229], v[162:165]
    ds_read_b64_tr_b16 v[58:59], v21 offset:8
    v_mfma_f32_16x16x32_bf16 v[186:189], v[106:109], v[230:233], v[186:189]
    ds_read_b64_tr_b16 v[60:61], v21 offset:1288
    v_mfma_f32_16x16x32_bf16 v[210:213], v[106:109], v[234:237], v[210:213]
    ds_read_b64_tr_b16 v[62:63], v21 offset:16
    s_waitcnt lgkmcnt(14)
    v_mfma_f32_16x16x32_bf16 v[142:145], v[110:113], v[222:225], v[142:145]
    ds_read_b64_tr_b16 v[64:65], v21 offset:1296
    v_mfma_f32_16x16x32_bf16 v[166:169], v[110:113], v[226:229], v[166:169]
    ds_read_b64_tr_b16 v[66:67], v21 offset:24
    v_mfma_f32_16x16x32_bf16 v[190:193], v[110:113], v[230:233], v[190:193]
    ds_read_b64_tr_b16 v[68:69], v21 offset:1304
    v_mfma_f32_16x16x32_bf16 v[214:217], v[110:113], v[234:237], v[214:217]
    ds_read_b64_tr_b16 v[70:71], v21 offset:32
    ds_read_b64_tr_b16 v[72:73], v21 offset:1312
    s_waitcnt lgkmcnt(12)
    v_mfma_f32_16x16x32_bf16 v[146:149], v[114:117], v[238:241], v[146:149]
    v_mfma_f32_16x16x32_bf16 v[170:173], v[114:117], v[242:245], v[170:173]
    v_mfma_f32_16x16x32_bf16 v[194:197], v[114:117], v[246:249], v[194:197]
    v_mfma_f32_16x16x32_bf16 v[218:221], v[114:117], v[250:253], v[218:221]
    s_waitcnt lgkmcnt(8)
    v_mfma_f32_16x16x32_bf16 v[126:129], v[54:57], v[238:241], v[126:129]
    v_mfma_f32_16x16x32_bf16 v[150:153], v[54:57], v[242:245], v[150:153]
    ds_read_b128 v[222:225], v20 offset:256
    v_mfma_f32_16x16x32_bf16 v[174:177], v[54:57], v[246:249], v[174:177]
    s_waitcnt vmcnt(0)
    ds_write_b128 v53, v[74:77] offset:0
    v_mfma_f32_16x16x32_bf16 v[198:201], v[54:57], v[250:253], v[198:201]
    ds_read_b128 v[226:229], v20 offset:5376
    s_waitcnt lgkmcnt(9)
    v_mfma_f32_16x16x32_bf16 v[130:133], v[58:61], v[238:241], v[130:133]
    ds_write_b128 v53, v[78:81] offset:1024
    v_mfma_f32_16x16x32_bf16 v[154:157], v[58:61], v[242:245], v[154:157]
    ds_read_b128 v[230:233], v20 offset:10496
    v_mfma_f32_16x16x32_bf16 v[178:181], v[58:61], v[246:249], v[178:181]
    ds_write_b128 v53, v[82:85] offset:2048
    v_mfma_f32_16x16x32_bf16 v[202:205], v[58:61], v[250:253], v[202:205]
    ds_read_b128 v[234:237], v20 offset:15616
    s_waitcnt lgkmcnt(11)
    v_mfma_f32_16x16x32_bf16 v[134:137], v[62:65], v[238:241], v[134:137]
    ds_write_b128 v53, v[86:89] offset:3072
    v_mfma_f32_16x16x32_bf16 v[158:161], v[62:65], v[242:245], v[158:161]
    v_mfma_f32_16x16x32_bf16 v[182:185], v[62:65], v[246:249], v[182:185]
    ds_write_b128 v53, v[90:93] offset:4096
    v_mfma_f32_16x16x32_bf16 v[206:209], v[62:65], v[250:253], v[206:209]
    ds_read_b64_tr_b16 v[74:75], v21 offset:0
    s_waitcnt lgkmcnt(12)
    v_mfma_f32_16x16x32_bf16 v[138:141], v[66:69], v[238:241], v[138:141]
    ds_read_b64_tr_b16 v[76:77], v21 offset:1280
    v_mfma_f32_16x16x32_bf16 v[162:165], v[66:69], v[242:245], v[162:165]
    ds_read_b64_tr_b16 v[78:79], v21 offset:8
    v_mfma_f32_16x16x32_bf16 v[186:189], v[66:69], v[246:249], v[186:189]
    ds_read_b64_tr_b16 v[80:81], v21 offset:1288
    v_mfma_f32_16x16x32_bf16 v[210:213], v[66:69], v[250:253], v[210:213]
    ds_read_b64_tr_b16 v[82:83], v21 offset:16
    s_waitcnt lgkmcnt(14)
    v_mfma_f32_16x16x32_bf16 v[142:145], v[70:73], v[238:241], v[142:145]
    ds_read_b64_tr_b16 v[84:85], v21 offset:1296
    v_mfma_f32_16x16x32_bf16 v[166:169], v[70:73], v[242:245], v[166:169]
    ds_read_b64_tr_b16 v[86:87], v21 offset:24
    v_mfma_f32_16x16x32_bf16 v[190:193], v[70:73], v[246:249], v[190:193]
    ds_read_b64_tr_b16 v[88:89], v21 offset:1304
    v_mfma_f32_16x16x32_bf16 v[214:217], v[70:73], v[250:253], v[214:217]
    ds_read_b64_tr_b16 v[90:91], v21 offset:32
    ds_read_b64_tr_b16 v[92:93], v21 offset:1312
    s_waitcnt lgkmcnt(12)
    v_mfma_f32_16x16x32_bf16 v[170:173], v[118:121], v[226:229], v[170:173]
    v_mfma_f32_16x16x32_bf16 v[194:197], v[118:121], v[230:233], v[194:197]
    v_add_u32 v94, s32, v1
    v_mfma_f32_16x16x32_bf16 v[218:221], v[118:121], v[234:237], v[218:221]
    v_add_u32 v95, s33, v1
    v_mfma_f32_16x16x32_bf16 v[146:149], v[118:121], v[222:225], v[146:149]
    v_add_u32 v96, s34, v1
    s_waitcnt lgkmcnt(8)
    v_mfma_f32_16x16x32_bf16 v[150:153], v[74:77], v[226:229], v[150:153]
    v_add_u32 v97, s35, v1
    v_mfma_f32_16x16x32_bf16 v[174:177], v[74:77], v[230:233], v[174:177]
    v_add_u32 v248, s28, v1
    v_mfma_f32_16x16x32_bf16 v[198:201], v[74:77], v[234:237], v[198:201]
    v_add_u32 v251, s29, v1
    v_mfma_f32_16x16x32_bf16 v[126:129], v[74:77], v[222:225], v[126:129]
    v_add_u32 v252, s30, v1
    s_waitcnt lgkmcnt(6)
    v_mfma_f32_16x16x32_bf16 v[154:157], v[78:81], v[226:229], v[154:157]
    v_add_u32 v253, s31, v1
    v_mfma_f32_16x16x32_bf16 v[178:181], v[78:81], v[230:233], v[178:181]
    v_add_u32 v249, 16, v255
    v_mfma_f32_16x16x32_bf16 v[202:205], v[78:81], v[234:237], v[202:205]
    buffer_load_dwordx2 v[8:9], v2, s[8:11], s63 offen sc1
    v_mfma_f32_16x16x32_bf16 v[130:133], v[78:81], v[222:225], v[130:133]
    s_waitcnt lgkmcnt(4)
    v_mfma_f32_16x16x32_bf16 v[158:161], v[82:85], v[226:229], v[158:161]
    v_mfma_f32_16x16x32_bf16 v[182:185], v[82:85], v[230:233], v[182:185]
    v_mfma_f32_16x16x32_bf16 v[206:209], v[82:85], v[234:237], v[206:209]
    v_mfma_f32_16x16x32_bf16 v[134:137], v[82:85], v[222:225], v[134:137]
    s_waitcnt lgkmcnt(2)
    v_mfma_f32_16x16x32_bf16 v[162:165], v[86:89], v[226:229], v[162:165]
    v_mfma_f32_16x16x32_bf16 v[186:189], v[86:89], v[230:233], v[186:189]
    v_mfma_f32_16x16x32_bf16 v[210:213], v[86:89], v[234:237], v[210:213]
    v_mfma_f32_16x16x32_bf16 v[138:141], v[86:89], v[222:225], v[138:141]
    s_waitcnt lgkmcnt(0)
    v_mfma_f32_16x16x32_bf16 v[166:169], v[90:93], v[226:229], v[166:169]
    v_mfma_f32_16x16x32_bf16 v[190:193], v[90:93], v[230:233], v[190:193]
    v_mfma_f32_16x16x32_bf16 v[214:217], v[90:93], v[234:237], v[214:217]
    v_mfma_f32_16x16x32_bf16 v[142:145], v[90:93], v[222:225], v[142:145]
    s_nop 0
    ds_write_b128 v94, v[150:153] offset:0
    ds_write_b128 v94, v[154:157] offset:1024
    ds_write_b128 v94, v[158:161] offset:2048
    ds_write_b128 v94, v[162:165] offset:3072
    ds_write_b128 v94, v[166:169] offset:4096
    ds_write_b32 v94, v170 offset:5120
    ds_write_b128 v94, v[174:177] offset:6144
    ds_write_b128 v94, v[178:181] offset:7168
    ds_write_b128 v94, v[182:185] offset:8192
    ds_write_b128 v94, v[186:189] offset:9216
    ds_write_b128 v94, v[190:193] offset:10240
    ds_write_b32 v94, v194 offset:11264
    ds_write_b128 v94, v[198:201] offset:12288
    ds_write_b128 v94, v[202:205] offset:13312
    ds_write_b128 v94, v[206:209] offset:14336
    ds_write_b128 v94, v[210:213] offset:15360
    ds_write_b128 v94, v[214:217] offset:16384
    ds_write_b32 v94, v218 offset:17408
    v_mov_b32 v5, 2
    s_mov_b64 exec, 1
    ds_write_b32 v254, v5 offset:0
    s_mov_b64 exec, -1
    v_mov_b64 v[220:221], v[24:25]
    v_mov_b64 v[222:223], v[26:27]
    v_mov_b64 v[224:225], v[28:29]
    v_mov_b64 v[226:227], v[30:31]
    v_mov_b64 v[240:241], v[16:17]
    v_mov_b64 v[228:229], v[24:25]
    v_mov_b64 v[230:231], v[26:27]
    v_mov_b64 v[232:233], v[28:29]
    v_mov_b64 v[234:235], v[30:31]
    v_mov_b64 v[246:247], v[16:17]
    s_movk_i32 s47, 0x4000
    s_branch poll_4_c
poll_4:
    buffer_load_dwordx2 v[8:9], v2, s[8:11], s63 offen sc1
poll_4_c:
    s_sub_u32 s47, s47, 1
    s_cbranch_scc1 poll_4_x
    s_waitcnt vmcnt(0)
    v_cmp_ne_u32 vcc, s43, v9
    s_cbranch_vccnz poll_4
poll_4_x:
    s_waitcnt vmcnt(0)
A_kvok:
    s_add_u32 s52, s50, s51
    s_add_u32 s51, s50, 40960
    s_mov_b32 s53, s52
    buffer_load_dwordx4 v[12:15], v1, s[8:11], s52 offen sc1
    s_mov_b32 exec_hi, 0
    buffer_load_dwordx2 v[16:17], v2, s[8:11], s52 offen offset:1024 sc1
    s_mov_b32 exec_hi, -1
    s_add_u32 s52, s52, 2560
    s_cmp_eq_u32 s52, s51
    s_cselect_b32 s52, s50, s52
    s_mov_b64 exec, s[54:55]
    buffer_load_dwordx4 v[24:27], v3, s[8:11], s53 offen offset:1280 sc1
    buffer_load_dwordx4 v[28:31], v3, s[8:11], s53 offen offset:1920 sc1
    s_mov_b64 exec, -1
    s_add_u32 s53, s53, 2560
    s_cmp_eq_u32 s53, s51
    s_cselect_b32 s53, s50, s53
    buffer_load_dwordx4 v[18:21], v1, s[8:11], s52 offen sc1
    s_mov_b32 exec_hi, 0
    buffer_load_dwordx2 v[22:23], v2, s[8:11], s52 offen offset:1024 sc1
    s_mov_b32 exec_hi, -1
    s_add_u32 s52, s52, 2560
    s_cmp_eq_u32 s52, s51
    s_cselect_b32 s52, s50, s52
    s_mov_b64 exec, s[54:55]
    buffer_load_dwordx4 v[32:35], v3, s[8:11], s53 offen offset:1280 sc1
    buffer_load_dwordx4 v[36:39], v3, s[8:11], s53 offen offset:1920 sc1
    s_mov_b64 exec, -1
    s_add_u32 s53, s53, 2560
    s_cmp_eq_u32 s53, s51
    s_cselect_b32 s53, s50, s53
    buffer_load_dwordx4 v[236:239], v1, s[8:11], s52 offen sc1
    s_mov_b32 exec_hi, 0
    buffer_load_dwordx2 v[240:241], v2, s[8:11], s52 offen offset:1024 sc1
    s_mov_b32 exec_hi, -1
    s_add_u32 s52, s52, 2560
    s_cmp_eq_u32 s52, s51
    s_cselect_b32 s52, s50, s52
    s_mov_b64 exec, s[54:55]
    buffer_load_dwordx4 v[220:223], v3, s[8:11], s53 offen offset:1280 sc1
    buffer_load_dwordx4 v[224:227], v3, s[8:11], s53 offen offset:1920 sc1
    s_mov_b64 exec, -1
    s_add_u32 s53, s53, 2560
    s_cmp_eq_u32 s53, s51
    s_cselect_b32 s53, s50, s53
    buffer_load_dwordx4 v[242:245], v1, s[8:11], s52 offen sc1
    s_mov_b32 exec_hi, 0
    buffer_load_dwordx2 v[246:247], v2, s[8:11], s52 offen offset:1024 sc1
    s_mov_b32 exec_hi, -1
    s_add_u32 s52, s52, 2560
    s_cmp_eq_u32 s52, s51
    s_cselect_b32 s52, s50, s52
    v_mov_b32 v9, v8
    s_nop 1
    v_permlane32_swap_b32 v8, v9
    v_max_f32 v8, v8, v9
    v_mov_b32 v9, v8
    s_nop 1
    v_permlane16_swap_b32 v8, v9
    v_max_f32 v8, v8, v9
    s_nop 1
    v_max_f32_dpp v8, v8, v8 quad_perm:[1,0,3,2] row_mask:0xf bank_mask:0xf
    s_nop 1
    v_max_f32_dpp v8, v8, v8 quad_perm:[2,3,0,1] row_mask:0xf bank_mask:0xf
    s_nop 1
    v_max_f32_dpp v8, v8, v8 row_half_mirror row_mask:0xf bank_mask:0xf
    s_nop 1
    v_max_f32_dpp v8, v8, v8 row_mirror row_mask:0xf bank_mask:0xf
    ds_write_b32 v254, v8 offset:64
    s_mov_b32 s47, 0x40000
sbw_5:
    ds_read_b32 v5, v255 offset:0
    s_sub_u32 s47, s47, 1
    s_waitcnt lgkmcnt(0)
    v_cmp_gt_u32 vcc, 2, v5
    s_cbranch_scc1 sbw_5_x
    s_cbranch_vccnz sbw_5
sbw_5_x:
    ds_read_b128 v[150:153], v95 offset:0
    ds_read_b128 v[154:157], v95 offset:1024
    ds_read_b128 v[158:161], v95 offset:2048
    ds_read_b128 v[162:165], v95 offset:3072
    ds_read_b128 v[166:169], v95 offset:4096
    ds_read_b32 v170, v95 offset:5120
    ds_read_b128 v[174:177], v96 offset:6144
    ds_read_b128 v[178:181], v96 offset:7168
    ds_read_b128 v[182:185], v96 offset:8192
    ds_read_b128 v[186:189], v96 offset:9216
    ds_read_b128 v[190:193], v96 offset:10240
    ds_read_b32 v194, v96 offset:11264
    ds_read_b128 v[198:201], v97 offset:12288
    ds_read_b128 v[202:205], v97 offset:13312
    ds_read_b128 v[206:209], v97 offset:14336
    ds_read_b128 v[210:213], v97 offset:15360
    ds_read_b128 v[214:217], v97 offset:16384
    ds_read_b32 v218, v97 offset:17408
    v_mov_b32 v5, 3
    s_mov_b64 exec, 1
    ds_write_b32 v254, v5 offset:0
    s_mov_b64 exec, -1
    s_waitcnt lgkmcnt(13)
    v_add_f32 v126, v150, v126
    v_add_f32 v127, v151, v127
    v_add_f32 v128, v152, v128
    v_add_f32 v129, v153, v129
    v_add_f32 v130, v154, v130
    v_add_f32 v131, v155, v131
    v_add_f32 v132, v156, v132
    v_add_f32 v133, v157, v133
    v_add_f32 v134, v158, v134
    v_add_f32 v135, v159, v135
    v_add_f32 v136, v160, v136
    v_add_f32 v137, v161, v137
    v_add_f32 v138, v162, v138
    v_add_f32 v139, v163, v139
    v_add_f32 v140, v164, v140
    v_add_f32 v141, v165, v141
    v_add_f32 v142, v166, v142
    v_add_f32 v143, v167, v143
    v_add_f32 v144, v168, v144
    v_add_f32 v145, v169, v145
    v_add_f32 v146, v146, v170
    s_waitcnt lgkmcnt(7)
    v_add_f32 v126, v174, v126
    v_add_f32 v127, v175, v127
    v_add_f32 v128, v176, v128
    v_add_f32 v129, v177, v129
    v_add_f32 v130, v178, v130
    v_add_f32 v131, v179, v131
    v_add_f32 v132, v180, v132
    v_add_f32 v133, v181, v133
    v_add_f32 v134, v182, v134
    v_add_f32 v135, v183, v135
    v_add_f32 v136, v184, v136
    v_add_f32 v137, v185, v137
    v_add_f32 v138, v186, v138
    v_add_f32 v139, v187, v139
    v_add_f32 v140, v188, v140
    v_add_f32 v141, v189, v141
    v_add_f32 v142, v190, v142
    v_add_f32 v143, v191, v143
    v_add_f32 v144, v192, v144
    v_add_f32 v145, v193, v145
    v_add_f32 v146, v146, v194
    s_waitcnt lgkmcnt(1)
    v_add_f32 v126, v198, v126
    v_add_f32 v127, v199, v127
    v_add_f32 v128, v200, v128
    v_add_f32 v129, v201, v129
    v_add_f32 v130, v202, v130
    v_add_f32 v131, v203, v131
    v_add_f32 v132, v204, v132
    v_add_f32 v133, v205, v133
    v_add_f32 v134, v206, v134
    v_add_f32 v135, v207, v135
    v_add_f32 v136, v208, v136
    v_add_f32 v137, v209, v137
    v_add_f32 v138, v210, v138
    v_add_f32 v139, v211, v139
    v_add_f32 v140, v212, v140
    v_add_f32 v141, v213, v141
    v_add_f32 v142, v214, v142
    v_add_f32 v143, v215, v143
    v_add_f32 v144, v216, v144
    v_add_f32 v145, v217, v145
    v_add_f32 v146, v146, v218
    v_mul_f32 v146, 0xbfb8aa3b, v146
    v_mfma_f32_32x32x8_bf16 v[56:71], v[10:11], v[10:11], 0
    v_exp_f32 v146, v146
    v_mul_f32 v126, s60, v126
    v_mul_f32 v127, s60, v127
    v_mul_f32 v128, s60, v128
    v_mul_f32 v129, s60, v129
    v_mul_f32 v130, s60, v130
    v_mul_f32 v131, s60, v131
    v_add_f32 v146, 1.0, v146
    v_rcp_f32 v146, v146
    v_mul_f32 v132, s60, v132
    v_mul_f32 v133, s60, v133
    v_mul_f32 v134, s60, v134
    v_mul_f32 v135, s60, v135
    v_mfma_f32_32x32x8_bf16 v[204:219], v[10:11], v[10:11], 0
    v_mul_f32 v136, s60, v136
    v_mul_f32 v137, s60, v137
    v_mul_f32 v138, s60, v138
    v_mul_f32 v139, s60, v139
    v_mul_f32 v140, s60, v140
    v_mul_f32 v141, s60, v141
    v_mul_f32 v142, s60, v142
    v_mul_f32 v143, s60, v143
    v_mul_f32 v144, s60, v144
    v_mul_f32 v145, s60, v145
    v_mfma_f32_32x32x8_bf16 v[156:171], v[10:11], v[10:11], 0
    ds_write_b32 v52, v146
    v_cvt_pk_bf16_f32 v72, v126, v127
    v_cvt_pk_bf16_f32 v73, v128, v129
    v_cvt_pk_bf16_f32 v76, v130, v131
    v_cvt_pk_bf16_f32 v77, v132, v133
    v_cvt_pk_bf16_f32 v74, v134, v135
    v_cvt_pk_bf16_f32 v75, v136, v137
    v_mfma_f32_32x32x8_bf16 v[188:203], v[10:11], v[10:11], 0
    v_cvt_pk_bf16_f32 v78, v138, v139
    v_cvt_pk_bf16_f32 v79, v140, v141
    v_cvt_pk_bf16_f32 v80, v142, v143
    v_cvt_pk_bf16_f32 v81, v144, v145
    v_mfma_f32_32x32x8_bf16 v[148:163], v[10:11], v[10:11], 0
    ds_write_b128 v49, v[72:75]
    ds_write_b128 v49, v[76:79] offset:512
    ds_write_b64 v50, v[80:81] offset:1024
    v_mul_f32 v82, v126, v126
    v_mul_f32 v83, v127, v127
    v_mul_f32 v84, v128, v128
    v_mul_f32 v85, v129, v129
    v_fmac_f32 v82, v130, v130
    v_fmac_f32 v83, v131, v131
    v_fmac_f32 v84, v132, v132
    v_fmac_f32 v85, v133, v133
    v_fmac_f32 v82, v134, v134
    v_fmac_f32 v83, v135, v135
    v_mfma_f32_32x32x8_bf16 v[172:187], v[10:11], v[10:11], 0
    v_fmac_f32 v84, v136, v136
    v_fmac_f32 v85, v137, v137
    v_fmac_f32 v82, v138, v138
    v_fmac_f32 v83, v139, v139
    v_fmac_f32 v84, v140, v140
    v_fmac_f32 v85, v141, v141
    v_fmac_f32 v82, v142, v142
    v_fmac_f32 v83, v143, v143
    v_fmac_f32 v84, v144, v144
    v_fmac_f32 v85, v145, v145
    v_add_f32 v82, v84, v82
    v_add_f32 v83, v85, v83
    v_add_f32 v82, v82, v83
    v_mov_b32 v83, 0
    v_sqrt_f32 v82, v82
    v_mfma_f32_32x32x8_bf16 v[120:135], v[10:11], v[10:11], 0
    ds_write_b64 v50, v[82:83] offset:1280
    v_mov_b32 v7, 4
    s_mov_b64 exec, 1
    ds_write_b32 v254, v7 offset:0
    s_mov_b64 exec, -1
    v_mfma_f32_32x32x8_bf16 v[132:147], v[10:11], v[10:11], 0
    s_mov_b32 s47, 0x40000
sbw_6:
    ds_read_b32 v7, v255 offset:0
    s_sub_u32 s47, s47, 1
    s_waitcnt lgkmcnt(0)
    v_cmp_gt_u32 vcc, 4, v7
    s_cbranch_scc1 sbw_6_x
    s_cbranch_vccnz sbw_6
sbw_6_x:
    ds_read_b32 v6, v255 offset:64
    ds_read_b64 v[76:77], v43 offset:1024
    ds_read_b64 v[82:83], v43 offset:7168
    ds_read_b64 v[88:89], v45 offset:1024
    ds_read_b64 v[94:95], v45 offset:7168
    ds_read_b64 v[100:101], v47 offset:1024
    ds_read_b64 v[106:107], v47 offset:7168
    ds_read_b64 v[112:113], v41 offset:1024
    ds_read_b64 v[118:119], v41 offset:7168
    ds_read_b128 v[72:75], v42 offset:0
    ds_read_b128 v[78:81], v42 offset:6144
    ds_read_b128 v[84:87], v44 offset:0
    ds_read_b128 v[90:93], v44 offset:6144
    ds_read_b128 v[96:99], v46 offset:0
    ds_read_b128 v[102:105], v46 offset:6144
    ds_read_b128 v[108:111], v40 offset:0
    ds_read_b128 v[114:117], v40 offset:6144
    ds_read_b32 v5, v48
    s_waitcnt lgkmcnt(15)
    v_max_f32_dpp v6, v6, v6 quad_perm:[1,0,3,2] row_mask:0xf bank_mask:0xf
    s_nop 1
    v_max_f32_dpp v6, v6, v6 quad_perm:[2,3,0,1] row_mask:0xf bank_mask:0xf
    s_nop 1
    v_sqrt_f32 v6, v6
    s_nop 0
    v_mul_f32 v6, 0xbf810625, v6
    s_waitcnt lgkmcnt(9)
    s_mov_b32 exec_lo, 0
    v_mul_f32 v76, v6, v76
    v_mul_f32 v82, v6, v82
    v_mul_f32 v88, v6, v88
    v_mul_f32 v94, v6, v94
    v_mul_f32 v100, v6, v100
    v_mul_f32 v106, v6, v106
    v_mul_f32 v112, v6, v112
    v_mul_f32 v118, v6, v118
    v_lshrrev_b32 v76, 16, v76
    v_lshrrev_b32 v82, 16, v82
    v_lshrrev_b32 v88, 16, v88
    v_lshrrev_b32 v94, 16, v94
    v_lshrrev_b32 v100, 16, v100
    v_lshrrev_b32 v106, 16, v106
    v_lshrrev_b32 v112, 16, v112
    v_lshrrev_b32 v118, 16, v118
    s_mov_b32 exec_lo, -1
    s_waitcnt lgkmcnt(0)
    v_mov_b32 v7, 7
    s_mov_b64 exec, 1
    ds_write_b32 v254, v7 offset:0
    s_mov_b64 exec, -1
    s_setprio 0
    s_mov_b32 s47, 3
    s_waitcnt vmcnt(12)
    v_mfma_f32_32x32x16_bf16 v[40:55], v[12:15], v[72:75], 0
    v_mfma_f32_32x32x8_bf16 v[40:55], v[16:17], v[76:77], v[40:55]
    s_nop 11
.p2align 6
A_loop:
    v_exp_f32 v40, v40
    v_exp_f32 v41, v41
    v_smfmac_f32_32x32x32_bf16 v[204:219], v[232:235], v[64:71], v4
    s_mov_b64 exec, s[54:55]
    buffer_load_dwordx4 v[228:231], v3, s[8:11], s53 offen offset:1280 sc1
    buffer_load_dwordx4 v[232:235], v3, s[8:11], s53 offen offset:1920 sc1
    s_mov_b64 exec, -1
    v_exp_f32 v42, v42
    v_exp_f32 v43, v43
    v_exp_f32 v44, v44
    v_exp_f32 v45, v45
    v_mfma_f32_32x32x16_bf16 v[56:71], v[12:15], v[78:81], 0
    v_exp_f32 v46, v46
    v_exp_f32 v47, v47
    v_exp_f32 v48, v48
    v_exp_f32 v49, v49
    v_mfma_f32_32x32x8_bf16 v[56:71], v[16:17], v[82:83], v[56:71]
    v_exp_f32 v50, v50
    v_exp_f32 v51, v51
    v_exp_f32 v52, v52
    v_exp_f32 v53, v53
    s_waitcnt vmcnt(12)
    v_smfmac_f32_32x32x32_bf16 v[120:135], v[24:27], v[40:47], v4
    v_exp_f32 v54, v54
    v_exp_f32 v55, v55
    v_exp_f32 v56, v56
    v_exp_f32 v57, v57
    v_smfmac_f32_32x32x32_bf16 v[120:135], v[28:31], v[48:55], v4
    v_exp_f32 v58, v58
    s_add_u32 s53, s53, 2560
    v_exp_f32 v59, v59
    v_exp_f32 v60, v60
    v_exp_f32 v61, v61
    v_mfma_f32_32x32x16_bf16 v[40:55], v[12:15], v[84:87], 0
    s_cmp_eq_u32 s53, s51
    v_exp_f32 v62, v62
    v_exp_f32 v63, v63
    v_exp_f32 v64, v64
    s_cselect_b32 s53, s50, s53
    v_exp_f32 v65, v65
    v_mfma_f32_32x32x8_bf16 v[40:55], v[16:17], v[88:89], v[40:55]
    v_exp_f32 v66, v66
    v_exp_f32 v67, v67
    v_exp_f32 v68, v68
    v_exp_f32 v69, v69
    v_smfmac_f32_32x32x32_bf16 v[132:147], v[24:27], v[56:63], v4
    v_exp_f32 v70, v70
    v_exp_f32 v71, v71
    v_exp_f32 v40, v40
    v_exp_f32 v41, v41
    v_smfmac_f32_32x32x32_bf16 v[132:147], v[28:31], v[64:71], v4
    v_exp_f32 v42, v42
    v_exp_f32 v43, v43
    v_exp_f32 v44, v44
    v_exp_f32 v45, v45
    v_mfma_f32_32x32x16_bf16 v[56:71], v[12:15], v[90:93], 0
    v_exp_f32 v46, v46
    v_exp_f32 v47, v47
    v_exp_f32 v48, v48
    v_exp_f32 v49, v49
    v_mfma_f32_32x32x8_bf16 v[56:71], v[16:17], v[94:95], v[56:71]
    v_exp_f32 v50, v50
    v_exp_f32 v51, v51
    v_exp_f32 v52, v52
    v_exp_f32 v53, v53
    v_smfmac_f32_32x32x32_bf16 v[144:159], v[24:27], v[40:47], v4
    v_exp_f32 v54, v54
    v_exp_f32 v55, v55
    v_exp_f32 v56, v56
    v_exp_f32 v57, v57
    v_smfmac_f32_32x32x32_bf16 v[144:159], v[28:31], v[48:55], v4
    v_exp_f32 v58, v58
    v_exp_f32 v59, v59
    v_exp_f32 v60, v60
    v_exp_f32 v61, v61
    v_mfma_f32_32x32x16_bf16 v[40:55], v[12:15], v[96:99], 0
    v_exp_f32 v62, v62
    v_exp_f32 v63, v63
    v_exp_f32 v64, v64
    v_exp_f32 v65, v65
    v_mfma_f32_32x32x8_bf16 v[40:55], v[16:17], v[100:101], v[40:55]
    v_exp_f32 v66, v66
    v_exp_f32 v67, v67
    v_exp_f32 v68, v68
    v_exp_f32 v69, v69
    v_smfmac_f32_32x32x32_bf16 v[156:171], v[24:27], v[56:63], v4
    v_exp_f32 v70, v70
    v_exp_f32 v71, v71
    v_exp_f32 v40, v40
    v_exp_f32 v41, v41
    v_smfmac_f32_32x32x32_bf16 v[156:171], v[28:31], v[64:71], v4
    v_exp_f32 v42, v42
    v_exp_f32 v43, v43
    v_exp_f32 v44, v44
    v_exp_f32 v45, v45
    v_mfma_f32_32x32x16_bf16 v[56:71], v[12:15], v[102:105], 0
    v_exp_f32 v46, v46
    v_exp_f32 v47, v47
    v_exp_f32 v48, v48
    v_exp_f32 v49, v49
    v_mfma_f32_32x32x8_bf16 v[56:71], v[16:17], v[106:107], v[56:71]
    v_exp_f32 v50, v50
    v_exp_f32 v51, v51
    v_exp_f32 v52, v52
    v_exp_f32 v53, v53
    v_smfmac_f32_32x32x32_bf16 v[168:183], v[24:27], v[40:47], v4
    v_exp_f32 v54, v54
    v_exp_f32 v55, v55
    v_exp_f32 v56, v56
    v_exp_f32 v57, v57
    v_smfmac_f32_32x32x32_bf16 v[168:183], v[28:31], v[48:55], v4
    v_exp_f32 v58, v58
    v_exp_f32 v59, v59
    v_exp_f32 v60, v60
    v_exp_f32 v61, v61
    v_mfma_f32_32x32x16_bf16 v[40:55], v[12:15], v[108:111], 0
    v_exp_f32 v62, v62
    v_exp_f32 v63, v63
    v_exp_f32 v64, v64
    v_exp_f32 v65, v65
    v_mfma_f32_32x32x8_bf16 v[40:55], v[16:17], v[112:113], v[40:55]
    v_exp_f32 v66, v66
    v_exp_f32 v67, v67
    v_exp_f32 v68, v68
    v_exp_f32 v69, v69
    v_smfmac_f32_32x32x32_bf16 v[180:195], v[24:27], v[56:63], v4
    v_exp_f32 v70, v70
    v_exp_f32 v71, v71
    v_exp_f32 v40, v40
    v_exp_f32 v41, v41
    v_smfmac_f32_32x32x32_bf16 v[180:195], v[28:31], v[64:71], v4
    v_exp_f32 v42, v42
    v_exp_f32 v43, v43
    v_exp_f32 v44, v44
    v_exp_f32 v45, v45
    v_mfma_f32_32x32x16_bf16 v[56:71], v[12:15], v[114:117], 0
    v_exp_f32 v46, v46
    v_exp_f32 v47, v47
    v_exp_f32 v48, v48
    v_exp_f32 v49, v49
    v_mfma_f32_32x32x8_bf16 v[56:71], v[16:17], v[118:119], v[56:71]
    v_exp_f32 v50, v50
    v_exp_f32 v51, v51
    v_exp_f32 v52, v52
    v_exp_f32 v53, v53
    v_smfmac_f32_32x32x32_bf16 v[192:207], v[24:27], v[40:47], v4
    v_exp_f32 v54, v54
    v_exp_f32 v55, v55
    buffer_load_dwordx4 v[12:15], v1, s[8:11], s52 offen sc1
    s_mov_b32 exec_hi, 0
    buffer_load_dwordx2 v[16:17], v2, s[8:11], s52 offen offset:1024 sc1
    s_mov_b32 exec_hi, -1
    v_exp_f32 v56, v56
    v_exp_f32 v57, v57
    v_smfmac_f32_32x32x32_bf16 v[192:207], v[28:31], v[48:55], v4
    v_exp_f32 v58, v58
    s_add_u32 s52, s52, 2560
    v_exp_f32 v59, v59
    v_exp_f32 v60, v60
    v_exp_f32 v61, v61
    s_waitcnt vmcnt(12)
    v_mfma_f32_32x32x16_bf16 v[40:55], v[18:21], v[72:75], 0
    s_cmp_eq_u32 s52, s51
    v_exp_f32 v62, v62
    v_exp_f32 v63, v63
    v_exp_f32 v64, v64
    s_cselect_b32 s52, s50, s52
    v_exp_f32 v65, v65
    v_mfma_f32_32x32x8_bf16 v[40:55], v[22:23], v[76:77], v[40:55]
    v_exp_f32 v66, v66
    v_exp_f32 v67, v67
    v_exp_f32 v68, v68
    v_exp_f32 v69, v69
    v_smfmac_f32_32x32x32_bf16 v[204:219], v[24:27], v[56:63], v4
    v_exp_f32 v70, v70
    v_exp_f32 v71, v71
    v_exp_f32 v40, v40
    v_exp_f32 v41, v41
    v_smfmac_f32_32x32x32_bf16 v[204:219], v[28:31], v[64:71], v4
    s_mov_b64 exec, s[54:55]
    buffer_load_dwordx4 v[24:27], v3, s[8:11], s53 offen offset:1280 sc1
    buffer_load_dwordx4 v[28:31], v3, s[8:11], s53 offen offset:1920 sc1
    s_mov_b64 exec, -1
    v_exp_f32 v42, v42
    v_exp_f32 v43, v43
    v_exp_f32 v44, v44
    v_exp_f32 v45, v45
    v_mfma_f32_32x32x16_bf16 v[56:71], v[18:21], v[78:81], 0
    v_exp_f32 v46, v46
    v_exp_f32 v47, v47
    v_exp_f32 v48, v48
    v_exp_f32 v49, v49
    v_mfma_f32_32x32x8_bf16 v[56:71], v[22:23], v[82:83], v[56:71]
    v_exp_f32 v50, v50
    v_exp_f32 v51, v51
    v_exp_f32 v52, v52
    v_exp_f32 v53, v53
    s_waitcnt vmcnt(12)
    v_smfmac_f32_32x32x32_bf16 v[120:135], v[32:35], v[40:47], v4
    v_exp_f32 v54, v54
    v_exp_f32 v55, v55
    v_exp_f32 v56, v56
    v_exp_f32 v57, v57
    v_smfmac_f32_32x32x32_bf16 v[120:135], v[36:39], v[48:55], v4
    v_exp_f32 v58, v58
    s_add_u32 s53, s53, 2560
    v_exp_f32 v59, v59
    v_exp_f32 v60, v60
    v_exp_f32 v61, v61
    v_mfma_f32_32x32x16_bf16 v[40:55], v[18:21], v[84:87], 0
    s_cmp_eq_u32 s53, s51
    v_exp_f32 v62, v62
    v_exp_f32 v63, v63
    v_exp_f32 v64, v64
    s_cselect_b32 s53, s50, s53
    v_exp_f32 v65, v65
    v_mfma_f32_32x32x8_bf16 v[40:55], v[22:23], v[88:89], v[40:55]
    v_exp_f32 v66, v66
    v_exp_f32 v67, v67
    v_exp_f32 v68, v68
    v_exp_f32 v69, v69
    v_smfmac_f32_32x32x32_bf16 v[132:147], v[32:35], v[56:63], v4
    v_exp_f32 v70, v70
    v_exp_f32 v71, v71
    v_exp_f32 v40, v40
    v_exp_f32 v41, v41
    v_smfmac_f32_32x32x32_bf16 v[132:147], v[36:39], v[64:71], v4
    v_exp_f32 v42, v42
    v_exp_f32 v43, v43
    v_exp_f32 v44, v44
    v_exp_f32 v45, v45
    v_mfma_f32_32x32x16_bf16 v[56:71], v[18:21], v[90:93], 0
    v_exp_f32 v46, v46
    v_exp_f32 v47, v47
    v_exp_f32 v48, v48
    v_exp_f32 v49, v49
    v_mfma_f32_32x32x8_bf16 v[56:71], v[22:23], v[94:95], v[56:71]
    v_exp_f32 v50, v50
    v_exp_f32 v51, v51
    v_exp_f32 v52, v52
    v_exp_f32 v53, v53
    v_smfmac_f32_32x32x32_bf16 v[144:159], v[32:35], v[40:47], v4
    v_exp_f32 v54, v54
    v_exp_f32 v55, v55
    v_exp_f32 v56, v56
    v_exp_f32 v57, v57
    v_smfmac_f32_32x32x32_bf16 v[144:159], v[36:39], v[48:55], v4
    v_exp_f32 v58, v58
    v_exp_f32 v59, v59
    v_exp_f32 v60, v60
    v_exp_f32 v61, v61
    v_mfma_f32_32x32x16_bf16 v[40:55], v[18:21], v[96:99], 0
    v_exp_f32 v62, v62
    v_exp_f32 v63, v63
    v_exp_f32 v64, v64
    v_exp_f32 v65, v65
    v_mfma_f32_32x32x8_bf16 v[40:55], v[22:23], v[100:101], v[40:55]
    v_exp_f32 v66, v66
    v_exp_f32 v67, v67
    v_exp_f32 v68, v68
    v_exp_f32 v69, v69
    v_smfmac_f32_32x32x32_bf16 v[156:171], v[32:35], v[56:63], v4
    v_exp_f32 v70, v70
    v_exp_f32 v71, v71
    v_exp_f32 v40, v40
    v_exp_f32 v41, v41
    v_smfmac_f32_32x32x32_bf16 v[156:171], v[36:39], v[64:71], v4
    v_exp_f32 v42, v42
    v_exp_f32 v43, v43
    v_exp_f32 v44, v44
    v_exp_f32 v45, v45
    v_mfma_f32_32x32x16_bf16 v[56:71], v[18:21], v[102:105], 0
    v_exp_f32 v46, v46
    v_exp_f32 v47, v47
    v_exp_f32 v48, v48
    v_exp_f32 v49, v49
    v_mfma_f32_32x32x8_bf16 v[56:71], v[22:23], v[106:107], v[56:71]
    v_exp_f32 v50, v50
    v_exp_f32 v51, v51
    v_exp_f32 v52, v52
    v_exp_f32 v53, v53
    v_smfmac_f32_32x32x32_bf16 v[168:183], v[32:35], v[40:47], v4
    v_exp_f32 v54, v54
    v_exp_f32 v55, v55
    v_exp_f32 v56, v56
    v_exp_f32 v57, v57
    v_smfmac_f32_32x32x32_bf16 v[168:183], v[36:39], v[48:55], v4
    v_exp_f32 v58, v58
    v_exp_f32 v59, v59
    v_exp_f32 v60, v60
    v_exp_f32 v61, v61
    v_mfma_f32_32x32x16_bf16 v[40:55], v[18:21], v[108:111], 0
    v_exp_f32 v62, v62
    v_exp_f32 v63, v63
    v_exp_f32 v64, v64
    v_exp_f32 v65, v65
    v_mfma_f32_32x32x8_bf16 v[40:55], v[22:23], v[112:113], v[40:55]
    v_exp_f32 v66, v66
    v_exp_f32 v67, v67
    v_exp_f32 v68, v68
    v_exp_f32 v69, v69
    v_smfmac_f32_32x32x32_bf16 v[180:195], v[32:35], v[56:63], v4
    v_exp_f32 v70, v70
    v_exp_f32 v71, v71
    v_exp_f32 v40, v40
    v_exp_f32 v41, v41
    v_smfmac_f32_32x32x32_bf16 v[180:195], v[36:39], v[64:71], v4
    v_exp_f32 v42, v42
    v_exp_f32 v43, v43
    v_exp_f32 v44, v44
    v_exp_f32 v45, v45
    v_mfma_f32_32x32x16_bf16 v[56:71], v[18:21], v[114:117], 0
    v_exp_f32 v46, v46
    v_exp_f32 v47, v47
    v_exp_f32 v48, v48
    v_exp_f32 v49, v49
    v_mfma_f32_32x32x8_bf16 v[56:71], v[22:23], v[118:119], v[56:71]
    v_exp_f32 v50, v50
    v_exp_f32 v51, v51
    v_exp_f32 v52, v52
    v_exp_f32 v53, v53
    v_smfmac_f32_32x32x32_bf16 v[192:207], v[32:35], v[40:47], v4
    v_exp_f32 v54, v54
    v_exp_f32 v55, v55
    buffer_load_dwordx4 v[18:21], v1, s[8:11], s52 offen sc1
    s_mov_b32 exec_hi, 0
    buffer_load_dwordx2 v[22:23], v2, s[8:11], s52 offen offset:1024 sc1
    s_mov_b32 exec_hi, -1
    v_exp_f32 v56, v56
    v_exp_f32 v57, v57
    v_smfmac_f32_32x32x32_bf16 v[192:207], v[36:39], v[48:55], v4
    v_exp_f32 v58, v58
    s_add_u32 s52, s52, 2560
    v_exp_f32 v59, v59
    v_exp_f32 v60, v60
    v_exp_f32 v61, v61
    s_waitcnt vmcnt(12)
    v_mfma_f32_32x32x16_bf16 v[40:55], v[236:239], v[72:75], 0
    s_cmp_eq_u32 s52, s51
    v_exp_f32 v62, v62
    v_exp_f32 v63, v63
    v_exp_f32 v64, v64
    s_cselect_b32 s52, s50, s52
    v_exp_f32 v65, v65
    v_mfma_f32_32x32x8_bf16 v[40:55], v[240:241], v[76:77], v[40:55]
    v_exp_f32 v66, v66
    v_exp_f32 v67, v67
    v_exp_f32 v68, v68
    v_exp_f32 v69, v69
    v_smfmac_f32_32x32x32_bf16 v[204:219], v[32:35], v[56:63], v4
    v_exp_f32 v70, v70
    v_exp_f32 v71, v71
    v_exp_f32 v40, v40
    v_exp_f32 v41, v41
    v_smfmac_f32_32x32x32_bf16 v[204:219], v[36:39], v[64:71], v4
    s_mov_b64 exec, s[54:55]
    buffer_load_dwordx4 v[32:35], v3, s[8:11], s53 offen offset:1280 sc1
    buffer_load_dwordx4 v[36:39], v3, s[8:11], s53 offen offset:1920 sc1
    s_mov_b64 exec, -1
    v_exp_f32 v42, v42
    v_exp_f32 v43, v43
    v_exp_f32 v44, v44
    v_exp_f32 v45, v45
    v_mfma_f32_32x32x16_bf16 v[56:71], v[236:239], v[78:81], 0
    v_exp_f32 v46, v46
    v_exp_f32 v47, v47
    v_exp_f32 v48, v48
    v_exp_f32 v49, v49
    v_mfma_f32_32x32x8_bf16 v[56:71], v[240:241], v[82:83], v[56:71]
    v_exp_f32 v50, v50
    v_exp_f32 v51, v51
    v_exp_f32 v52, v52
    v_exp_f32 v53, v53
    s_waitcnt vmcnt(12)
    v_smfmac_f32_32x32x32_bf16 v[120:135], v[220:223], v[40:47], v4
    v_exp_f32 v54, v54
    v_exp_f32 v55, v55
    v_exp_f32 v56, v56
    v_exp_f32 v57, v57
    v_smfmac_f32_32x32x32_bf16 v[120:135], v[224:227], v[48:55], v4
    v_exp_f32 v58, v58
    s_add_u32 s53, s53, 2560
    v_exp_f32 v59, v59
    v_exp_f32 v60, v60
    v_exp_f32 v61, v61
    v_mfma_f32_32x32x16_bf16 v[40:55], v[236:239], v[84:87], 0
    s_cmp_eq_u32 s53, s51
    v_exp_f32 v62, v62
    v_exp_f32 v63, v63
    v_exp_f32 v64, v64
    s_cselect_b32 s53, s50, s53
    v_exp_f32 v65, v65
    v_mfma_f32_32x32x8_bf16 v[40:55], v[240:241], v[88:89], v[40:55]
    v_exp_f32 v66, v66
    v_exp_f32 v67, v67
    v_exp_f32 v68, v68
    v_exp_f32 v69, v69
    v_smfmac_f32_32x32x32_bf16 v[132:147], v[220:223], v[56:63], v4
    v_exp_f32 v70, v70
    v_exp_f32 v71, v71
    v_exp_f32 v40, v40
    v_exp_f32 v41, v41
    v_smfmac_f32_32x32x32_bf16 v[132:147], v[224:227], v[64:71], v4
    v_exp_f32 v42, v42
    v_exp_f32 v43, v43
    v_exp_f32 v44, v44
    v_exp_f32 v45, v45
    v_mfma_f32_32x32x16_bf16 v[56:71], v[236:239], v[90:93], 0
    v_exp_f32 v46, v46
    v_exp_f32 v47, v47
    v_exp_f32 v48, v48
    v_exp_f32 v49, v49
    v_mfma_f32_32x32x8_bf16 v[56:71], v[240:241], v[94:95], v[56:71]
    v_exp_f32 v50, v50
    v_exp_f32 v51, v51
    v_exp_f32 v52, v52
    v_exp_f32 v53, v53
    v_smfmac_f32_32x32x32_bf16 v[144:159], v[220:223], v[40:47], v4
    v_exp_f32 v54, v54
    v_exp_f32 v55, v55
    v_exp_f32 v56, v56
    v_exp_f32 v57, v57
    v_smfmac_f32_32x32x32_bf16 v[144:159], v[224:227], v[48:55], v4
    v_exp_f32 v58, v58
    v_exp_f32 v59, v59
    v_exp_f32 v60, v60
    v_exp_f32 v61, v61
    v_mfma_f32_32x32x16_bf16 v[40:55], v[236:239], v[96:99], 0
    v_exp_f32 v62, v62
    v_exp_f32 v63, v63
    v_exp_f32 v64, v64
    v_exp_f32 v65, v65
    v_mfma_f32_32x32x8_bf16 v[40:55], v[240:241], v[100:101], v[40:55]
    v_exp_f32 v66, v66
    v_exp_f32 v67, v67
    v_exp_f32 v68, v68
    v_exp_f32 v69, v69
    v_smfmac_f32_32x32x32_bf16 v[156:171], v[220:223], v[56:63], v4
    v_exp_f32 v70, v70
    v_exp_f32 v71, v71
    v_exp_f32 v40, v40
    v_exp_f32 v41, v41
    v_smfmac_f32_32x32x32_bf16 v[156:171], v[224:227], v[64:71], v4
    v_exp_f32 v42, v42
    v_exp_f32 v43, v43
    v_exp_f32 v44, v44
    v_exp_f32 v45, v45
    v_mfma_f32_32x32x16_bf16 v[56:71], v[236:239], v[102:105], 0
    v_exp_f32 v46, v46
    v_exp_f32 v47, v47
    v_exp_f32 v48, v48
    v_exp_f32 v49, v49
    v_mfma_f32_32x32x8_bf16 v[56:71], v[240:241], v[106:107], v[56:71]
    v_exp_f32 v50, v50
    v_exp_f32 v51, v51
    v_exp_f32 v52, v52
    v_exp_f32 v53, v53
    v_smfmac_f32_32x32x32_bf16 v[168:183], v[220:223], v[40:47], v4
    v_exp_f32 v54, v54
    v_exp_f32 v55, v55
    v_exp_f32 v56, v56
    v_exp_f32 v57, v57
    v_smfmac_f32_32x32x32_bf16 v[168:183], v[224:227], v[48:55], v4
    v_exp_f32 v58, v58
    v_exp_f32 v59, v59
    v_exp_f32 v60, v60
    v_exp_f32 v61, v61
    v_mfma_f32_32x32x16_bf16 v[40:55], v[236:239], v[108:111], 0
    v_exp_f32 v62, v62
    v_exp_f32 v63, v63
    v_exp_f32 v64, v64
    v_exp_f32 v65, v65
    v_mfma_f32_32x32x8_bf16 v[40:55], v[240:241], v[112:113], v[40:55]
    v_exp_f32 v66, v66
    v_exp_f32 v67, v67
    v_exp_f32 v68, v68
    v_exp_f32 v69, v69
    v_smfmac_f32_32x32x32_bf16 v[180:195], v[220:223], v[56:63], v4
    v_exp_f32 v70, v70
    v_exp_f32 v71, v71
    v_exp_f32 v40, v40
    v_exp_f32 v41, v41
    v_smfmac_f32_32x32x32_bf16 v[180:195], v[224:227], v[64:71], v4
    v_exp_f32 v42, v42
    v_exp_f32 v43, v43
    v_exp_f32 v44, v44
    v_exp_f32 v45, v45
    v_mfma_f32_32x32x16_bf16 v[56:71], v[236:239], v[114:117], 0
    v_exp_f32 v46, v46
    v_exp_f32 v47, v47
    v_exp_f32 v48, v48
    v_exp_f32 v49, v49
    v_mfma_f32_32x32x8_bf16 v[56:71], v[240:241], v[118:119], v[56:71]
    v_exp_f32 v50, v50
    v_exp_f32 v51, v51
    v_exp_f32 v52, v52
    v_exp_f32 v53, v53
    v_smfmac_f32_32x32x32_bf16 v[192:207], v[220:223], v[40:47], v4
    v_exp_f32 v54, v54
    v_exp_f32 v55, v55
    buffer_load_dwordx4 v[236:239], v1, s[8:11], s52 offen sc1
    s_mov_b32 exec_hi, 0
    buffer_load_dwordx2 v[240:241], v2, s[8:11], s52 offen offset:1024 sc1
    s_mov_b32 exec_hi, -1
    v_exp_f32 v56, v56
    v_exp_f32 v57, v57
    v_smfmac_f32_32x32x32_bf16 v[192:207], v[224:227], v[48:55], v4
    v_exp_f32 v58, v58
    s_add_u32 s52, s52, 2560
    v_exp_f32 v59, v59
    v_exp_f32 v60, v60
    v_exp_f32 v61, v61
    s_waitcnt vmcnt(12)
    v_mfma_f32_32x32x16_bf16 v[40:55], v[242:245], v[72:75], 0
    s_cmp_eq_u32 s52, s51
    v_exp_f32 v62, v62
    v_exp_f32 v63, v63
    v_exp_f32 v64, v64
    s_cselect_b32 s52, s50, s52
    v_exp_f32 v65, v65
    v_mfma_f32_32x32x8_bf16 v[40:55], v[246:247], v[76:77], v[40:55]
    v_exp_f32 v66, v66
    v_exp_f32 v67, v67
    v_exp_f32 v68, v68
    v_exp_f32 v69, v69
    v_smfmac_f32_32x32x32_bf16 v[204:219], v[220:223], v[56:63], v4
    v_exp_f32 v70, v70
    v_exp_f32 v71, v71
    v_exp_f32 v40, v40
    v_exp_f32 v41, v41
    v_smfmac_f32_32x32x32_bf16 v[204:219], v[224:227], v[64:71], v4
    s_mov_b64 exec, s[54:55]
    buffer_load_dwordx4 v[220:223], v3, s[8:11], s53 offen offset:1280 sc1
    buffer_load_dwordx4 v[224:227], v3, s[8:11], s53 offen offset:1920 sc1
    s_mov_b64 exec, -1
    v_exp_f32 v42, v42
    v_exp_f32 v43, v43
    v_exp_f32 v44, v44
    v_exp_f32 v45, v45
    v_mfma_f32_32x32x16_bf16 v[56:71], v[242:245], v[78:81], 0
    v_exp_f32 v46, v46
    v_exp_f32 v47, v47
    v_exp_f32 v48, v48
    v_exp_f32 v49, v49
    v_mfma_f32_32x32x8_bf16 v[56:71], v[246:247], v[82:83], v[56:71]
    v_exp_f32 v50, v50
    v_exp_f32 v51, v51
    v_exp_f32 v52, v52
    v_exp_f32 v53, v53
    s_waitcnt vmcnt(12)
    v_smfmac_f32_32x32x32_bf16 v[120:135], v[228:231], v[40:47], v4
    v_exp_f32 v54, v54
    v_exp_f32 v55, v55
    v_exp_f32 v56, v56
    v_exp_f32 v57, v57
    v_smfmac_f32_32x32x32_bf16 v[120:135], v[232:235], v[48:55], v4
    v_exp_f32 v58, v58
    s_add_u32 s53, s53, 2560
    v_exp_f32 v59, v59
    v_exp_f32 v60, v60
    v_exp_f32 v61, v61
    v_mfma_f32_32x32x16_bf16 v[40:55], v[242:245], v[84:87], 0
    s_cmp_eq_u32 s53, s51
    v_exp_f32 v62, v62
    v_exp_f32 v63, v63
    v_exp_f32 v64, v64
    s_cselect_b32 s53, s50, s53
    v_exp_f32 v65, v65
    v_mfma_f32_32x32x8_bf16 v[40:55], v[246:247], v[88:89], v[40:55]
    v_exp_f32 v66, v66
    v_exp_f32 v67, v67
    v_exp_f32 v68, v68
    v_exp_f32 v69, v69
    v_smfmac_f32_32x32x32_bf16 v[132:147], v[228:231], v[56:63], v4
    v_exp_f32 v70, v70
    v_exp_f32 v71, v71
    v_exp_f32 v40, v40
    v_exp_f32 v41, v41
    v_smfmac_f32_32x32x32_bf16 v[132:147], v[232:235], v[64:71], v4
    v_exp_f32 v42, v42
    v_exp_f32 v43, v43
    v_exp_f32 v44, v44
    v_exp_f32 v45, v45
    v_mfma_f32_32x32x16_bf16 v[56:71], v[242:245], v[90:93], 0
    v_exp_f32 v46, v46
    v_exp_f32 v47, v47
    v_exp_f32 v48, v48
    v_exp_f32 v49, v49
    v_mfma_f32_32x32x8_bf16 v[56:71], v[246:247], v[94:95], v[56:71]
    v_exp_f32 v50, v50
    v_exp_f32 v51, v51
    v_exp_f32 v52, v52
    v_exp_f32 v53, v53
    v_smfmac_f32_32x32x32_bf16 v[144:159], v[228:231], v[40:47], v4
    v_exp_f32 v54, v54
    v_exp_f32 v55, v55
    v_exp_f32 v56, v56
    v_exp_f32 v57, v57
    v_smfmac_f32_32x32x32_bf16 v[144:159], v[232:235], v[48:55], v4
    v_exp_f32 v58, v58
    v_exp_f32 v59, v59
    v_exp_f32 v60, v60
    v_exp_f32 v61, v61
    v_mfma_f32_32x32x16_bf16 v[40:55], v[242:245], v[96:99], 0
    v_exp_f32 v62, v62
    v_exp_f32 v63, v63
    v_exp_f32 v64, v64
    v_exp_f32 v65, v65
    v_mfma_f32_32x32x8_bf16 v[40:55], v[246:247], v[100:101], v[40:55]
    v_exp_f32 v66, v66
    v_exp_f32 v67, v67
    v_exp_f32 v68, v68
    v_exp_f32 v69, v69
    v_smfmac_f32_32x32x32_bf16 v[156:171], v[228:231], v[56:63], v4
    v_exp_f32 v70, v70
    v_exp_f32 v71, v71
    v_exp_f32 v40, v40
    v_exp_f32 v41, v41
    v_smfmac_f32_32x32x32_bf16 v[156:171], v[232:235], v[64:71], v4
    v_exp_f32 v42, v42
    v_exp_f32 v43, v43
    v_exp_f32 v44, v44
    v_exp_f32 v45, v45
    v_mfma_f32_32x32x16_bf16 v[56:71], v[242:245], v[102:105], 0
    v_exp_f32 v46, v46
    v_exp_f32 v47, v47
    v_exp_f32 v48, v48
    v_exp_f32 v49, v49
    v_mfma_f32_32x32x8_bf16 v[56:71], v[246:247], v[106:107], v[56:71]
    v_exp_f32 v50, v50
    v_exp_f32 v51, v51
    v_exp_f32 v52, v52
    v_exp_f32 v53, v53
    v_smfmac_f32_32x32x32_bf16 v[168:183], v[228:231], v[40:47], v4
    v_exp_f32 v54, v54
    v_exp_f32 v55, v55
    v_exp_f32 v56, v56
    v_exp_f32 v57, v57
    v_smfmac_f32_32x32x32_bf16 v[168:183], v[232:235], v[48:55], v4
    v_exp_f32 v58, v58
    v_exp_f32 v59, v59
    v_exp_f32 v60, v60
    v_exp_f32 v61, v61
    v_mfma_f32_32x32x16_bf16 v[40:55], v[242:245], v[108:111], 0
    v_exp_f32 v62, v62
    v_exp_f32 v63, v63
    v_exp_f32 v64, v64
    v_exp_f32 v65, v65
    v_mfma_f32_32x32x8_bf16 v[40:55], v[246:247], v[112:113], v[40:55]
    v_exp_f32 v66, v66
    v_exp_f32 v67, v67
    v_exp_f32 v68, v68
    v_exp_f32 v69, v69
    v_smfmac_f32_32x32x32_bf16 v[180:195], v[228:231], v[56:63], v4
    v_exp_f32 v70, v70
    v_exp_f32 v71, v71
    v_exp_f32 v40, v40
    v_exp_f32 v41, v41
    v_smfmac_f32_32x32x32_bf16 v[180:195], v[232:235], v[64:71], v4
    v_exp_f32 v42, v42
    v_exp_f32 v43, v43
    v_exp_f32 v44, v44
    v_exp_f32 v45, v45
    v_mfma_f32_32x32x16_bf16 v[56:71], v[242:245], v[114:117], 0
    v_exp_f32 v46, v46
    v_exp_f32 v47, v47
    v_exp_f32 v48, v48
    v_exp_f32 v49, v49
    v_mfma_f32_32x32x8_bf16 v[56:71], v[246:247], v[118:119], v[56:71]
    v_exp_f32 v50, v50
    v_exp_f32 v51, v51
    v_exp_f32 v52, v52
    v_exp_f32 v53, v53
    v_smfmac_f32_32x32x32_bf16 v[192:207], v[228:231], v[40:47], v4
    v_exp_f32 v54, v54
    v_exp_f32 v55, v55
    buffer_load_dwordx4 v[242:245], v1, s[8:11], s52 offen sc1
    s_mov_b32 exec_hi, 0
    buffer_load_dwordx2 v[246:247], v2, s[8:11], s52 offen offset:1024 sc1
    s_mov_b32 exec_hi, -1
    v_exp_f32 v56, v56
    v_exp_f32 v57, v57
    v_smfmac_f32_32x32x32_bf16 v[192:207], v[232:235], v[48:55], v4
    v_exp_f32 v58, v58
    s_add_u32 s52, s52, 2560
    v_exp_f32 v59, v59
    v_exp_f32 v60, v60
    v_exp_f32 v61, v61
    s_waitcnt vmcnt(12)
    v_mfma_f32_32x32x16_bf16 v[40:55], v[12:15], v[72:75], 0
    s_cmp_eq_u32 s52, s51
    v_exp_f32 v62, v62
    v_exp_f32 v63, v63
    v_exp_f32 v64, v64
    s_cselect_b32 s52, s50, s52
    v_exp_f32 v65, v65
    v_mfma_f32_32x32x8_bf16 v[40:55], v[16:17], v[76:77], v[40:55]
    v_exp_f32 v66, v66
    v_exp_f32 v67, v67
    v_exp_f32 v68, v68
    v_exp_f32 v69, v69
    v_smfmac_f32_32x32x32_bf16 v[204:219], v[228:231], v[56:63], v4
    s_sub_u32 s47, s47, 1
    v_exp_f32 v70, v70
    s_cmp_lg_u32 s47, 0
    v_exp_f32 v71, v71
    s_cbranch_scc1 A_loop
    v_exp_f32 v40, v40
    v_exp_f32 v41, v41
    v_smfmac_f32_32x32x32_bf16 v[204:219], v[232:235], v[64:71], v4
    s_mov_b64 exec, s[54:55]
    buffer_load_dwordx4 v[228:231], v3, s[8:11], s53 offen offset:1280 sc1
    buffer_load_dwordx4 v[232:235], v3, s[8:11], s53 offen offset:1920 sc1
    s_mov_b64 exec, -1
    v_exp_f32 v42, v42
    v_exp_f32 v43, v43
    v_exp_f32 v44, v44
    v_exp_f32 v45, v45
    v_mfma_f32_32x32x16_bf16 v[56:71], v[12:15], v[78:81], 0
    v_exp_f32 v46, v46
    v_exp_f32 v47, v47
    v_exp_f32 v48, v48
    v_exp_f32 v49, v49
    v_mfma_f32_32x32x8_bf16 v[56:71], v[16:17], v[82:83], v[56:71]
    v_exp_f32 v50, v50
    v_exp_f32 v51, v51
    v_exp_f32 v52, v52
    v_exp_f32 v53, v53
    s_waitcnt vmcnt(12)
    v_smfmac_f32_32x32x32_bf16 v[120:135], v[24:27], v[40:47], v4
    v_exp_f32 v54, v54
    v_exp_f32 v55, v55
    v_exp_f32 v56, v56
    v_exp_f32 v57, v57
    v_smfmac_f32_32x32x32_bf16 v[120:135], v[28:31], v[48:55], v4
    v_exp_f32 v58, v58
    s_add_u32 s53, s53, 2560
    v_exp_f32 v59, v59
    v_exp_f32 v60, v60
    v_exp_f32 v61, v61
    v_mfma_f32_32x32x16_bf16 v[40:55], v[12:15], v[84:87], 0
    s_cmp_eq_u32 s53, s51
    v_exp_f32 v62, v62
    v_exp_f32 v63, v63
    v_exp_f32 v64, v64
    s_cselect_b32 s53, s50, s53
    v_exp_f32 v65, v65
    v_mfma_f32_32x32x8_bf16 v[40:55], v[16:17], v[88:89], v[40:55]
    v_exp_f32 v66, v66
    v_exp_f32 v67, v67
    v_exp_f32 v68, v68
    v_exp_f32 v69, v69
    v_smfmac_f32_32x32x32_bf16 v[132:147], v[24:27], v[56:63], v4
    v_exp_f32 v70, v70
    v_exp_f32 v71, v71
    v_exp_f32 v40, v40
    v_exp_f32 v41, v41
    v_smfmac_f32_32x32x32_bf16 v[132:147], v[28:31], v[64:71], v4
    v_exp_f32 v42, v42
    v_exp_f32 v43, v43
    v_exp_f32 v44, v44
    v_exp_f32 v45, v45
    v_mfma_f32_32x32x16_bf16 v[56:71], v[12:15], v[90:93], 0
    v_exp_f32 v46, v46
    v_exp_f32 v47, v47
    v_exp_f32 v48, v48
    v_exp_f32 v49, v49
    v_mfma_f32_32x32x8_bf16 v[56:71], v[16:17], v[94:95], v[56:71]
    v_exp_f32 v50, v50
    v_exp_f32 v51, v51
    v_exp_f32 v52, v52
    v_exp_f32 v53, v53
    v_smfmac_f32_32x32x32_bf16 v[144:159], v[24:27], v[40:47], v4
    v_exp_f32 v54, v54
    v_exp_f32 v55, v55
    v_exp_f32 v56, v56
    v_exp_f32 v57, v57
    v_smfmac_f32_32x32x32_bf16 v[144:159], v[28:31], v[48:55], v4
    v_exp_f32 v58, v58
    v_exp_f32 v59, v59
    v_exp_f32 v60, v60
    v_exp_f32 v61, v61
    v_mfma_f32_32x32x16_bf16 v[40:55], v[12:15], v[96:99], 0
    v_exp_f32 v62, v62
    v_exp_f32 v63, v63
    v_exp_f32 v64, v64
    v_exp_f32 v65, v65
    v_mfma_f32_32x32x8_bf16 v[40:55], v[16:17], v[100:101], v[40:55]
    v_exp_f32 v66, v66
    v_exp_f32 v67, v67
    v_exp_f32 v68, v68
    v_exp_f32 v69, v69
    v_smfmac_f32_32x32x32_bf16 v[156:171], v[24:27], v[56:63], v4
    v_exp_f32 v70, v70
    v_exp_f32 v71, v71
    v_exp_f32 v40, v40
    v_exp_f32 v41, v41
    v_smfmac_f32_32x32x32_bf16 v[156:171], v[28:31], v[64:71], v4
    v_exp_f32 v42, v42
    v_exp_f32 v43, v43
    v_exp_f32 v44, v44
    v_exp_f32 v45, v45
    v_mfma_f32_32x32x16_bf16 v[56:71], v[12:15], v[102:105], 0
    v_exp_f32 v46, v46
    v_exp_f32 v47, v47
    v_exp_f32 v48, v48
    v_exp_f32 v49, v49
    v_mfma_f32_32x32x8_bf16 v[56:71], v[16:17], v[106:107], v[56:71]
    v_exp_f32 v50, v50
    v_exp_f32 v51, v51
    v_exp_f32 v52, v52
    v_exp_f32 v53, v53
    v_smfmac_f32_32x32x32_bf16 v[168:183], v[24:27], v[40:47], v4
    v_exp_f32 v54, v54
    v_exp_f32 v55, v55
    v_exp_f32 v56, v56
    v_exp_f32 v57, v57
    v_smfmac_f32_32x32x32_bf16 v[168:183], v[28:31], v[48:55], v4
    v_exp_f32 v58, v58
    v_exp_f32 v59, v59
    v_exp_f32 v60, v60
    v_exp_f32 v61, v61
    v_mfma_f32_32x32x16_bf16 v[40:55], v[12:15], v[108:111], 0
    v_exp_f32 v62, v62
    v_exp_f32 v63, v63
    v_exp_f32 v64, v64
    v_exp_f32 v65, v65
    v_mfma_f32_32x32x8_bf16 v[40:55], v[16:17], v[112:113], v[40:55]
    v_exp_f32 v66, v66
    v_exp_f32 v67, v67
    v_exp_f32 v68, v68
    v_exp_f32 v69, v69
    v_smfmac_f32_32x32x32_bf16 v[180:195], v[24:27], v[56:63], v4
    v_exp_f32 v70, v70
    v_exp_f32 v71, v71
    v_exp_f32 v40, v40
    v_exp_f32 v41, v41
    v_smfmac_f32_32x32x32_bf16 v[180:195], v[28:31], v[64:71], v4
    v_exp_f32 v42, v42
    v_exp_f32 v43, v43
    v_exp_f32 v44, v44
    v_exp_f32 v45, v45
    v_mfma_f32_32x32x16_bf16 v[56:71], v[12:15], v[114:117], 0
    v_exp_f32 v46, v46
    v_exp_f32 v47, v47
    v_exp_f32 v48, v48
    v_exp_f32 v49, v49
    v_mfma_f32_32x32x8_bf16 v[56:71], v[16:17], v[118:119], v[56:71]
    v_exp_f32 v50, v50
    v_exp_f32 v51, v51
    v_exp_f32 v52, v52
    v_exp_f32 v53, v53
    v_smfmac_f32_32x32x32_bf16 v[192:207], v[24:27], v[40:47], v4
    v_exp_f32 v54, v54
    v_exp_f32 v55, v55
    v_exp_f32 v56, v56
    v_exp_f32 v57, v57
    v_smfmac_f32_32x32x32_bf16 v[192:207], v[28:31], v[48:55], v4
    v_exp_f32 v58, v58
    v_exp_f32 v59, v59
    v_exp_f32 v60, v60
    v_exp_f32 v61, v61
    s_waitcnt vmcnt(10)
    v_mfma_f32_32x32x16_bf16 v[40:55], v[18:21], v[72:75], 0
    v_exp_f32 v62, v62
    v_exp_f32 v63, v63
    v_exp_f32 v64, v64
    v_exp_f32 v65, v65
    v_mfma_f32_32x32x8_bf16 v[40:55], v[22:23], v[76:77], v[40:55]
    v_exp_f32 v66, v66
    v_exp_f32 v67, v67
    v_exp_f32 v68, v68
    v_exp_f32 v69, v69
    v_smfmac_f32_32x32x32_bf16 v[204:219], v[24:27], v[56:63], v4
    v_exp_f32 v70, v70
    v_exp_f32 v71, v71
    v_exp_f32 v40, v40
    v_exp_f32 v41, v41
    v_smfmac_f32_32x32x32_bf16 v[204:219], v[28:31], v[64:71], v4
    v_exp_f32 v42, v42
    v_exp_f32 v43, v43
    v_exp_f32 v44, v44
    v_exp_f32 v45, v45
    v_mfma_f32_32x32x16_bf16 v[56:71], v[18:21], v[78:81], 0
    v_exp_f32 v46, v46
    v_exp_f32 v47, v47
    v_exp_f32 v48, v48
    v_exp_f32 v49, v49
    v_mfma_f32_32x32x8_bf16 v[56:71], v[22:23], v[82:83], v[56:71]
    v_exp_f32 v50, v50
    v_exp_f32 v51, v51
    v_exp_f32 v52, v52
    v_exp_f32 v53, v53
    s_waitcnt vmcnt(8)
    v_smfmac_f32_32x32x32_bf16 v[120:135], v[32:35], v[40:47], v4
    v_exp_f32 v54, v54
    v_exp_f32 v55, v55
    v_exp_f32 v56, v56
    v_exp_f32 v57, v57
    v_smfmac_f32_32x32x32_bf16 v[120:135], v[36:39], v[48:55], v4
    v_exp_f32 v58, v58
    v_exp_f32 v59, v59
    v_exp_f32 v60, v60
    v_exp_f32 v61, v61
    v_mfma_f32_32x32x16_bf16 v[40:55], v[18:21], v[84:87], 0
    v_exp_f32 v62, v62
    v_exp_f32 v63, v63
    v_exp_f32 v64, v64
    v_exp_f32 v65, v65
    v_mfma_f32_32x32x8_bf16 v[40:55], v[22:23], v[88:89], v[40:55]
    v_exp_f32 v66, v66
    v_exp_f32 v67, v67
    v_exp_f32 v68, v68
    v_exp_f32 v69, v69
    v_smfmac_f32_32x32x32_bf16 v[132:147], v[32:35], v[56:63], v4
    v_exp_f32 v70, v70
    v_exp_f32 v71, v71
    v_exp_f32 v40, v40
    v_exp_f32 v41, v41
    v_smfmac_f32_32x32x32_bf16 v[132:147], v[36:39], v[64:71], v4
    v_exp_f32 v42, v42
    v_exp_f32 v43, v43
    v_exp_f32 v44, v44
    v_exp_f32 v45, v45
    v_mfma_f32_32x32x16_bf16 v[56:71], v[18:21], v[90:93], 0
    v_exp_f32 v46, v46
    v_exp_f32 v47, v47
    v_exp_f32 v48, v48
    v_exp_f32 v49, v49
    v_mfma_f32_32x32x8_bf16 v[56:71], v[22:23], v[94:95], v[56:71]
    v_exp_f32 v50, v50
    v_exp_f32 v51, v51
    v_exp_f32 v52, v52
    v_exp_f32 v53, v53
    v_smfmac_f32_32x32x32_bf16 v[144:159], v[32:35], v[40:47], v4
    v_exp_f32 v54, v54
    v_exp_f32 v55, v55
    v_exp_f32 v56, v56
    v_exp_f32 v57, v57
    v_smfmac_f32_32x32x32_bf16 v[144:159], v[36:39], v[48:55], v4
    v_exp_f32 v58, v58
    v_exp_f32 v59, v59
    v_exp_f32 v60, v60
    v_exp_f32 v61, v61
    v_mfma_f32_32x32x16_bf16 v[40:55], v[18:21], v[96:99], 0
    v_exp_f32 v62, v62
    v_exp_f32 v63, v63
    v_exp_f32 v64, v64
    v_exp_f32 v65, v65
    v_mfma_f32_32x32x8_bf16 v[40:55], v[22:23], v[100:101], v[40:55]
    v_exp_f32 v66, v66
    v_exp_f32 v67, v67
    v_exp_f32 v68, v68
    v_exp_f32 v69, v69
    v_smfmac_f32_32x32x32_bf16 v[156:171], v[32:35], v[56:63], v4
    v_exp_f32 v70, v70
    v_exp_f32 v71, v71
    v_exp_f32 v40, v40
    v_exp_f32 v41, v41
    v_smfmac_f32_32x32x32_bf16 v[156:171], v[36:39], v[64:71], v4
    v_exp_f32 v42, v42
    v_exp_f32 v43, v43
    v_exp_f32 v44, v44
    v_exp_f32 v45, v45
    v_mfma_f32_32x32x16_bf16 v[56:71], v[18:21], v[102:105], 0
    v_exp_f32 v46, v46
    v_exp_f32 v47, v47
    v_exp_f32 v48, v48
    v_exp_f32 v49, v49
    v_mfma_f32_32x32x8_bf16 v[56:71], v[22:23], v[106:107], v[56:71]
    v_exp_f32 v50, v50
    v_exp_f32 v51, v51
    v_exp_f32 v52, v52
    v_exp_f32 v53, v53
    v_smfmac_f32_32x32x32_bf16 v[168:183], v[32:35], v[40:47], v4
    v_exp_f32 v54, v54
    v_exp_f32 v55, v55
    v_exp_f32 v56, v56
    v_exp_f32 v57, v57
    v_smfmac_f32_32x32x32_bf16 v[168:183], v[36:39], v[48:55], v4
    v_exp_f32 v58, v58
    v_exp_f32 v59, v59
    v_exp_f32 v60, v60
    v_exp_f32 v61, v61
    v_mfma_f32_32x32x16_bf16 v[40:55], v[18:21], v[108:111], 0
    v_exp_f32 v62, v62
    v_exp_f32 v63, v63
    v_exp_f32 v64, v64
    v_exp_f32 v65, v65
    v_mfma_f32_32x32x8_bf16 v[40:55], v[22:23], v[112:113], v[40:55]
    v_exp_f32 v66, v66
    v_exp_f32 v67, v67
    v_exp_f32 v68, v68
    v_exp_f32 v69, v69
    v_smfmac_f32_32x32x32_bf16 v[180:195], v[32:35], v[56:63], v4
    v_exp_f32 v70, v70
    v_exp_f32 v71, v71
    v_exp_f32 v40, v40
    v_exp_f32 v41, v41
    v_smfmac_f32_32x32x32_bf16 v[180:195], v[36:39], v[64:71], v4
    v_exp_f32 v42, v42
    v_exp_f32 v43, v43
    v_exp_f32 v44, v44
    v_exp_f32 v45, v45
    v_mfma_f32_32x32x16_bf16 v[56:71], v[18:21], v[114:117], 0
    v_exp_f32 v46, v46
    v_exp_f32 v47, v47
    v_exp_f32 v48, v48
    v_exp_f32 v49, v49
    v_mfma_f32_32x32x8_bf16 v[56:71], v[22:23], v[118:119], v[56:71]
    v_exp_f32 v50, v50
    v_exp_f32 v51, v51
    v_exp_f32 v52, v52
    v_exp_f32 v53, v53
    v_smfmac_f32_32x32x32_bf16 v[192:207], v[32:35], v[40:47], v4
    v_exp_f32 v54, v54
    v_exp_f32 v55, v55
    v_exp_f32 v56, v56
    v_exp_f32 v57, v57
    v_smfmac_f32_32x32x32_bf16 v[192:207], v[36:39], v[48:55], v4
    v_exp_f32 v58, v58
    v_exp_f32 v59, v59
    v_exp_f32 v60, v60
    v_exp_f32 v61, v61
    s_waitcnt vmcnt(6)
    v_mfma_f32_32x32x16_bf16 v[40:55], v[236:239], v[72:75], 0
    v_exp_f32 v62, v62
    v_exp_f32 v63, v63
    v_exp_f32 v64, v64
    v_exp_f32 v65, v65
    v_mfma_f32_32x32x8_bf16 v[40:55], v[240:241], v[76:77], v[40:55]
    v_exp_f32 v66, v66
    v_exp_f32 v67, v67
    v_exp_f32 v68, v68
    v_exp_f32 v69, v69
    v_smfmac_f32_32x32x32_bf16 v[204:219], v[32:35], v[56:63], v4
    v_exp_f32 v70, v70
    v_exp_f32 v71, v71
    v_exp_f32 v40, v40
    v_exp_f32 v41, v41
    v_smfmac_f32_32x32x32_bf16 v[204:219], v[36:39], v[64:71], v4
    v_exp_f32 v42, v42
    v_exp_f32 v43, v43
    v_exp_f32 v44, v44
    v_exp_f32 v45, v45
    v_mfma_f32_32x32x16_bf16 v[56:71], v[236:239], v[78:81], 0
    v_exp_f32 v46, v46
    v_exp_f32 v47, v47
    v_exp_f32 v48, v48
    v_exp_f32 v49, v49
    v_mfma_f32_32x32x8_bf16 v[56:71], v[240:241], v[82:83], v[56:71]
    v_exp_f32 v50, v50
    v_exp_f32 v51, v51
    v_exp_f32 v52, v52
    v_exp_f32 v53, v53
    s_waitcnt vmcnt(4)
    v_smfmac_f32_32x32x32_bf16 v[120:135], v[220:223], v[40:47], v4
    v_exp_f32 v54, v54
    v_exp_f32 v55, v55
    v_exp_f32 v56, v56
    v_exp_f32 v57, v57
    v_smfmac_f32_32x32x32_bf16 v[120:135], v[224:227], v[48:55], v4
    v_exp_f32 v58, v58
    v_exp_f32 v59, v59
    v_exp_f32 v60, v60
    v_exp_f32 v61, v61
    v_mfma_f32_32x32x16_bf16 v[40:55], v[236:239], v[84:87], 0
    v_exp_f32 v62, v62
    v_exp_f32 v63, v63
    v_exp_f32 v64, v64
    v_exp_f32 v65, v65
    v_mfma_f32_32x32x8_bf16 v[40:55], v[240:241], v[88:89], v[40:55]
    v_exp_f32 v66, v66
    v_exp_f32 v67, v67
    v_exp_f32 v68, v68
    v_exp_f32 v69, v69
    v_smfmac_f32_32x32x32_bf16 v[132:147], v[220:223], v[56:63], v4
    v_exp_f32 v70, v70
    v_exp_f32 v71, v71
    v_exp_f32 v40, v40
    v_exp_f32 v41, v41
    v_smfmac_f32_32x32x32_bf16 v[132:147], v[224:227], v[64:71], v4
    v_exp_f32 v42, v42
    v_exp_f32 v43, v43
    v_exp_f32 v44, v44
    v_exp_f32 v45, v45
    v_mfma_f32_32x32x16_bf16 v[56:71], v[236:239], v[90:93], 0
    v_exp_f32 v46, v46
    v_exp_f32 v47, v47
    v_exp_f32 v48, v48
    v_exp_f32 v49, v49
    v_mfma_f32_32x32x8_bf16 v[56:71], v[240:241], v[94:95], v[56:71]
    v_exp_f32 v50, v50
    v_exp_f32 v51, v51
    v_exp_f32 v52, v52
    v_exp_f32 v53, v53
    v_smfmac_f32_32x32x32_bf16 v[144:159], v[220:223], v[40:47], v4
    v_exp_f32 v54, v54
    v_exp_f32 v55, v55
    v_exp_f32 v56, v56
    v_exp_f32 v57, v57
    v_smfmac_f32_32x32x32_bf16 v[144:159], v[224:227], v[48:55], v4
    v_exp_f32 v58, v58
    v_exp_f32 v59, v59
    v_exp_f32 v60, v60
    v_exp_f32 v61, v61
    v_mfma_f32_32x32x16_bf16 v[40:55], v[236:239], v[96:99], 0
    v_exp_f32 v62, v62
    v_exp_f32 v63, v63
    v_exp_f32 v64, v64
    v_exp_f32 v65, v65
    v_mfma_f32_32x32x8_bf16 v[40:55], v[240:241], v[100:101], v[40:55]
    v_exp_f32 v66, v66
    v_exp_f32 v67, v67
    v_exp_f32 v68, v68
    v_exp_f32 v69, v69
    v_smfmac_f32_32x32x32_bf16 v[156:171], v[220:223], v[56:63], v4
    v_exp_f32 v70, v70
    v_exp_f32 v71, v71
    v_exp_f32 v40, v40
    v_exp_f32 v41, v41
    v_smfmac_f32_32x32x32_bf16 v[156:171], v[224:227], v[64:71], v4
    v_exp_f32 v42, v42
    v_exp_f32 v43, v43
    v_exp_f32 v44, v44
    v_exp_f32 v45, v45
    v_mfma_f32_32x32x16_bf16 v[56:71], v[236:239], v[102:105], 0
    v_exp_f32 v46, v46
    v_exp_f32 v47, v47
    v_exp_f32 v48, v48
    v_exp_f32 v49, v49
    v_mfma_f32_32x32x8_bf16 v[56:71], v[240:241], v[106:107], v[56:71]
    v_exp_f32 v50, v50
    v_exp_f32 v51, v51
    v_exp_f32 v52, v52
    v_exp_f32 v53, v53
    v_smfmac_f32_32x32x32_bf16 v[168:183], v[220:223], v[40:47], v4
    v_exp_f32 v54, v54
    v_exp_f32 v55, v55
    v_exp_f32 v56, v56
    v_exp_f32 v57, v57
    v_smfmac_f32_32x32x32_bf16 v[168:183], v[224:227], v[48:55], v4
    v_exp_f32 v58, v58
    v_exp_f32 v59, v59
    v_exp_f32 v60, v60
    v_exp_f32 v61, v61
    v_mfma_f32_32x32x16_bf16 v[40:55], v[236:239], v[108:111], 0
    v_exp_f32 v62, v62
    v_exp_f32 v63, v63
    v_exp_f32 v64, v64
    v_exp_f32 v65, v65
    v_mfma_f32_32x32x8_bf16 v[40:55], v[240:241], v[112:113], v[40:55]
    v_exp_f32 v66, v66
    v_exp_f32 v67, v67
    v_exp_f32 v68, v68
    v_exp_f32 v69, v69
    v_smfmac_f32_32x32x32_bf16 v[180:195], v[220:223], v[56:63], v4
    v_exp_f32 v70, v70
    v_exp_f32 v71, v71
    v_exp_f32 v40, v40
    v_exp_f32 v41, v41
    v_smfmac_f32_32x32x32_bf16 v[180:195], v[224:227], v[64:71], v4
    v_exp_f32 v42, v42
    v_exp_f32 v43, v43
    v_exp_f32 v44, v44
    v_exp_f32 v45, v45
    v_mfma_f32_32x32x16_bf16 v[56:71], v[236:239], v[114:117], 0
    v_exp_f32 v46, v46
    v_exp_f32 v47, v47
    v_exp_f32 v48, v48
    v_exp_f32 v49, v49
    v_mfma_f32_32x32x8_bf16 v[56:71], v[240:241], v[118:119], v[56:71]
    v_exp_f32 v50, v50
    v_exp_f32 v51, v51
    v_exp_f32 v52, v52
    v_exp_f32 v53, v53
    v_smfmac_f32_32x32x32_bf16 v[192:207], v[220:223], v[40:47], v4
    v_exp_f32 v54, v54
    v_exp_f32 v55, v55
    v_exp_f32 v56, v56
    v_exp_f32 v57, v57
    v_smfmac_f32_32x32x32_bf16 v[192:207], v[224:227], v[48:55], v4
    v_exp_f32 v58, v58
    v_exp_f32 v59, v59
    v_exp_f32 v60, v60
    v_exp_f32 v61, v61
    s_waitcnt vmcnt(2)
    v_mfma_f32_32x32x16_bf16 v[40:55], v[242:245], v[72:75], 0
    v_exp_f32 v62, v62
    v_exp_f32 v63, v63
    v_exp_f32 v64, v64
    v_exp_f32 v65, v65
    v_mfma_f32_32x32x8_bf16 v[40:55], v[246:247], v[76:77], v[40:55]
    v_exp_f32 v66, v66
    v_exp_f32 v67, v67
    v_exp_f32 v68, v68
    v_exp_f32 v69, v69
    v_smfmac_f32_32x32x32_bf16 v[204:219], v[220:223], v[56:63], v4
    v_exp_f32 v70, v70
    v_exp_f32 v71, v71
    v_exp_f32 v40, v40
    ds_read_b32 v6, v249
    v_exp_f32 v41, v41
    v_smfmac_f32_32x32x32_bf16 v[204:219], v[224:227], v[64:71], v4
    v_exp_f32 v42, v42
    v_exp_f32 v43, v43
    v_exp_f32 v44, v44
    v_exp_f32 v45, v45
    v_mfma_f32_32x32x16_bf16 v[56:71], v[242:245], v[78:81], 0
    v_exp_f32 v46, v46
    v_exp_f32 v47, v47
    v_exp_f32 v48, v48
    v_exp_f32 v49, v49
    v_mfma_f32_32x32x8_bf16 v[56:71], v[246:247], v[82:83], v[56:71]
    v_exp_f32 v50, v50
    v_exp_f32 v51, v51
    v_exp_f32 v52, v52
    v_exp_f32 v53, v53
    s_waitcnt vmcnt(0)
    v_smfmac_f32_32x32x32_bf16 v[120:135], v[228:231], v[40:47], v4
    v_exp_f32 v54, v54
    v_exp_f32 v55, v55
    v_exp_f32 v56, v56
    v_exp_f32 v57, v57
    v_smfmac_f32_32x32x32_bf16 v[120:135], v[232:235], v[48:55], v4
    v_exp_f32 v58, v58
    v_exp_f32 v59, v59
    v_exp_f32 v60, v60
    v_exp_f32 v61, v61
    v_mfma_f32_32x32x16_bf16 v[40:55], v[242:245], v[84:87], 0
    v_exp_f32 v62, v62
    s_waitcnt lgkmcnt(0)
    v_cmp_gt_u32 vcc, 9, v6
    v_exp_f32 v63, v63
    v_exp_f32 v64, v64
    s_cbranch_vccnz A_pre
A_preb:
    v_exp_f32 v65, v65
    v_mfma_f32_32x32x8_bf16 v[40:55], v[246:247], v[88:89], v[40:55]
    v_exp_f32 v66, v66
    ds_write_b128 v248, v[120:123] offset:0
    v_exp_f32 v67, v67
    v_exp_f32 v68, v68
    ds_write_b128 v248, v[124:127] offset:1024
    v_exp_f32 v69, v69
    v_smfmac_f32_32x32x32_bf16 v[132:147], v[228:231], v[56:63], v4
    v_exp_f32 v70, v70
    ds_write_b128 v248, v[128:131] offset:2048
    v_exp_f32 v71, v71
    v_exp_f32 v40, v40
    v_exp_f32 v41, v41
    v_smfmac_f32_32x32x32_bf16 v[132:147], v[232:235], v[64:71], v4
    v_exp_f32 v42, v42
    v_exp_f32 v43, v43
    v_exp_f32 v44, v44
    v_exp_f32 v45, v45
    v_mfma_f32_32x32x16_bf16 v[56:71], v[242:245], v[90:93], 0
    v_exp_f32 v46, v46
    v_exp_f32 v47, v47
    v_exp_f32 v48, v48
    v_exp_f32 v49, v49
    v_mfma_f32_32x32x8_bf16 v[56:71], v[246:247], v[94:95], v[56:71]
    v_exp_f32 v50, v50
    ds_write_b128 v248, v[132:135] offset:3072
    v_exp_f32 v51, v51
    v_exp_f32 v52, v52
    ds_write_b128 v248, v[136:139] offset:4096
    v_exp_f32 v53, v53
    v_smfmac_f32_32x32x32_bf16 v[144:159], v[228:231], v[40:47], v4
    v_exp_f32 v54, v54
    ds_write_b128 v248, v[140:143] offset:5120
    v_exp_f32 v55, v55
    v_exp_f32 v56, v56
    v_exp_f32 v57, v57
    v_smfmac_f32_32x32x32_bf16 v[144:159], v[232:235], v[48:55], v4
    v_exp_f32 v58, v58
    v_exp_f32 v59, v59
    v_exp_f32 v60, v60
    v_exp_f32 v61, v61
    v_mfma_f32_32x32x16_bf16 v[40:55], v[242:245], v[96:99], 0
    v_exp_f32 v62, v62
    v_exp_f32 v63, v63
    v_exp_f32 v64, v64
    v_exp_f32 v65, v65
    v_mfma_f32_32x32x8_bf16 v[40:55], v[246:247], v[100:101], v[40:55]
    v_exp_f32 v66, v66
    ds_write_b128 v248, v[144:147] offset:6144
    v_exp_f32 v67, v67
    v_exp_f32 v68, v68
    ds_write_b128 v248, v[148:151] offset:7168
    v_exp_f32 v69, v69
    v_smfmac_f32_32x32x32_bf16 v[156:171], v[228:231], v[56:63], v4
    v_exp_f32 v70, v70
    ds_write_b128 v248, v[152:155] offset:8192
    v_exp_f32 v71, v71
    v_exp_f32 v40, v40
    v_exp_f32 v41, v41
    v_smfmac_f32_32x32x32_bf16 v[156:171], v[232:235], v[64:71], v4
    v_exp_f32 v42, v42
    v_exp_f32 v43, v43
    v_exp_f32 v44, v44
    v_exp_f32 v45, v45
    v_mfma_f32_32x32x16_bf16 v[56:71], v[242:245], v[102:105], 0
    v_exp_f32 v46, v46
    v_exp_f32 v47, v47
    v_exp_f32 v48, v48
    v_exp_f32 v49, v49
    v_mfma_f32_32x32x8_bf16 v[56:71], v[246:247], v[106:107], v[56:71]
    v_exp_f32 v50, v50
    ds_write_b128 v248, v[156:159] offset:9216
    v_exp_f32 v51, v51
    v_exp_f32 v52, v52
    ds_write_b128 v248, v[160:163] offset:10240
    v_exp_f32 v53, v53
    v_smfmac_f32_32x32x32_bf16 v[168:183], v[228:231], v[40:47], v4
    v_exp_f32 v54, v54
    ds_write_b128 v248, v[164:167] offset:11264
    v_exp_f32 v55, v55
    v_exp_f32 v56, v56
    v_exp_f32 v57, v57
    v_smfmac_f32_32x32x32_bf16 v[168:183], v[232:235], v[48:55], v4
    v_exp_f32 v58, v58
    v_exp_f32 v59, v59
    v_exp_f32 v60, v60
    v_exp_f32 v61, v61
    v_mfma_f32_32x32x16_bf16 v[40:55], v[242:245], v[108:111], 0
    v_exp_f32 v62, v62
    v_exp_f32 v63, v63
    v_exp_f32 v64, v64
    v_exp_f32 v65, v65
    v_mfma_f32_32x32x8_bf16 v[40:55], v[246:247], v[112:113], v[40:55]
    v_exp_f32 v66, v66
    ds_write_b128 v248, v[168:171] offset:12288
    v_exp_f32 v67, v67
    v_exp_f32 v68, v68
    ds_write_b128 v248, v[172:175] offset:13312
    v_exp_f32 v69, v69
    v_smfmac_f32_32x32x32_bf16 v[180:195], v[228:231], v[56:63], v4
    v_exp_f32 v70, v70
    ds_write_b128 v248, v[176:179] offset:14336
    v_exp_f32 v71, v71
    v_exp_f32 v40, v40
    v_exp_f32 v41, v41
    v_smfmac_f32_32x32x32_bf16 v[180:195], v[232:235], v[64:71], v4
    v_exp_f32 v42, v42
    v_exp_f32 v43, v43
    v_exp_f32 v44, v44
    v_exp_f32 v45, v45
    v_mfma_f32_32x32x16_bf16 v[56:71], v[242:245], v[114:117], 0
    v_exp_f32 v46, v46
    v_exp_f32 v47, v47
    v_exp_f32 v48, v48
    v_exp_f32 v49, v49
    v_mfma_f32_32x32x8_bf16 v[56:71], v[246:247], v[118:119], v[56:71]
    v_exp_f32 v50, v50
    ds_write_b128 v248, v[180:183] offset:15360
    v_exp_f32 v51, v51
    v_exp_f32 v52, v52
    ds_write_b128 v248, v[184:187] offset:16384
    v_exp_f32 v53, v53
    v_smfmac_f32_32x32x32_bf16 v[192:207], v[228:231], v[40:47], v4
    v_exp_f32 v54, v54
    ds_write_b128 v248, v[188:191] offset:17408
    v_mov_b32 v6, 8
    s_mov_b64 exec, 1
    ds_write_b32 v254, v6 offset:0
    s_mov_b64 exec, -1
    v_exp_f32 v55, v55
    v_exp_f32 v56, v56
    v_exp_f32 v57, v57
    v_smfmac_f32_32x32x32_bf16 v[192:207], v[232:235], v[48:55], v4
    v_exp_f32 v58, v58
    v_exp_f32 v59, v59
    v_exp_f32 v60, v60
    v_exp_f32 v61, v61
    v_exp_f32 v62, v62
    v_exp_f32 v63, v63
    v_exp_f32 v64, v64
    v_exp_f32 v65, v65
    v_exp_f32 v66, v66
    v_exp_f32 v67, v67
    v_exp_f32 v68, v68
    v_exp_f32 v69, v69
    v_smfmac_f32_32x32x32_bf16 v[204:219], v[228:231], v[56:63], v4
    v_exp_f32 v70, v70
    v_exp_f32 v71, v71
    s_setprio 2
    s_nop 1
    v_smfmac_f32_32x32x32_bf16 v[204:219], v[232:235], v[64:71], v4
    s_mov_b32 s47, 0x40000
sbw_7:
    ds_read_b32 v6, v255 offset:0
    s_sub_u32 s47, s47, 1
    s_waitcnt lgkmcnt(0)
    v_cmp_gt_u32 vcc, 8, v6
    s_cbranch_scc1 sbw_7_x
    s_cbranch_vccnz sbw_7
sbw_7_x:
    ds_read_b128 v[120:123], v251 offset:0
    ds_read_b128 v[124:127], v251 offset:1024
    ds_read_b128 v[128:131], v251 offset:2048
    ds_read_b128 v[132:135], v252 offset:6144
    ds_read_b128 v[136:139], v252 offset:7168
    ds_read_b128 v[140:143], v252 offset:8192
    ds_read_b128 v[144:147], v253 offset:12288
    ds_read_b128 v[148:151], v253 offset:13312
    ds_read_b128 v[152:155], v253 offset:14336
    s_waitcnt lgkmcnt(6)
    v_add_f32 v192, v120, v192
    v_add_f32 v193, v121, v193
    v_add_f32 v194, v122, v194
    v_add_f32 v195, v123, v195
    v_add_f32 v196, v124, v196
    v_add_f32 v197, v125, v197
    v_add_f32 v198, v126, v198
    v_add_f32 v199, v127, v199
    v_add_f32 v200, v128, v200
    v_add_f32 v201, v129, v201
    v_add_f32 v202, v130, v202
    v_add_f32 v203, v131, v203
    s_waitcnt lgkmcnt(3)
    v_add_f32 v192, v132, v192
    v_add_f32 v193, v133, v193
    v_add_f32 v194, v134, v194
    v_add_f32 v195, v135, v195
    v_add_f32 v196, v136, v196
    v_add_f32 v197, v137, v197
    v_add_f32 v198, v138, v198
    v_add_f32 v199, v139, v199
    v_add_f32 v200, v140, v200
    v_add_f32 v201, v141, v201
    v_add_f32 v202, v142, v202
    v_add_f32 v203, v143, v203
    s_waitcnt lgkmcnt(0)
    v_add_f32 v192, v144, v192
    v_add_f32 v193, v145, v193
    v_add_f32 v194, v146, v194
    v_add_f32 v195, v147, v195
    v_add_f32 v196, v148, v196
    v_add_f32 v197, v149, v197
    v_add_f32 v198, v150, v198
    v_add_f32 v199, v151, v199
    v_add_f32 v200, v152, v200
    v_add_f32 v201, v153, v201
    v_add_f32 v202, v154, v202
    v_add_f32 v203, v155, v203
    v_mov_b32 v6, v200
    v_mov_b32 v7, v200
    v_mov_b32 v8, 0x7e800000
    s_nop 0
    v_permlane32_swap_b32 v6, v7
    v_cmp_le_f32 vcc, 0x17800000, v7
    v_cmp_lt_f32 s[60:61], v7, v8
    s_nop 1
    s_and_b64 vcc, vcc, s[60:61]
    s_cmp_eq_u64 vcc, -1
    s_cbranch_scc0 A_0_fb
A_0_fin:
    v_rcp_f32 v8, v7
    s_nop 0
    v_mul_f32 v8, v8, v5
    v_mul_f32 v192, v8, v192
    v_mul_f32 v193, v8, v193
    v_mul_f32 v194, v8, v194
    v_mul_f32 v195, v8, v195
    v_mul_f32 v196, v8, v196
    v_mul_f32 v197, v8, v197
    v_mul_f32 v198, v8, v198
    v_mul_f32 v199, v8, v199
    v_mul_f32 v200, v8, v200
    v_mul_f32 v201, v8, v201
    v_mul_f32 v202, v8, v202
    v_mul_f32 v203, v8, v203
    v_cvt_pk_bf16_f32 v192, v192, v193
    v_cvt_pk_bf16_f32 v193, v194, v195
    v_cvt_pk_bf16_f32 v194, v196, v197
    v_cvt_pk_bf16_f32 v195, v198, v199
    v_cvt_pk_bf16_f32 v196, v200, v201
    v_cvt_pk_bf16_f32 v197, v202, v203
    buffer_store_dwordx4 v[192:195], v1, s[8:11], s56 offen sc1
    s_mov_b32 exec_hi, 0
    buffer_store_dwordx2 v[196:197], v1, s[8:11], s57 offen sc1
    s_mov_b32 exec_hi, -1
    ds_read_b128 v[120:123], v251 offset:3072
    ds_read_b128 v[124:127], v251 offset:4096
    ds_read_b128 v[128:131], v251 offset:5120
    ds_read_b128 v[132:135], v252 offset:9216
    ds_read_b128 v[136:139], v252 offset:10240
    ds_read_b128 v[140:143], v252 offset:11264
    ds_read_b128 v[144:147], v253 offset:15360
    ds_read_b128 v[148:151], v253 offset:16384
    ds_read_b128 v[152:155], v253 offset:17408
    s_waitcnt lgkmcnt(6)
    v_add_f32 v204, v120, v204
    v_add_f32 v205, v121, v205
    v_add_f32 v206, v122, v206
    v_add_f32 v207, v123, v207
    v_add_f32 v208, v124, v208
    v_add_f32 v209, v125, v209
    v_add_f32 v210, v126, v210
    v_add_f32 v211, v127, v211
    v_add_f32 v212, v128, v212
    v_add_f32 v213, v129, v213
    v_add_f32 v214, v130, v214
    v_add_f32 v215, v131, v215
    s_waitcnt lgkmcnt(3)
    v_add_f32 v204, v132, v204
    v_add_f32 v205, v133, v205
    v_add_f32 v206, v134, v206
    v_add_f32 v207, v135, v207
    v_add_f32 v208, v136, v208
    v_add_f32 v209, v137, v209
    v_add_f32 v210, v138, v210
    v_add_f32 v211, v139, v211
    v_add_f32 v212, v140, v212
    v_add_f32 v213, v141, v213
    v_add_f32 v214, v142, v214
    v_add_f32 v215, v143, v215
    s_waitcnt lgkmcnt(0)
    v_add_f32 v204, v144, v204
    v_add_f32 v205, v145, v205
    v_add_f32 v206, v146, v206
    v_add_f32 v207, v147, v207
    v_add_f32 v208, v148, v208
    v_add_f32 v209, v149, v209
    v_add_f32 v210, v150, v210
    v_add_f32 v211, v151, v211
    v_add_f32 v212, v152, v212
    v_add_f32 v213, v153, v213
    v_add_f32 v214, v154, v214
    v_add_f32 v215, v155, v215
    v_mov_b32 v6, v212
    v_mov_b32 v7, v212
    v_mov_b32 v8, 0x7e800000
    s_nop 0
    v_permlane32_swap_b32 v6, v7
    v_cmp_le_f32 vcc, 0x17800000, v7
    v_cmp_lt_f32 s[60:61], v7, v8
    s_nop 1
    s_and_b64 vcc, vcc, s[60:61]
    s_cmp_eq_u64 vcc, -1
    s_cbranch_scc0 A_1_fb
A_1_fin:
    v_rcp_f32 v8, v7
    s_nop 0
    v_mul_f32 v8, v8, v5
    v_mul_f32 v204, v8, v204
    v_mul_f32 v205, v8, v205
    v_mul_f32 v206, v8, v206
    v_mul_f32 v207, v8, v207
    v_mul_f32 v208, v8, v208
    v_mul_f32 v209, v8, v209
    v_mul_f32 v210, v8, v210
    v_mul_f32 v211, v8, v211
    v_mul_f32 v212, v8, v212
    v_mul_f32 v213, v8, v213
    v_mul_f32 v214, v8, v214
    v_mul_f32 v215, v8, v215
    v_cvt_pk_bf16_f32 v204, v204, v205
    v_cvt_pk_bf16_f32 v205, v206, v207
    v_cvt_pk_bf16_f32 v206, v208, v209
    v_cvt_pk_bf16_f32 v207, v210, v211
    v_cvt_pk_bf16_f32 v208, v212, v213
    v_cvt_pk_bf16_f32 v209, v214, v215
    buffer_store_dwordx4 v[204:207], v1, s[8:11], s58 offen sc1
    s_mov_b32 exec_hi, 0
    buffer_store_dwordx2 v[208:209], v1, s[8:11], s59 offen sc1
    s_mov_b32 exec_hi, -1
    s_endpgm
A_pre:
    s_mov_b32 s47, 0x40000
sbw_8:
    ds_read_b32 v6, v249 offset:0
    s_sub_u32 s47, s47, 1
    s_waitcnt lgkmcnt(0)
    v_cmp_gt_u32 vcc, 9, v6
    s_cbranch_scc1 sbw_8_x
    s_cbranch_vccnz sbw_8
sbw_8_x:
    s_branch A_preb
A_0_fb:
    v_cmp_gt_u32 vcc, 32, v0
    v_mov_b32 v6, 0xff800000
    s_mov_b32 s44, 0
    v_cndmask_b32 v112, 0, v112, vcc
A_0_fb_1:
    buffer_load_dwordx4 v[12:15], v1, s[8:11], s44 offen sc1
    s_mov_b32 exec_hi, 0
    buffer_load_dwordx2 v[16:17], v2, s[8:11], s44 offen offset:1024 sc1
    s_mov_b32 exec_hi, -1
    s_waitcnt vmcnt(0)
    v_mfma_f32_32x32x16_bf16 v[40:55], v[12:15], v[108:111], 0
    v_mfma_f32_32x32x8_bf16 v[40:55], v[16:17], v[112:113], v[40:55]
    s_add_u32 s44, s44, 2560
    s_nop 11
    v_max3_f32 v6, v6, v40, v41
    v_max3_f32 v6, v6, v42, v43
    v_max3_f32 v6, v6, v44, v45
    v_max3_f32 v6, v6, v46, v47
    v_max3_f32 v6, v6, v48, v49
    v_max3_f32 v6, v6, v50, v51
    v_max3_f32 v6, v6, v52, v53
    v_max3_f32 v6, v6, v54, v55
    s_cmp_lt_u32 s44, 163840
    s_cbranch_scc1 A_0_fb_1
    v_mov_b32 v7, v6
    s_nop 1
    v_permlane32_swap_b32 v6, v7
    v_max_f32 v6, v6, v7
    v_sub_f32 v6, 0, v6
    v_and_b32 v7, 0xffff0000, v6
    v_sub_f32 v6, v6, v7
    v_and_b32 v8, 0xffff0000, v6
    v_sub_f32 v6, v6, v8
    v_lshrrev_b32 v7, 16, v7
    v_lshrrev_b32 v6, 16, v6
    v_or_b32 v7, v7, v8
    v_cndmask_b32 v112, v7, v112, vcc
    v_cndmask_b32 v113, v6, v113, vcc
    s_mov_b32 s44, 0
    v_mov_b32 v192, 0
    v_mov_b32 v193, 0
    v_mov_b32 v194, 0
    v_mov_b32 v195, 0
    v_mov_b32 v196, 0
    v_mov_b32 v197, 0
    v_mov_b32 v198, 0
    v_mov_b32 v199, 0
    v_mov_b32 v200, 0
    v_mov_b32 v201, 0
    v_mov_b32 v202, 0
    v_mov_b32 v203, 0
A_0_fb_2:
    buffer_load_dwordx4 v[12:15], v1, s[8:11], s44 offen sc1
    s_mov_b32 exec_hi, 0
    buffer_load_dwordx2 v[16:17], v2, s[8:11], s44 offen offset:1024 sc1
    s_mov_b64 exec, s[54:55]
    buffer_load_dwordx4 v[24:27], v3, s[8:11], s44 offen offset:1280 sc1
    buffer_load_dwordx4 v[28:31], v3, s[8:11], s44 offen offset:1920 sc1
    s_mov_b64 exec, -1
    s_waitcnt vmcnt(0)
    v_mfma_f32_32x32x16_bf16 v[40:55], v[12:15], v[108:111], 0
    v_mfma_f32_32x32x8_bf16 v[40:55], v[16:17], v[112:113], v[40:55]
    s_add_u32 s44, s44, 2560
    s_nop 11
    v_exp_f32 v40, v40
    v_exp_f32 v41, v41
    v_exp_f32 v42, v42
    v_exp_f32 v43, v43
    v_exp_f32 v44, v44
    v_exp_f32 v45, v45
    v_exp_f32 v46, v46
    v_exp_f32 v47, v47
    v_exp_f32 v48, v48
    v_exp_f32 v49, v49
    v_exp_f32 v50, v50
    v_exp_f32 v51, v51
    v_exp_f32 v52, v52
    v_exp_f32 v53, v53
    v_exp_f32 v54, v54
    v_exp_f32 v55, v55
    s_nop 1
    v_smfmac_f32_32x32x32_bf16 v[192:207], v[24:27], v[40:47], v4
    v_smfmac_f32_32x32x32_bf16 v[192:207], v[28:31], v[48:55], v4
    s_cmp_lt_u32 s44, 163840
    s_cbranch_scc1 A_0_fb_2
    s_nop 11
    v_mov_b32 v6, v200
    v_mov_b32 v7, v200
    s_nop 1
    v_permlane32_swap_b32 v6, v7
    s_branch A_0_fin
A_1_fb:
    v_cmp_gt_u32 vcc, 32, v0
    v_mov_b32 v6, 0xff800000
    s_mov_b32 s44, 0
    v_cndmask_b32 v118, 0, v118, vcc
A_1_fb_1:
    buffer_load_dwordx4 v[12:15], v1, s[8:11], s44 offen sc1
    s_mov_b32 exec_hi, 0
    buffer_load_dwordx2 v[16:17], v2, s[8:11], s44 offen offset:1024 sc1
    s_mov_b32 exec_hi, -1
    s_waitcnt vmcnt(0)
    v_mfma_f32_32x32x16_bf16 v[40:55], v[12:15], v[114:117], 0
    v_mfma_f32_32x32x8_bf16 v[40:55], v[16:17], v[118:119], v[40:55]
    s_add_u32 s44, s44, 2560
    s_nop 11
    v_max3_f32 v6, v6, v40, v41
    v_max3_f32 v6, v6, v42, v43
    v_max3_f32 v6, v6, v44, v45
    v_max3_f32 v6, v6, v46, v47
    v_max3_f32 v6, v6, v48, v49
    v_max3_f32 v6, v6, v50, v51
    v_max3_f32 v6, v6, v52, v53
    v_max3_f32 v6, v6, v54, v55
    s_cmp_lt_u32 s44, 163840
    s_cbranch_scc1 A_1_fb_1
    v_mov_b32 v7, v6
    s_nop 1
    v_permlane32_swap_b32 v6, v7
    v_max_f32 v6, v6, v7
    v_sub_f32 v6, 0, v6
    v_and_b32 v7, 0xffff0000, v6
    v_sub_f32 v6, v6, v7
    v_and_b32 v8, 0xffff0000, v6
    v_sub_f32 v6, v6, v8
    v_lshrrev_b32 v7, 16, v7
    v_lshrrev_b32 v6, 16, v6
    v_or_b32 v7, v7, v8
    v_cndmask_b32 v118, v7, v118, vcc
    v_cndmask_b32 v119, v6, v119, vcc
    s_mov_b32 s44, 0
    v_mov_b32 v204, 0
    v_mov_b32 v205, 0
    v_mov_b32 v206, 0
    v_mov_b32 v207, 0
    v_mov_b32 v208, 0
    v_mov_b32 v209, 0
    v_mov_b32 v210, 0
    v_mov_b32 v211, 0
    v_mov_b32 v212, 0
    v_mov_b32 v213, 0
    v_mov_b32 v214, 0
    v_mov_b32 v215, 0
A_1_fb_2:
    buffer_load_dwordx4 v[12:15], v1, s[8:11], s44 offen sc1
    s_mov_b32 exec_hi, 0
    buffer_load_dwordx2 v[16:17], v2, s[8:11], s44 offen offset:1024 sc1
    s_mov_b64 exec, s[54:55]
    buffer_load_dwordx4 v[24:27], v3, s[8:11], s44 offen offset:1280 sc1
    buffer_load_dwordx4 v[28:31], v3, s[8:11], s44 offen offset:1920 sc1
    s_mov_b64 exec, -1
    s_waitcnt vmcnt(0)
    v_mfma_f32_32x32x16_bf16 v[40:55], v[12:15], v[114:117], 0
    v_mfma_f32_32x32x8_bf16 v[40:55], v[16:17], v[118:119], v[40:55]
    s_add_u32 s44, s44, 2560
    s_nop 11
    v_exp_f32 v40, v40
    v_exp_f32 v41, v41
    v_exp_f32 v42, v42
    v_exp_f32 v43, v43
    v_exp_f32 v44, v44
    v_exp_f32 v45, v45
    v_exp_f32 v46, v46
    v_exp_f32 v47, v47
    v_exp_f32 v48, v48
    v_exp_f32 v49, v49
    v_exp_f32 v50, v50
    v_exp_f32 v51, v51
    v_exp_f32 v52, v52
    v_exp_f32 v53, v53
    v_exp_f32 v54, v54
    v_exp_f32 v55, v55
    s_nop 1
    v_smfmac_f32_32x32x32_bf16 v[204:219], v[24:27], v[40:47], v4
    v_smfmac_f32_32x32x32_bf16 v[204:219], v[28:31], v[48:55], v4
    s_cmp_lt_u32 s44, 163840
    s_cbranch_scc1 A_1_fb_2
    s_nop 11
    v_mov_b32 v6, v212
    v_mov_b32 v7, v212
    s_nop 1
    v_permlane32_swap_b32 v6, v7
    s_branch A_1_fin
.p2align 6
F_G:
    s_load_dwordx2 s[16:17], s[0:1], 48
    s_mov_b32 s18, 0x1e0000
    s_mov_b32 s19, 0x00020000
    v_lshlrev_b32 v2, 2, v0
    v_add_u32 v2, 159744, v2
    v_mov_b32 v3, 0
    ds_write_b32 v2, v3
    s_sub_u32 s42, s42, 4
    v_lshrrev_b32 v252, 3, v0
    v_and_b32 v24, 7, v0
    v_min_u32 v252, 4, v252
    v_min_u32 v24, 5, v24
    v_mul_u32_u24 v252, 3072, v252
    v_lshl_add_u32 v252, v24, 7, v252
    s_lshr_b32 s53, s2, 3
    s_lshl2_add_u32 s53, s53, s42
    s_mul_i32 s53, s53, 15360
    s_bitcmp1_b32 s41, 2
    s_cselect_b32 s44, 768, 0
    s_add_u32 s53, s53, s44
    s_movk_i32 s44, 960
    v_mul_u32_u24 v24, 3277, v0
    v_lshrrev_b32 v24, 16, v24
    v_bfe_u32 v25, v24, 2, 2
    v_xor_b32 v25, v25, v0
    v_lshlrev_b32 v25, 4, v25
    v_mad_u32_u24 v56, v24, s44, v25
    v_add_u32 v24, 64, v0
    v_mul_u32_u24 v24, 3277, v24
    v_lshrrev_b32 v24, 16, v24
    v_bfe_u32 v25, v24, 2, 2
    v_xor_b32 v25, v25, v0
    v_lshlrev_b32 v25, 4, v25
    v_mad_u32_u24 v57, v24, s44, v25
    v_add_u32 v24, 128, v0
    v_mul_u32_u24 v24, 3277, v24
    v_lshrrev_b32 v24, 16, v24
    v_bfe_u32 v25, v24, 2, 2
    v_xor_b32 v25, v25, v0
    v_lshlrev_b32 v25, 4, v25
    v_mad_u32_u24 v58, v24, s44, v25
    v_add_u32 v24, 192, v0
    v_mul_u32_u24 v24, 3277, v24
    v_lshrrev_b32 v24, 16, v24
    v_bfe_u32 v25, v24, 2, 2
    v_xor_b32 v25, v25, v0
    v_lshlrev_b32 v25, 4, v25
    v_mad_u32_u24 v59, v24, s44, v25
    v_add_u32 v24, 256, v0
    v_mul_u32_u24 v24, 3277, v24
    v_lshrrev_b32 v24, 16, v24
    v_bfe_u32 v25, v24, 2, 2
    v_xor_b32 v25, v25, v0
    v_lshlrev_b32 v25, 4, v25
    v_mad_u32_u24 v60, v24, s44, v25
    s_mul_i32 s56, s42, 20480
    s_mul_i32 s44, s40, 81920
    s_mul_i32 s45, s42, 320
    s_add_u32 s57, s44, s45
    v_add_u32 v60, 4096, v60
    s_and_b32 s51, s41, 3
    s_load_dwordx2 s[20:21], s[0:1], 56
    s_mov_b32 s22, 0x800000
    s_mov_b32 s23, 0x00020000
    s_load_dwordx2 s[24:25], s[0:1], 64
    s_mov_b32 s26, 0x1000
    s_mov_b32 s27, 0x00020000
    s_load_dwordx2 s[28:29], s[0:1], 32
    s_mov_b32 s30, 0xc8000
    s_mov_b32 s31, 0x00020000
    s_load_dwordx2 s[32:33], s[0:1], 72
    s_mov_b32 s34, 0xf0000
    s_mov_b32 s35, 0x00020000
    s_load_dwordx2 s[36:37], s[0:1], 88
    s_mov_b32 s38, 0x280000
    s_mov_b32 s39, 0x00020000
    s_lshl_b32 s44, s42, 2
    s_add_u32 s44, s44, 159760
    v_mov_b32 v254, s44
    s_waitcnt lgkmcnt(0)
    s_barrier
    s_load_dword s43, s[8:9], 196608
    v_mul_u32_u24 v24, 5462, v0
    v_lshrrev_b32 v24, 16, v24
    v_mul_u32_u24 v24, 2880, v24
    v_lshl_add_u32 v240, v0, 4, v24
    v_add_u32 v24, 64, v0
    v_mul_u32_u24 v24, 5462, v24
    v_lshrrev_b32 v24, 16, v24
    v_mul_u32_u24 v24, 2880, v24
    v_lshl_add_u32 v241, v0, 4, v24
    v_add_u32 v24, 128, v0
    v_mul_u32_u24 v24, 5462, v24
    v_lshrrev_b32 v24, 16, v24
    v_mul_u32_u24 v24, 2880, v24
    v_lshl_add_u32 v242, v0, 4, v24
    s_mul_i32 s60, s42, 12288
    s_add_u32 s60, s60, 81920
    s_mul_i32 s61, s42, 491520
    s_mul_i32 s44, s41, 192
    s_add_u32 s61, s61, s44
    v_and_b32 v243, 19, v0
    v_bfe_u32 v24, v0, 2, 1
    v_lshl_or_b32 v243, v24, 3, v243
    v_bfe_u32 v24, v0, 3, 1
    v_lshl_or_b32 v243, v24, 2, v243
    v_lshrrev_b32 v24, 5, v0
    v_bfe_u32 v25, v243, 2, 2
    v_xor_b32 v25, v25, v24
    v_mul_u32_u24 v22, 320, v243
    v_lshl_add_u32 v22, v25, 4, v22
    v_add_u32 v22, s56, v22
    v_xor_b32 v23, 32, v22
    s_and_b32 s44, s42, 1
    s_lshl_b32 s44, s44, 4
    v_xor_b32 v243, s44, v243
    v_xor_b32 v1, s44, v0
    v_bfe_u32 v25, v0, 2, 2
    v_lshl_or_b32 v24, v24, 3, v25
    v_mul_u32_u24 v24, 192, v24
    v_and_b32 v25, 3, v0
    v_lshl_add_u32 v24, v25, 3, v24
    v_and_b32 v25, 16, v1
    v_lshl_add_u32 v24, v25, 1, v24
    v_add_u32 v8, s60, v24
    v_lshlrev_b32 v1, 4, v1
    v_subrev_u32 v24, 16, v254
    v_and_b32 v255, 3, v0
    v_lshlrev_b32 v255, 2, v255
    v_add_u32 v255, 159760, v255
    s_xor_b32 s44, s42, 0
    s_mul_i32 s44, s44, 12288
    s_add_u32 s44, s44, 81920
    v_add_u32 v244, s44, v1
    s_xor_b32 s44, s42, 1
    s_mul_i32 s44, s44, 12288
    s_add_u32 s44, s44, 81920
    v_add_u32 v245, s44, v1
    s_xor_b32 s44, s42, 2
    s_mul_i32 s44, s44, 12288
    s_add_u32 s44, s44, 81920
    v_add_u32 v246, s44, v1
    s_xor_b32 s44, s42, 3
    s_mul_i32 s44, s44, 12288
    s_add_u32 s44, s44, 81920
    v_add_u32 v247, s44, v1
    s_mov_b32 s58, 0xbdd2d3e8
    s_mov_b32 s59, s58
    v_mov_b64 v[12:13], -1
    v_mov_b64 v[14:15], -1
    s_movk_i32 s98, 0x4000
    s_mul_i32 s49, s41, 393216
    s_add_u32 s49, s49, 12582912
    s_lshl2_add_u32 s44, s40, s42
    s_mul_i32 s7, s44, 45056
    s_add_u32 s7, s7, 16777216
    s_mul_i32 s44, s44, 3072
    s_add_u32 s5, s44, s49
    s_mul_i32 s44, s42, 12288
    s_add_u32 s49, s49, s44
    s_lshl_b32 s6, s41, 9
    s_add_u32 s6, s6, 204800
    s_and_b32 s44, s40, 3
    s_lshl_b32 s44, s44, 5
    s_and_b32 s99, s40, 28
    s_add_u32 s44, s44, s99
    s_add_u32 s44, s44, s42
    s_lshl2_add_u32 s99, s44, s6
    s_lshl_b32 s44, s42, 7
    s_add_u32 s6, s6, s44
    s_lshr_b32 s44, s42, 1
    s_lshl1_add_u32 s54, s40, s44
    s_lshl_b32 s54, s54, 17
    s_lshl_b32 s44, s42, 7
    s_add_u32 s54, s54, s44
    s_xor_b32 s55, s54, 0x20000
    s_mul_i32 s44, s41, 2
    s_mul_i32 s50, s40, 1
    s_add_u32 s50, s50, s44
    s_and_b32 s50, s50, 7
    s_sub_u32 s52, s50, 1
    s_mul_i32 s48, s42, 18432
    s_mul_i32 s101, s42, 5120
    s_add_u32 s101, s101, 73728
    v_and_b32 v11, 7, v0
    v_lshlrev_b32 v11, 2, v11
    v_add_u32 v11, 159744, v11
    v_lshrrev_b32 v16, 3, v0
    v_lshrrev_b32 v17, 4, v0
    v_and_b32 v18, 7, v0
    v_xor_b32 v18, v18, v17
    v_lshlrev_b32 v16, 12, v16
    v_lshl_add_u32 v2, v18, 4, v16
    v_xor_b32 v3, 64, v2
    v_lshrrev_b32 v17, 5, v0
    v_bfe_u32 v18, v243, 1, 3
    v_xor_b32 v17, v17, v18
    v_lshlrev_b32 v17, 4, v17
    v_lshl_add_u32 v17, v243, 7, v17
    v_xor_b32 v4, 0, v17
    v_xor_b32 v5, 32, v17
    v_xor_b32 v6, 64, v17
    v_xor_b32 v7, 96, v17
    v_add_u32 v4, s48, v4
    v_add_u32 v5, s48, v5
    v_add_u32 v6, s48, v6
    v_add_u32 v7, s48, v7
    s_lshr_b32 s46, s42, 1
    s_lshl1_add_u32 s45, s40, s46
    s_lshl_b32 s45, s45, 6
    s_lshl_b32 s46, s46, 7
    s_add_u32 s46, s46, 160000
    v_lshl_add_u32 v248, v243, 1, s45
    v_lshl_add_u32 v10, v243, 2, s46
    s_lshl2_add_u32 s3, s41, s42
    s_mul_i32 s3, s3, 56320
    s_add_u32 s3, s3, 262144
    s_movk_i32 s44, 1120
    v_lshlrev_b32 v45, 4, v0
    v_mul_u32_u24 v44, 6554, v0
    v_lshrrev_b32 v44, 16, v44
    v_mad_u32_u24 v253, v44, s44, v45
    s_lshl_b32 s44, s40, 3
    s_and_b32 s45, s41, 6
    s_add_u32 s44, s44, s45
    s_lshr_b32 s46, s42, 1
    s_add_u32 s44, s44, s46
    s_mul_i32 s44, s44, 22
    s_and_b32 s45, s41, 1
    s_mul_i32 s46, s45, 6
    s_add_u32 s44, s44, s46
    s_and_b32 s46, s42, 1
    s_add_u32 s44, s44, s46
    s_lshl_b32 s44, s44, 10
    s_add_u32 s0, s44, 16787456
    s_add_u32 s100, s0, 4096
    s_lshl_b32 s45, s45, 10
    s_mul_i32 s62, s45, -2
    s_add_u32 s62, s62, s0
    s_sub_u32 s62, s62, 10240
    s_mul_i32 s63, s45, -3
    s_add_u32 s63, s63, s62
    s_lshl_b32 s46, s46, 9
    s_sub_u32 s63, s63, s46
    s_add_u32 s63, s63, 8192
    s_lshl3_add_u32 s4, s40, s41
    s_lshr_b32 s44, s4, 1
    s_lshl_b32 s4, s44, 7
    s_lshr_b32 s45, s45, 6
    s_add_u32 s4, s4, s45
    s_lshl2_add_u32 s4, s42, s4
    s_add_u32 s4, s4, 212992
    s_lshl2_add_u32 s1, s40, s42
    s_lshl_b32 s1, s1, 7
    s_add_u32 s1, s1, 53248
    v_lshrrev_b32 v46, 4, v0
    v_and_b32 v47, 15, v0
    v_mul_u32_u24 v37, 1280, v47
    v_mad_u32_u24 v37, v46, 40, v37
    v_lshl_or_b32 v46, v46, 5, v47
    v_lshlrev_b32 v38, 4, v46
    v_bfe_u32 v46, v0, 1, 1
    v_bfe_u32 v47, v0, 2, 1
    v_and_b32 v48, 1, v0
    v_mad_u32_u24 v36, v46, 22, v48
    v_mad_u32_u24 v36, v47, 6, v36
    v_mad_u32_u24 v47, v48, 22, v47
    v_lshlrev_b32 v36, 10, v36
    v_lshlrev_b32 v47, 7, v47
    v_add_lshl_u32 v39, v47, v46, 3
    v_bfe_u32 v249, v0, 2, 3
    v_lshrrev_b32 v46, 5, v0
    v_lshl_or_b32 v249, v46, 4, v249
    v_and_b32 v46, 3, v0
    v_lshl_add_u32 v249, v249, 2, v46
    v_mad_u32_u24 v249, v249, 40, s101
    v_add_u32 v45, 160256, v45
    ds_write_b128 v45, v[36:39] offset:1024
    s_xor_b32 s44, s51, 1
    s_xor_b32 s45, s44, s42
    s_mul_i32 s44, s44, 20480
    s_mul_i32 s45, s45, 5120
    s_add_u32 m0, s56, s45
    s_add_u32 s44, s44, s57
    buffer_load_dwordx4 v56, s[12:15], s44 offen offset:0 lds
    buffer_load_dwordx4 v57, s[12:15], s44 offen offset:1024 lds
    buffer_load_dwordx4 v58, s[12:15], s44 offen offset:2048 lds
    buffer_load_dwordx4 v59, s[12:15], s44 offen offset:3072 lds
    s_add_u32 m0, m0, 4096
    s_nop 0
    buffer_load_dwordx4 v60, s[12:15], s44 offen offset:0 lds
    s_xor_b32 s44, s51, 2
    s_xor_b32 s45, s44, s42
    s_mul_i32 s44, s44, 20480
    s_mul_i32 s45, s45, 5120
    s_add_u32 m0, s56, s45
    s_add_u32 s44, s44, s57
    buffer_load_dwordx4 v56, s[12:15], s44 offen offset:0 lds
    buffer_load_dwordx4 v57, s[12:15], s44 offen offset:1024 lds
    buffer_load_dwordx4 v58, s[12:15], s44 offen offset:2048 lds
    buffer_load_dwordx4 v59, s[12:15], s44 offen offset:3072 lds
    s_add_u32 m0, m0, 4096
    s_nop 0
    buffer_load_dwordx4 v60, s[12:15], s44 offen offset:0 lds
    s_xor_b32 s44, s51, 3
    s_xor_b32 s45, s44, s42
    s_mul_i32 s44, s44, 20480
    s_mul_i32 s45, s45, 5120
    s_add_u32 m0, s56, s45
    s_add_u32 s44, s44, s57
    buffer_load_dwordx4 v56, s[12:15], s44 offen offset:0 lds
    buffer_load_dwordx4 v57, s[12:15], s44 offen offset:1024 lds
    buffer_load_dwordx4 v58, s[12:15], s44 offen offset:2048 lds
    buffer_load_dwordx4 v59, s[12:15], s44 offen offset:3072 lds
    s_add_u32 m0, m0, 4096
    s_nop 0
    buffer_load_dwordx4 v60, s[12:15], s44 offen offset:0 lds
    s_add_u32 m0, s60, 0
    s_add_u32 s44, s61, 1536
    buffer_load_dwordx4 v240, s[16:19], s44 offen offset:0 lds
    buffer_load_dwordx4 v241, s[16:19], s44 offen offset:1024 lds
    buffer_load_dwordx4 v242, s[16:19], s44 offen offset:2048 lds
    s_add_u32 m0, s60, 3072
    s_add_u32 s44, s61, 50688
    buffer_load_dwordx4 v240, s[16:19], s44 offen offset:0 lds
    buffer_load_dwordx4 v241, s[16:19], s44 offen offset:1024 lds
    buffer_load_dwordx4 v242, s[16:19], s44 offen offset:2048 lds
    s_add_u32 m0, s60, 6144
    s_add_u32 s44, s61, 99840
    buffer_load_dwordx4 v240, s[16:19], s44 offen offset:0 lds
    buffer_load_dwordx4 v241, s[16:19], s44 offen offset:1024 lds
    buffer_load_dwordx4 v242, s[16:19], s44 offen offset:2048 lds
    s_add_u32 m0, s60, 9216
    s_add_u32 s44, s61, 148992
    buffer_load_dwordx4 v240, s[16:19], s44 offen offset:0 lds
    buffer_load_dwordx4 v241, s[16:19], s44 offen offset:1024 lds
    buffer_load_dwordx4 v242, s[16:19], s44 offen offset:2048 lds
    v_mov_b32 v9, 1
    s_mov_b64 exec, 1
    ds_write_b32 v254, v9 offset:0
    s_mov_b64 exec, -1
    s_mov_b32 s47, 0x40000
sbw_9:
    ds_read_b32 v9, v24 offset:32
    s_sub_u32 s47, s47, 1
    s_waitcnt lgkmcnt(0)
    v_cmp_gt_u32 vcc, 1, v9
    s_cbranch_scc1 sbw_9_x
    s_cbranch_vccnz sbw_9
sbw_9_x:
    s_add_u32 s43, s43, 0x9e3779b1
    s_waitcnt vmcnt(12)
    ds_read_b128 v[112:115], v22 offset:0
    ds_read_b128 v[116:119], v22 offset:10240
    ds_read_b128 v[120:123], v23 offset:0
    ds_read_b128 v[124:127], v23 offset:10240
    ds_read_b128 v[128:131], v22 offset:64
    ds_read_b128 v[132:135], v22 offset:10304
    ds_read_b128 v[136:139], v23 offset:64
    ds_read_b128 v[140:143], v23 offset:10304
    ds_read_b128 v[144:147], v22 offset:128
    ds_read_b128 v[148:151], v22 offset:10368
    ds_read_b128 v[152:155], v23 offset:128
    ds_read_b128 v[156:159], v23 offset:10368
    ds_read_b128 v[160:163], v22 offset:192
    ds_read_b128 v[164:167], v22 offset:10432
    ds_read_b128 v[168:171], v23 offset:192
    ds_read_b128 v[172:175], v23 offset:10432
    ds_read_b128 v[176:179], v22 offset:256
    ds_read_b128 v[180:183], v22 offset:10496
    ds_read_b128 v[184:187], v23 offset:256
    ds_read_b128 v[188:191], v23 offset:10496
    s_waitcnt vmcnt(9)
    ds_read_b64_tr_b16 v[192:193], v8 offset:0
    ds_read_b64_tr_b16 v[194:195], v8 offset:768
    ds_read_b64_tr_b16 v[196:197], v8 offset:64
    ds_read_b64_tr_b16 v[198:199], v8 offset:832
    ds_read_b64_tr_b16 v[200:201], v8 offset:128
    ds_read_b64_tr_b16 v[202:203], v8 offset:896
    s_waitcnt lgkmcnt(0)
    v_mfma_f32_32x32x16_bf16 v[64:79], v[116:119], v[192:195], 0
    s_waitcnt vmcnt(6)
    ds_read_b64_tr_b16 v[204:205], v8 offset:3072
    ds_read_b64_tr_b16 v[206:207], v8 offset:3840
    ds_read_b64_tr_b16 v[208:209], v8 offset:3136
    ds_read_b64_tr_b16 v[210:211], v8 offset:3904
    ds_read_b64_tr_b16 v[212:213], v8 offset:3200
    ds_read_b64_tr_b16 v[214:215], v8 offset:3968
    v_mfma_f32_32x32x16_bf16 v[16:31], v[112:115], v[192:195], 0
    s_add_u32 m0, s60, 0
    s_add_u32 s44, s61, 198144
    buffer_load_dwordx4 v240, s[16:19], s44 offen offset:0 lds
    v_mfma_f32_32x32x16_bf16 v[80:95], v[116:119], v[196:199], 0
    buffer_load_dwordx4 v241, s[16:19], s44 offen offset:1024 lds
    v_mfma_f32_32x32x16_bf16 v[32:47], v[112:115], v[196:199], 0
    buffer_load_dwordx4 v242, s[16:19], s44 offen offset:2048 lds
    v_mfma_f32_32x32x16_bf16 v[96:111], v[116:119], v[200:203], 0
    v_mfma_f32_32x32x16_bf16 v[48:63], v[112:115], v[200:203], 0
    s_waitcnt lgkmcnt(0)
    v_mfma_f32_32x32x16_bf16 v[64:79], v[124:127], v[204:207], v[64:79]
    s_waitcnt vmcnt(6)
    ds_read_b64_tr_b16 v[192:193], v8 offset:6144
    ds_read_b64_tr_b16 v[194:195], v8 offset:6912
    ds_read_b64_tr_b16 v[196:197], v8 offset:6208
    ds_read_b64_tr_b16 v[198:199], v8 offset:6976
    ds_read_b64_tr_b16 v[200:201], v8 offset:6272
    ds_read_b64_tr_b16 v[202:203], v8 offset:7040
    v_mfma_f32_32x32x16_bf16 v[16:31], v[120:123], v[204:207], v[16:31]
    s_add_u32 m0, s60, 3072
    s_add_u32 s44, s61, 247296
    buffer_load_dwordx4 v240, s[16:19], s44 offen offset:0 lds
    v_mfma_f32_32x32x16_bf16 v[80:95], v[124:127], v[208:211], v[80:95]
    buffer_load_dwordx4 v241, s[16:19], s44 offen offset:1024 lds
    v_mfma_f32_32x32x16_bf16 v[32:47], v[120:123], v[208:211], v[32:47]
    buffer_load_dwordx4 v242, s[16:19], s44 offen offset:2048 lds
    v_mfma_f32_32x32x16_bf16 v[96:111], v[124:127], v[212:215], v[96:111]
    v_mfma_f32_32x32x16_bf16 v[48:63], v[120:123], v[212:215], v[48:63]
    s_waitcnt lgkmcnt(0)
    v_mfma_f32_32x32x16_bf16 v[64:79], v[132:135], v[192:195], v[64:79]
    s_waitcnt vmcnt(6)
    ds_read_b64_tr_b16 v[204:205], v8 offset:9216
    ds_read_b64_tr_b16 v[206:207], v8 offset:9984
    ds_read_b64_tr_b16 v[208:209], v8 offset:9280
    ds_read_b64_tr_b16 v[210:211], v8 offset:10048
    ds_read_b64_tr_b16 v[212:213], v8 offset:9344
    ds_read_b64_tr_b16 v[214:215], v8 offset:10112
    v_mfma_f32_32x32x16_bf16 v[16:31], v[128:131], v[192:195], v[16:31]
    s_add_u32 m0, s60, 6144
    s_add_u32 s44, s61, 296448
    buffer_load_dwordx4 v240, s[16:19], s44 offen offset:0 lds
    v_mfma_f32_32x32x16_bf16 v[80:95], v[132:135], v[196:199], v[80:95]
    buffer_load_dwordx4 v241, s[16:19], s44 offen offset:1024 lds
    v_mfma_f32_32x32x16_bf16 v[32:47], v[128:131], v[196:199], v[32:47]
    buffer_load_dwordx4 v242, s[16:19], s44 offen offset:2048 lds
    v_mfma_f32_32x32x16_bf16 v[96:111], v[132:135], v[200:203], v[96:111]
    v_mfma_f32_32x32x16_bf16 v[48:63], v[128:131], v[200:203], v[48:63]
    s_waitcnt lgkmcnt(0)
    v_mfma_f32_32x32x16_bf16 v[64:79], v[140:143], v[204:207], v[64:79]
    s_waitcnt vmcnt(6)
    ds_read_b64_tr_b16 v[192:193], v8 offset:0
    ds_read_b64_tr_b16 v[194:195], v8 offset:768
    ds_read_b64_tr_b16 v[196:197], v8 offset:64
    ds_read_b64_tr_b16 v[198:199], v8 offset:832
    ds_read_b64_tr_b16 v[200:201], v8 offset:128
    ds_read_b64_tr_b16 v[202:203], v8 offset:896
    v_mfma_f32_32x32x16_bf16 v[16:31], v[136:139], v[204:207], v[16:31]
    s_add_u32 m0, s60, 9216
    s_add_u32 s44, s61, 345600
    buffer_load_dwordx4 v240, s[16:19], s44 offen offset:0 lds
    v_mfma_f32_32x32x16_bf16 v[80:95], v[140:143], v[208:211], v[80:95]
    buffer_load_dwordx4 v241, s[16:19], s44 offen offset:1024 lds
    v_mfma_f32_32x32x16_bf16 v[32:47], v[136:139], v[208:211], v[32:47]
    buffer_load_dwordx4 v242, s[16:19], s44 offen offset:2048 lds
    v_mfma_f32_32x32x16_bf16 v[96:111], v[140:143], v[212:215], v[96:111]
    v_mfma_f32_32x32x16_bf16 v[48:63], v[136:139], v[212:215], v[48:63]
    s_waitcnt lgkmcnt(0)
    v_mfma_f32_32x32x16_bf16 v[64:79], v[148:151], v[192:195], v[64:79]
    s_waitcnt vmcnt(6)
    ds_read_b64_tr_b16 v[204:205], v8 offset:3072
    ds_read_b64_tr_b16 v[206:207], v8 offset:3840
    ds_read_b64_tr_b16 v[208:209], v8 offset:3136
    ds_read_b64_tr_b16 v[210:211], v8 offset:3904
    ds_read_b64_tr_b16 v[212:213], v8 offset:3200
    ds_read_b64_tr_b16 v[214:215], v8 offset:3968
    v_mfma_f32_32x32x16_bf16 v[16:31], v[144:147], v[192:195], v[16:31]
    s_add_u32 m0, s60, 0
    s_add_u32 s44, s61, 394752
    buffer_load_dwordx4 v240, s[16:19], s44 offen offset:0 lds
    v_mfma_f32_32x32x16_bf16 v[80:95], v[148:151], v[196:199], v[80:95]
    buffer_load_dwordx4 v241, s[16:19], s44 offen offset:1024 lds
    v_mfma_f32_32x32x16_bf16 v[32:47], v[144:147], v[196:199], v[32:47]
    buffer_load_dwordx4 v242, s[16:19], s44 offen offset:2048 lds
    v_mfma_f32_32x32x16_bf16 v[96:111], v[148:151], v[200:203], v[96:111]
    v_mfma_f32_32x32x16_bf16 v[48:63], v[144:147], v[200:203], v[48:63]
    s_waitcnt lgkmcnt(0)
    v_mfma_f32_32x32x16_bf16 v[64:79], v[156:159], v[204:207], v[64:79]
    s_waitcnt vmcnt(6)
    ds_read_b64_tr_b16 v[192:193], v8 offset:6144
    ds_read_b64_tr_b16 v[194:195], v8 offset:6912
    ds_read_b64_tr_b16 v[196:197], v8 offset:6208
    ds_read_b64_tr_b16 v[198:199], v8 offset:6976
    ds_read_b64_tr_b16 v[200:201], v8 offset:6272
    ds_read_b64_tr_b16 v[202:203], v8 offset:7040
    v_mfma_f32_32x32x16_bf16 v[16:31], v[152:155], v[204:207], v[16:31]
    s_add_u32 m0, s60, 3072
    s_add_u32 s44, s61, 443904
    buffer_load_dwordx4 v240, s[16:19], s44 offen offset:0 lds
    v_mfma_f32_32x32x16_bf16 v[80:95], v[156:159], v[208:211], v[80:95]
    buffer_load_dwordx4 v241, s[16:19], s44 offen offset:1024 lds
    v_mfma_f32_32x32x16_bf16 v[32:47], v[152:155], v[208:211], v[32:47]
    buffer_load_dwordx4 v242, s[16:19], s44 offen offset:2048 lds
    v_mfma_f32_32x32x16_bf16 v[96:111], v[156:159], v[212:215], v[96:111]
    v_mov_b32 v9, 2
    s_mov_b64 exec, 1
    ds_write_b32 v254, v9 offset:0
    s_mov_b64 exec, -1
    v_mfma_f32_32x32x16_bf16 v[48:63], v[152:155], v[212:215], v[48:63]
    s_waitcnt lgkmcnt(1)
    buffer_load_dword v252, v252, s[16:19], s53 offen
    v_mfma_f32_32x32x16_bf16 v[64:79], v[164:167], v[192:195], v[64:79]
    s_waitcnt vmcnt(7)
    ds_read_b64_tr_b16 v[204:205], v8 offset:9216
    ds_read_b64_tr_b16 v[206:207], v8 offset:9984
    ds_read_b64_tr_b16 v[208:209], v8 offset:9280
    ds_read_b64_tr_b16 v[210:211], v8 offset:10048
    ds_read_b64_tr_b16 v[212:213], v8 offset:9344
    ds_read_b64_tr_b16 v[214:215], v8 offset:10112
    v_mfma_f32_32x32x16_bf16 v[16:31], v[160:163], v[192:195], v[16:31]
    v_mfma_f32_32x32x16_bf16 v[80:95], v[164:167], v[196:199], v[80:95]
    v_mfma_f32_32x32x16_bf16 v[32:47], v[160:163], v[196:199], v[32:47]
    v_mfma_f32_32x32x16_bf16 v[96:111], v[164:167], v[200:203], v[96:111]
    v_mfma_f32_32x32x16_bf16 v[48:63], v[160:163], v[200:203], v[48:63]
    s_waitcnt lgkmcnt(0)
    v_mfma_f32_32x32x16_bf16 v[64:79], v[172:175], v[204:207], v[64:79]
    s_waitcnt vmcnt(4)
    ds_read_b64_tr_b16 v[192:193], v8 offset:0
    ds_read_b64_tr_b16 v[194:195], v8 offset:768
    ds_read_b64_tr_b16 v[196:197], v8 offset:64
    ds_read_b64_tr_b16 v[198:199], v8 offset:832
    ds_read_b64_tr_b16 v[200:201], v8 offset:128
    ds_read_b64_tr_b16 v[202:203], v8 offset:896
    v_mfma_f32_32x32x16_bf16 v[16:31], v[168:171], v[204:207], v[16:31]
    v_mfma_f32_32x32x16_bf16 v[80:95], v[172:175], v[208:211], v[80:95]
    v_mfma_f32_32x32x16_bf16 v[32:47], v[168:171], v[208:211], v[32:47]
    v_mfma_f32_32x32x16_bf16 v[96:111], v[172:175], v[212:215], v[96:111]
    v_mfma_f32_32x32x16_bf16 v[48:63], v[168:171], v[212:215], v[48:63]
    s_waitcnt lgkmcnt(0)
    v_mfma_f32_32x32x16_bf16 v[64:79], v[180:183], v[192:195], v[64:79]
    s_waitcnt vmcnt(1)
    ds_read_b64_tr_b16 v[204:205], v8 offset:3072
    ds_read_b64_tr_b16 v[206:207], v8 offset:3840
    ds_read_b64_tr_b16 v[208:209], v8 offset:3136
    ds_read_b64_tr_b16 v[210:211], v8 offset:3904
    ds_read_b64_tr_b16 v[212:213], v8 offset:3200
    ds_read_b64_tr_b16 v[214:215], v8 offset:3968
    v_mfma_f32_32x32x16_bf16 v[16:31], v[176:179], v[192:195], v[16:31]
    v_mfma_f32_32x32x16_bf16 v[80:95], v[180:183], v[196:199], v[80:95]
    v_mfma_f32_32x32x16_bf16 v[32:47], v[176:179], v[196:199], v[32:47]
    v_mfma_f32_32x32x16_bf16 v[96:111], v[180:183], v[200:203], v[96:111]
    v_mfma_f32_32x32x16_bf16 v[48:63], v[176:179], v[200:203], v[48:63]
    s_waitcnt lgkmcnt(0)
    v_mfma_f32_32x32x16_bf16 v[64:79], v[188:191], v[204:207], v[64:79]
    v_mfma_f32_32x32x16_bf16 v[80:95], v[188:191], v[208:211], v[80:95]
    v_mfma_f32_32x32x16_bf16 v[96:111], v[188:191], v[212:215], v[96:111]
    v_mfma_f32_32x32x16_bf16 v[16:31], v[184:187], v[204:207], v[16:31]
    s_nop 8
    ds_write_b128 v244, v[64:67] offset:0
    ds_write_b128 v244, v[68:71] offset:1024
    ds_write_b128 v244, v[72:75] offset:2048
    ds_write_b128 v244, v[76:79] offset:3072
    v_mfma_f32_32x32x16_bf16 v[32:47], v[184:187], v[208:211], v[32:47]
    ds_write_b128 v244, v[80:83] offset:4096
    ds_write_b128 v244, v[84:87] offset:5120
    ds_write_b128 v244, v[88:91] offset:6144
    ds_write_b128 v244, v[92:95] offset:7168
    v_mfma_f32_32x32x16_bf16 v[48:63], v[184:187], v[212:215], v[48:63]
    ds_write_b128 v244, v[96:99] offset:8192
    ds_write_b128 v244, v[100:103] offset:9216
    ds_write_b128 v244, v[104:107] offset:10240
    ds_write_b128 v244, v[108:111] offset:11264
    s_setprio 1
    s_xor_b32 s44, s42, 3
    s_sub_u32 s44, s44, s42
    s_mul_i32 s44, s44, 12288
    s_add_u32 s60, s60, s44
    v_add_u32 v8, s44, v8
    v_mov_b32 v9, 3
    s_mov_b64 exec, 1
    ds_write_b32 v254, v9 offset:0
    s_mov_b64 exec, -1
    s_mov_b32 s47, 0x40000
sbw_10:
    ds_read_b32 v9, v255 offset:0
    s_sub_u32 s47, s47, 1
    s_waitcnt lgkmcnt(0)
    v_cmp_gt_u32 vcc, 3, v9
    s_cbranch_scc1 sbw_10_x
    s_cbranch_vccnz sbw_10
sbw_10_x:
    ds_read_b128 v[72:75], v246 offset:2048
    ds_read_b128 v[76:79], v246 offset:3072
    ds_read_b128 v[88:91], v246 offset:6144
    ds_read_b128 v[92:95], v246 offset:7168
    ds_read_b128 v[104:107], v246 offset:10240
    ds_read_b128 v[108:111], v246 offset:11264
    ds_read_b128 v[64:67], v246 offset:0
    ds_read_b128 v[68:71], v246 offset:1024
    ds_read_b128 v[80:83], v246 offset:4096
    ds_read_b128 v[84:87], v246 offset:5120
    ds_read_b128 v[96:99], v246 offset:8192
    ds_read_b128 v[100:103], v246 offset:9216
    s_waitcnt lgkmcnt(11)
    v_add_f32 v24, v72, v24
    v_add_f32 v25, v73, v25
    v_add_f32 v26, v74, v26
    v_add_f32 v27, v75, v27
    s_waitcnt lgkmcnt(10)
    v_add_f32 v28, v76, v28
    v_add_f32 v29, v77, v29
    v_add_f32 v30, v78, v30
    v_add_f32 v31, v79, v31
    s_waitcnt lgkmcnt(9)
    v_add_f32 v40, v88, v40
    v_add_f32 v41, v89, v41
    v_add_f32 v42, v90, v42
    v_add_f32 v43, v91, v43
    s_waitcnt lgkmcnt(8)
    v_add_f32 v44, v92, v44
    v_add_f32 v45, v93, v45
    v_add_f32 v46, v94, v46
    v_add_f32 v47, v95, v47
    s_waitcnt lgkmcnt(7)
    v_add_f32 v56, v104, v56
    v_add_f32 v57, v105, v57
    v_add_f32 v58, v106, v58
    v_add_f32 v59, v107, v59
    s_waitcnt lgkmcnt(6)
    v_add_f32 v60, v108, v60
    v_add_f32 v61, v109, v61
    v_add_f32 v62, v110, v62
    v_add_f32 v63, v111, v63
    ds_write_b128 v246, v[24:27] offset:2048
    ds_write_b128 v246, v[28:31] offset:3072
    ds_write_b128 v246, v[40:43] offset:6144
    ds_write_b128 v246, v[44:47] offset:7168
    ds_write_b128 v246, v[56:59] offset:10240
    ds_write_b128 v246, v[60:63] offset:11264
    v_mov_b32 v9, 4
    s_mov_b64 exec, 1
    ds_write_b32 v254, v9 offset:0
    s_mov_b64 exec, -1
    s_waitcnt lgkmcnt(7)
    v_add_f32 v16, v64, v16
    v_add_f32 v17, v65, v17
    v_add_f32 v18, v66, v18
    v_add_f32 v19, v67, v19
    v_add_f32 v20, v68, v20
    v_add_f32 v21, v69, v21
    v_add_f32 v22, v70, v22
    v_add_f32 v23, v71, v23
    v_add_f32 v32, v80, v32
    v_add_f32 v33, v81, v33
    v_add_f32 v34, v82, v34
    v_add_f32 v35, v83, v35
    v_add_f32 v36, v84, v36
    v_add_f32 v37, v85, v37
    v_add_f32 v38, v86, v38
    v_add_f32 v39, v87, v39
    v_add_f32 v48, v96, v48
    v_add_f32 v49, v97, v49
    v_add_f32 v50, v98, v50
    v_add_f32 v51, v99, v51
    v_add_f32 v52, v100, v52
    v_add_f32 v53, v101, v53
    v_add_f32 v54, v102, v54
    v_add_f32 v55, v103, v55
    s_mov_b32 s47, 0x40000
sbw_11:
    ds_read_b32 v9, v255 offset:0
    s_sub_u32 s47, s47, 1
    s_waitcnt lgkmcnt(0)
    v_cmp_gt_u32 vcc, 4, v9
    s_cbranch_scc1 sbw_11_x
    s_cbranch_vccnz sbw_11
sbw_11_x:
    ds_read_b128 v[24:27], v247 offset:2048
    ds_read_b128 v[28:31], v247 offset:3072
    ds_read_b128 v[40:43], v247 offset:6144
    ds_read_b128 v[44:47], v247 offset:7168
    ds_read_b128 v[56:59], v247 offset:10240
    ds_read_b128 v[60:63], v247 offset:11264
    s_waitcnt lgkmcnt(5)
    v_add_f32 v216, v24, v16
    v_add_f32 v217, v25, v17
    v_add_f32 v218, v26, v18
    v_add_f32 v219, v27, v19
    s_waitcnt lgkmcnt(4)
    v_add_f32 v220, v28, v20
    v_add_f32 v221, v29, v21
    v_add_f32 v222, v30, v22
    v_add_f32 v223, v31, v23
    s_waitcnt lgkmcnt(3)
    v_add_f32 v224, v40, v32
    v_add_f32 v225, v41, v33
    v_add_f32 v226, v42, v34
    v_add_f32 v227, v43, v35
    s_waitcnt lgkmcnt(2)
    v_add_f32 v228, v44, v36
    v_add_f32 v229, v45, v37
    v_add_f32 v230, v46, v38
    v_add_f32 v231, v47, v39
    s_waitcnt lgkmcnt(1)
    v_add_f32 v232, v56, v48
    v_add_f32 v233, v57, v49
    v_add_f32 v234, v58, v50
    v_add_f32 v235, v59, v51
    s_waitcnt lgkmcnt(0)
    v_add_f32 v236, v60, v52
    v_add_f32 v237, v61, v53
    v_add_f32 v238, v62, v54
    v_add_f32 v239, v63, v55
    s_add_u32 m0, s60, 0
    s_add_u32 s44, s61, 0
    buffer_load_dwordx4 v240, s[16:19], s44 offen offset:0 lds
    buffer_load_dwordx4 v241, s[16:19], s44 offen offset:1024 lds
    buffer_load_dwordx4 v242, s[16:19], s44 offen offset:2048 lds
    s_add_u32 m0, s60, 3072
    s_add_u32 s44, s61, 49152
    buffer_load_dwordx4 v240, s[16:19], s44 offen offset:0 lds
    buffer_load_dwordx4 v241, s[16:19], s44 offen offset:1024 lds
    buffer_load_dwordx4 v242, s[16:19], s44 offen offset:2048 lds
    s_add_u32 m0, s60, 6144
    s_add_u32 s44, s61, 98304
    buffer_load_dwordx4 v240, s[16:19], s44 offen offset:0 lds
    buffer_load_dwordx4 v241, s[16:19], s44 offen offset:1024 lds
    buffer_load_dwordx4 v242, s[16:19], s44 offen offset:2048 lds
    s_add_u32 m0, s60, 9216
    s_add_u32 s44, s61, 147456
    buffer_load_dwordx4 v240, s[16:19], s44 offen offset:0 lds
    buffer_load_dwordx4 v241, s[16:19], s44 offen offset:1024 lds
    buffer_load_dwordx4 v242, s[16:19], s44 offen offset:2048 lds
    buffer_load_ushort v248, v248, s[24:27], 0 offen
    s_xor_b32 s44, s42, 0
    s_mul_i32 s24, s44, 18432
    s_xor_b32 s44, s42, 1
    s_mul_i32 s25, s44, 18432
    s_xor_b32 s44, s42, 2
    s_mul_i32 s26, s44, 18432
    s_xor_b32 s44, s42, 3
    s_mul_i32 s27, s44, 18432
    v_mov_b32 v24, 0xc0135761
    v_mov_b32 v25, 0xc0135761
    v_mul_f32 v16, v216, v216
    v_mul_f32 v17, v217, v217
    v_mul_f32 v18, v218, v218
    v_mul_f32 v19, v219, v219
    v_mul_f32 v20, v220, v220
    v_mul_f32 v21, v221, v221
    v_mul_f32 v22, v222, v222
    v_mul_f32 v23, v223, v223
    v_fma_f32 v16, v16, s58, v24
    v_fma_f32 v17, v17, s59, v25
    v_fma_f32 v18, v18, s58, v24
    v_fma_f32 v19, v19, s59, v25
    v_fma_f32 v20, v20, s58, v24
    v_fma_f32 v21, v21, s59, v25
    v_fma_f32 v22, v22, s58, v24
    v_fma_f32 v23, v23, s59, v25
    v_mul_f32 v16, v216, v16
    v_mul_f32 v17, v217, v17
    v_mul_f32 v18, v218, v18
    v_mul_f32 v19, v219, v19
    v_mul_f32 v20, v220, v20
    v_mul_f32 v21, v221, v21
    v_mul_f32 v22, v222, v22
    v_mul_f32 v23, v223, v23
    v_exp_f32 v16, v16
    v_exp_f32 v17, v17
    v_exp_f32 v18, v18
    v_exp_f32 v19, v19
    v_exp_f32 v20, v20
    v_exp_f32 v21, v21
    v_exp_f32 v22, v22
    v_exp_f32 v23, v23
    v_add_f32 v16, 1.0, v16
    v_add_f32 v17, 1.0, v17
    v_add_f32 v18, 1.0, v18
    v_add_f32 v19, 1.0, v19
    v_add_f32 v20, 1.0, v20
    v_add_f32 v21, 1.0, v21
    v_add_f32 v22, 1.0, v22
    v_add_f32 v23, 1.0, v23
    v_rcp_f32 v16, v16
    v_rcp_f32 v17, v17
    v_rcp_f32 v18, v18
    v_rcp_f32 v19, v19
    v_rcp_f32 v20, v20
    v_rcp_f32 v21, v21
    v_rcp_f32 v22, v22
    v_rcp_f32 v23, v23
    v_mul_f32 v216, v216, v16
    v_mul_f32 v217, v217, v17
    v_mul_f32 v218, v218, v18
    v_mul_f32 v219, v219, v19
    v_mul_f32 v220, v220, v20
    v_mul_f32 v221, v221, v21
    v_mul_f32 v222, v222, v22
    v_mul_f32 v223, v223, v23
    v_mul_f32 v16, v224, v224
    v_mul_f32 v17, v225, v225
    v_mul_f32 v18, v226, v226
    v_mul_f32 v19, v227, v227
    v_mul_f32 v20, v228, v228
    v_mul_f32 v21, v229, v229
    v_mul_f32 v22, v230, v230
    v_mul_f32 v23, v231, v231
    v_fma_f32 v16, v16, s58, v24
    v_fma_f32 v17, v17, s59, v25
    v_fma_f32 v18, v18, s58, v24
    v_fma_f32 v19, v19, s59, v25
    v_fma_f32 v20, v20, s58, v24
    v_fma_f32 v21, v21, s59, v25
    v_fma_f32 v22, v22, s58, v24
    v_fma_f32 v23, v23, s59, v25
    v_mul_f32 v16, v224, v16
    v_mul_f32 v17, v225, v17
    v_mul_f32 v18, v226, v18
    v_mul_f32 v19, v227, v19
    v_mul_f32 v20, v228, v20
    v_mul_f32 v21, v229, v21
    v_mul_f32 v22, v230, v22
    v_mul_f32 v23, v231, v23
    v_exp_f32 v16, v16
    v_exp_f32 v17, v17
    v_exp_f32 v18, v18
    v_exp_f32 v19, v19
    v_exp_f32 v20, v20
    v_exp_f32 v21, v21
    v_exp_f32 v22, v22
    v_exp_f32 v23, v23
    v_add_f32 v16, 1.0, v16
    v_add_f32 v17, 1.0, v17
    v_add_f32 v18, 1.0, v18
    v_add_f32 v19, 1.0, v19
    v_add_f32 v20, 1.0, v20
    v_add_f32 v21, 1.0, v21
    v_add_f32 v22, 1.0, v22
    v_add_f32 v23, 1.0, v23
    v_rcp_f32 v16, v16
    v_rcp_f32 v17, v17
    v_rcp_f32 v18, v18
    v_rcp_f32 v19, v19
    v_rcp_f32 v20, v20
    v_rcp_f32 v21, v21
    v_rcp_f32 v22, v22
    v_rcp_f32 v23, v23
    v_mul_f32 v224, v224, v16
    v_mul_f32 v225, v225, v17
    v_mul_f32 v226, v226, v18
    v_mul_f32 v227, v227, v19
    v_mul_f32 v228, v228, v20
    v_mul_f32 v229, v229, v21
    v_mul_f32 v230, v230, v22
    v_mul_f32 v231, v231, v23
    v_mul_f32 v16, v232, v232
    v_mul_f32 v17, v233, v233
    v_mul_f32 v18, v234, v234
    v_mul_f32 v19, v235, v235
    v_mul_f32 v20, v236, v236
    v_mul_f32 v21, v237, v237
    v_mul_f32 v22, v238, v238
    v_mul_f32 v23, v239, v239
    v_fma_f32 v16, v16, s58, v24
    v_fma_f32 v17, v17, s59, v25
    v_fma_f32 v18, v18, s58, v24
    v_fma_f32 v19, v19, s59, v25
    v_fma_f32 v20, v20, s58, v24
    v_fma_f32 v21, v21, s59, v25
    v_fma_f32 v22, v22, s58, v24
    v_fma_f32 v23, v23, s59, v25
    v_mul_f32 v16, v232, v16
    v_mul_f32 v17, v233, v17
    v_mul_f32 v18, v234, v18
    v_mul_f32 v19, v235, v19
    v_mul_f32 v20, v236, v20
    v_mul_f32 v21, v237, v21
    v_mul_f32 v22, v238, v22
    v_mul_f32 v23, v239, v23
    v_exp_f32 v16, v16
    v_exp_f32 v17, v17
    v_exp_f32 v18, v18
    v_exp_f32 v19, v19
    v_exp_f32 v20, v20
    v_exp_f32 v21, v21
    v_exp_f32 v22, v22
    v_exp_f32 v23, v23
    v_add_f32 v16, 1.0, v16
    v_add_f32 v17, 1.0, v17
    v_add_f32 v18, 1.0, v18
    v_add_f32 v19, 1.0, v19
    v_add_f32 v20, 1.0, v20
    v_add_f32 v21, 1.0, v21
    v_add_f32 v22, 1.0, v22
    v_add_f32 v23, 1.0, v23
    v_rcp_f32 v16, v16
    v_rcp_f32 v17, v17
    v_rcp_f32 v18, v18
    v_rcp_f32 v19, v19
    v_rcp_f32 v20, v20
    v_rcp_f32 v21, v21
    v_rcp_f32 v22, v22
    v_rcp_f32 v23, v23
    v_mul_f32 v232, v232, v16
    v_mul_f32 v233, v233, v17
    v_mul_f32 v234, v234, v18
    v_mul_f32 v235, v235, v19
    v_mul_f32 v236, v236, v20
    v_mul_f32 v237, v237, v21
    v_mul_f32 v238, v238, v22
    v_mul_f32 v239, v239, v23
    v_add_f32 v16, v224, v216
    v_add_f32 v17, v225, v217
    v_mul_f32 v24, v216, v216
    v_mul_f32 v25, v217, v217
    v_add_f32 v18, v226, v218
    v_add_f32 v19, v227, v219
    v_mul_f32 v26, v218, v218
    v_mul_f32 v27, v219, v219
    v_add_f32 v20, v228, v220
    v_add_f32 v21, v229, v221
    v_mul_f32 v28, v220, v220
    v_mul_f32 v29, v221, v221
    v_add_f32 v22, v230, v222
    v_add_f32 v23, v231, v223
    v_mul_f32 v30, v222, v222
    v_mul_f32 v31, v223, v223
    v_add_f32 v16, v232, v16
    v_add_f32 v17, v233, v17
    v_fmac_f32 v24, v224, v224
    v_fmac_f32 v25, v225, v225
    v_add_f32 v18, v234, v18
    v_add_f32 v19, v235, v19
    v_fmac_f32 v26, v226, v226
    v_fmac_f32 v27, v227, v227
    v_add_f32 v20, v236, v20
    v_add_f32 v21, v237, v21
    v_fmac_f32 v28, v228, v228
    v_fmac_f32 v29, v229, v229
    v_add_f32 v22, v238, v22
    v_add_f32 v23, v239, v23
    v_fmac_f32 v30, v230, v230
    v_fmac_f32 v31, v231, v231
    v_fmac_f32 v24, v232, v232
    v_fmac_f32 v25, v233, v233
    v_fmac_f32 v26, v234, v234
    v_fmac_f32 v27, v235, v235
    v_fmac_f32 v28, v236, v236
    v_fmac_f32 v29, v237, v237
    v_fmac_f32 v30, v238, v238
    v_fmac_f32 v31, v239, v239
    v_permlane16_swap_b32 v16, v20
    v_permlane16_swap_b32 v17, v21
    v_permlane16_swap_b32 v18, v22
    v_permlane16_swap_b32 v19, v23
    v_permlane16_swap_b32 v24, v28
    v_permlane16_swap_b32 v25, v29
    v_permlane16_swap_b32 v26, v30
    v_permlane16_swap_b32 v27, v31
    v_add_f32 v16, v20, v16
    v_add_f32 v17, v21, v17
    v_add_f32 v18, v22, v18
    v_add_f32 v19, v23, v19
    v_add_f32 v24, v28, v24
    v_add_f32 v25, v29, v25
    v_add_f32 v26, v30, v26
    v_add_f32 v27, v31, v27
    s_lshl_b32 s45, s40, 2
    s_add_u32 s45, s45, s42
    v_add_f32_dpp v20, v16, v16 row_ror:8 row_mask:0xf bank_mask:0x3
    v_add_f32_dpp v21, v17, v17 row_ror:8 row_mask:0xf bank_mask:0x3
    v_add_f32_dpp v28, v24, v24 row_ror:8 row_mask:0xf bank_mask:0x3
    v_add_f32_dpp v29, v25, v25 row_ror:8 row_mask:0xf bank_mask:0x3
    v_add_f32_dpp v20, v18, v18 row_ror:8 row_mask:0xf bank_mask:0xc
    v_add_f32_dpp v21, v19, v19 row_ror:8 row_mask:0xf bank_mask:0xc
    v_add_f32_dpp v28, v26, v26 row_ror:8 row_mask:0xf bank_mask:0xc
    v_add_f32_dpp v29, v27, v27 row_ror:8 row_mask:0xf bank_mask:0xc
    s_lshl_b32 s46, s45, 11
    s_add_u32 s46, s46, 3145728
    v_add_f32_dpp v16, v20, v20 row_half_mirror row_mask:0xf bank_mask:0x5
    v_add_f32_dpp v18, v28, v28 row_half_mirror row_mask:0xf bank_mask:0x5
    v_mov_b32 v17, s43
    v_add_f32_dpp v16, v21, v21 row_half_mirror row_mask:0xf bank_mask:0xa
    v_add_f32_dpp v18, v29, v29 row_half_mirror row_mask:0xf bank_mask:0xa
    v_mov_b32 v19, s43
    v_add_f32_dpp v16, v16, v16 quad_perm:[1,0,3,2] row_mask:0xf bank_mask:0xf
    v_add_f32_dpp v18, v18, v18 quad_perm:[1,0,3,2] row_mask:0xf bank_mask:0xf
    v_lshlrev_b32 v20, 2, v0
    v_add_f32_dpp v16, v16, v16 quad_perm:[2,3,0,1] row_mask:0xf bank_mask:0xf
    v_add_f32_dpp v18, v18, v18 quad_perm:[2,3,0,1] row_mask:0xf bank_mask:0xf
    s_lshl_b32 s44, s41, 8
    s_add_u32 s44, s44, s46
    s_mov_b32 exec_lo, 0x11111111
    s_mov_b32 exec_hi, 0x11111111
    buffer_store_dwordx4 v[16:19], v20, s[8:11], s44 offen sc1
    s_mov_b64 exec, -1
    s_setprio 0
    s_and_b32 s44, s40, 3
    s_lshl2_add_u32 s97, s41, s44
    s_mul_i32 s97, s97, 352
    s_and_b32 s13, s40, 28
    s_add_u32 s12, s13, s42
    s_mul_i32 s12, s12, 6
    s_add_u32 s96, s97, s12
    s_mul_i32 s96, s96, 160
    s_add_u32 s96, s96, 262144
    s_mul_i32 vcc_lo, s44, 192
    s_add_u32 s12, s12, vcc_lo
    s_lshl3_add_u32 s12, s12, s41
    s_mul_i32 s12, s12, 160
    s_mul_i32 s44, s44, 160
    s_mul_i32 vcc_lo, s13, 5
    s_add_u32 s44, s44, vcc_lo
    s_mul_i32 vcc_lo, s42, 6
    s_min_u32 vcc_lo, vcc_lo, 16
    s_add_u32 s44, s44, vcc_lo
    s_lshl2_add_u32 vcc_lo, s13, vcc_lo
    s_add_u32 vcc_lo, vcc_lo, 192
    s_lshr_b32 vcc_hi, 0x75643120, s13
    s_and_b32 vcc_hi, vcc_hi, 7
    s_lshl2_add_u32 vcc_hi, vcc_hi, 320
    s_cmp_eq_u32 s42, 3
    s_cselect_b32 vcc_lo, vcc_hi, vcc_lo
    s_add_u32 s97, s97, vcc_lo
    s_mul_i32 s97, s97, 160
    s_add_u32 s97, s97, 262144
    s_lshl3_add_u32 s13, s44, s41
    s_mul_i32 s13, s13, 160
    s_mov_b32 s47, 0x40000
sbw_12:
    ds_read_b32 v9, v11 offset:0
    s_sub_u32 s47, s47, 1
    s_waitcnt lgkmcnt(0)
    v_cmp_gt_u32 vcc, 3, v9
    s_cbranch_scc1 sbw_12_x
    s_cbranch_vccnz sbw_12
sbw_12_x:
    s_add_u32 s52, s52, 1
    s_and_b32 s52, s52, 7
    s_lshl_b32 s44, s52, 9
    s_add_u32 s56, s54, s44
    s_add_u32 s57, s55, s44
    s_add_u32 m0, s48, 0
    s_add_u32 s44, s56, 0
    buffer_load_dwordx4 v2, s[20:23], s44 offen lds
    s_add_u32 m0, s48, 1024
    s_add_u32 s44, s56, 32768
    buffer_load_dwordx4 v3, s[20:23], s44 offen lds
    s_add_u32 m0, s48, 2048
    s_add_u32 s44, s56, 65536
    buffer_load_dwordx4 v2, s[20:23], s44 offen lds
    s_add_u32 m0, s48, 3072
    s_add_u32 s44, s56, 98304
    buffer_load_dwordx4 v3, s[20:23], s44 offen lds
    s_add_u32 m0, s48, 4096
    s_add_u32 s44, s57, 0
    buffer_load_dwordx4 v2, s[20:23], s44 offen lds
    s_add_u32 m0, s48, 5120
    s_add_u32 s44, s57, 32768
    buffer_load_dwordx4 v3, s[20:23], s44 offen lds
    s_waitcnt vmcnt(17)
    ds_read_b64_tr_b16 v[192:193], v8 offset:0
    ds_read_b64_tr_b16 v[194:195], v8 offset:768
    ds_read_b64_tr_b16 v[196:197], v8 offset:64
    ds_read_b64_tr_b16 v[198:199], v8 offset:832
    ds_read_b64_tr_b16 v[200:201], v8 offset:128
    ds_read_b64_tr_b16 v[202:203], v8 offset:896
    s_waitcnt lgkmcnt(0)
    v_mfma_f32_32x32x16_bf16 v[64:79], v[192:195], v[116:119], 0
    s_waitcnt vmcnt(14)
    ds_read_b64_tr_b16 v[204:205], v8 offset:3072
    ds_read_b64_tr_b16 v[206:207], v8 offset:3840
    ds_read_b64_tr_b16 v[208:209], v8 offset:3136
    ds_read_b64_tr_b16 v[210:211], v8 offset:3904
    ds_read_b64_tr_b16 v[212:213], v8 offset:3200
    ds_read_b64_tr_b16 v[214:215], v8 offset:3968
    v_mfma_f32_32x32x16_bf16 v[16:31], v[192:195], v[112:115], 0
    s_add_u32 m0, s60, 0
    s_add_u32 s44, s61, 196608
    buffer_load_dwordx4 v240, s[16:19], s44 offen offset:0 lds
    v_mfma_f32_32x32x16_bf16 v[80:95], v[196:199], v[116:119], 0
    buffer_load_dwordx4 v241, s[16:19], s44 offen offset:1024 lds
    v_mfma_f32_32x32x16_bf16 v[32:47], v[196:199], v[112:115], 0
    buffer_load_dwordx4 v242, s[16:19], s44 offen offset:2048 lds
    v_mfma_f32_32x32x16_bf16 v[96:111], v[200:203], v[116:119], 0
    v_mfma_f32_32x32x16_bf16 v[48:63], v[200:203], v[112:115], 0
    s_waitcnt lgkmcnt(0)
    v_mfma_f32_32x32x16_bf16 v[64:79], v[204:207], v[124:127], v[64:79]
    s_waitcnt vmcnt(14)
    ds_read_b64_tr_b16 v[192:193], v8 offset:6144
    ds_read_b64_tr_b16 v[194:195], v8 offset:6912
    ds_read_b64_tr_b16 v[196:197], v8 offset:6208
    ds_read_b64_tr_b16 v[198:199], v8 offset:6976
    ds_read_b64_tr_b16 v[200:201], v8 offset:6272
    ds_read_b64_tr_b16 v[202:203], v8 offset:7040
    v_mfma_f32_32x32x16_bf16 v[16:31], v[204:207], v[120:123], v[16:31]
    s_add_u32 m0, s60, 3072
    s_add_u32 s44, s61, 245760
    buffer_load_dwordx4 v240, s[16:19], s44 offen offset:0 lds
    v_mfma_f32_32x32x16_bf16 v[80:95], v[208:211], v[124:127], v[80:95]
    buffer_load_dwordx4 v241, s[16:19], s44 offen offset:1024 lds
    v_mfma_f32_32x32x16_bf16 v[32:47], v[208:211], v[120:123], v[32:47]
    buffer_load_dwordx4 v242, s[16:19], s44 offen offset:2048 lds
    v_mfma_f32_32x32x16_bf16 v[96:111], v[212:215], v[124:127], v[96:111]
    v_mfma_f32_32x32x16_bf16 v[48:63], v[212:215], v[120:123], v[48:63]
    s_waitcnt lgkmcnt(0)
    v_mfma_f32_32x32x16_bf16 v[64:79], v[192:195], v[132:135], v[64:79]
    s_waitcnt vmcnt(14)
    ds_read_b64_tr_b16 v[204:205], v8 offset:9216
    ds_read_b64_tr_b16 v[206:207], v8 offset:9984
    ds_read_b64_tr_b16 v[208:209], v8 offset:9280
    ds_read_b64_tr_b16 v[210:211], v8 offset:10048
    ds_read_b64_tr_b16 v[212:213], v8 offset:9344
    ds_read_b64_tr_b16 v[214:215], v8 offset:10112
    v_mfma_f32_32x32x16_bf16 v[16:31], v[192:195], v[128:131], v[16:31]
    s_add_u32 m0, s60, 6144
    s_add_u32 s44, s61, 294912
    buffer_load_dwordx4 v240, s[16:19], s44 offen offset:0 lds
    v_mfma_f32_32x32x16_bf16 v[80:95], v[196:199], v[132:135], v[80:95]
    buffer_load_dwordx4 v241, s[16:19], s44 offen offset:1024 lds
    v_mfma_f32_32x32x16_bf16 v[32:47], v[196:199], v[128:131], v[32:47]
    buffer_load_dwordx4 v242, s[16:19], s44 offen offset:2048 lds
    v_mfma_f32_32x32x16_bf16 v[96:111], v[200:203], v[132:135], v[96:111]
    v_mfma_f32_32x32x16_bf16 v[48:63], v[200:203], v[128:131], v[48:63]
    s_waitcnt lgkmcnt(0)
    v_mfma_f32_32x32x16_bf16 v[64:79], v[204:207], v[140:143], v[64:79]
    s_waitcnt vmcnt(6)
    ds_read_b64_tr_b16 v[192:193], v8 offset:0
    ds_read_b64_tr_b16 v[194:195], v8 offset:768
    ds_read_b64_tr_b16 v[196:197], v8 offset:64
    ds_read_b64_tr_b16 v[198:199], v8 offset:832
    ds_read_b64_tr_b16 v[200:201], v8 offset:128
    ds_read_b64_tr_b16 v[202:203], v8 offset:896
    v_mfma_f32_32x32x16_bf16 v[16:31], v[204:207], v[136:139], v[16:31]
    s_add_u32 m0, s60, 9216
    s_add_u32 s44, s61, 344064
    buffer_load_dwordx4 v240, s[16:19], s44 offen offset:0 lds
    v_mfma_f32_32x32x16_bf16 v[80:95], v[208:211], v[140:143], v[80:95]
    buffer_load_dwordx4 v241, s[16:19], s44 offen offset:1024 lds
    v_mfma_f32_32x32x16_bf16 v[32:47], v[208:211], v[136:139], v[32:47]
    buffer_load_dwordx4 v242, s[16:19], s44 offen offset:2048 lds
    v_mfma_f32_32x32x16_bf16 v[96:111], v[212:215], v[140:143], v[96:111]
    v_mfma_f32_32x32x16_bf16 v[48:63], v[212:215], v[136:139], v[48:63]
    s_movk_i32 s47, 0x4000
poll_13:
    buffer_load_dwordx4 v[112:115], v1, s[8:11], s46 offen offset:0 sc1
    buffer_load_dwordx4 v[116:119], v1, s[8:11], s46 offen offset:1024 sc1
    s_sub_u32 s47, s47, 1
    s_cbranch_scc1 poll_13_x
    s_waitcnt vmcnt(0)
    v_xor_b32 v113, s43, v113
    v_xor_b32 v115, s43, v115
    v_xor_b32 v117, s43, v117
    v_xor_b32 v119, s43, v119
    v_or3_b32 v113, v113, v115, v117
    v_or_b32 v113, v113, v119
    v_cmp_ne_u32 vcc, 0, v113
    s_cbranch_vccnz poll_13
poll_13_x:
    s_waitcnt vmcnt(0)
    s_setprio 1
    v_add_f32 v112, v112, v116
    v_add_f32 v113, v114, v118
    v_mov_b32 v114, v112
    v_mov_b32 v115, v113
    s_nop 0
    v_permlane32_swap_b32 v112, v114
    v_permlane32_swap_b32 v113, v115
    v_add_f32 v112, v112, v114
    v_add_f32 v113, v113, v115
    v_mov_b32 v114, v112
    v_mov_b32 v115, v113
    s_nop 0
    v_permlane16_swap_b32 v112, v114
    v_permlane16_swap_b32 v113, v115
    v_add_f32 v112, v112, v114
    v_add_f32 v113, v113, v115
    v_mul_f32 v112, 0x3aaaaaab, v112
    v_mul_f32 v113, 0x3aaaaaab, v113
    v_fma_f32 v113, -v112, v112, v113
    v_max_f32 v113, 0, v113
    v_add_f32 v113, 0x3727c5ac, v113
    v_rsq_f32 v113, v113
    v_and_b32 v14, 31, v0
    v_mul_f32_e64 v112, -v112, v113
    v_lshlrev_b32 v14, 2, v14
    v_mov_b32_dpp v113, v113 row_ror:8 row_mask:0xc bank_mask:0xf
    v_mov_b32_dpp v112, v112 row_ror:8 row_mask:0xc bank_mask:0xf
    s_nop 0
    v_mov_b32_dpp v114, v113 row_newbcast:0 row_mask:0xf bank_mask:0xf
    v_mov_b32_dpp v122, v112 row_newbcast:0 row_mask:0xf bank_mask:0xf
    v_mov_b32_dpp v115, v113 row_newbcast:1 row_mask:0xf bank_mask:0xf
    v_mov_b32_dpp v123, v112 row_newbcast:1 row_mask:0xf bank_mask:0xf
    v_mov_b32_dpp v116, v113 row_newbcast:2 row_mask:0xf bank_mask:0xf
    v_mov_b32_dpp v124, v112 row_newbcast:2 row_mask:0xf bank_mask:0xf
    v_mov_b32_dpp v117, v113 row_newbcast:3 row_mask:0xf bank_mask:0xf
    v_mov_b32_dpp v125, v112 row_newbcast:3 row_mask:0xf bank_mask:0xf
    v_mov_b32_dpp v118, v113 row_newbcast:4 row_mask:0xf bank_mask:0xf
    v_mov_b32_dpp v126, v112 row_newbcast:4 row_mask:0xf bank_mask:0xf
    v_mov_b32_dpp v119, v113 row_newbcast:5 row_mask:0xf bank_mask:0xf
    v_mov_b32_dpp v127, v112 row_newbcast:5 row_mask:0xf bank_mask:0xf
    v_mov_b32_dpp v120, v113 row_newbcast:6 row_mask:0xf bank_mask:0xf
    v_mov_b32_dpp v128, v112 row_newbcast:6 row_mask:0xf bank_mask:0xf
    v_mov_b32_dpp v121, v113 row_newbcast:7 row_mask:0xf bank_mask:0xf
    v_mov_b32_dpp v129, v112 row_newbcast:7 row_mask:0xf bank_mask:0xf
    v_fma_f32 v216, v216, v114, v122
    v_fma_f32 v217, v217, v115, v123
    v_fma_f32 v218, v218, v116, v124
    v_fma_f32 v219, v219, v117, v125
    v_fma_f32 v220, v220, v118, v126
    v_fma_f32 v221, v221, v119, v127
    v_fma_f32 v222, v222, v120, v128
    v_fma_f32 v223, v223, v121, v129
    v_cvt_pk_bf16_f32 v132, v216, v217
    v_cvt_pk_bf16_f32 v133, v218, v219
    v_cvt_pk_bf16_f32 v134, v220, v221
    v_cvt_pk_bf16_f32 v135, v222, v223
    buffer_store_dwordx4 v[132:135], v1, s[8:11], s5 offen offset:0 sc1
    v_fma_f32 v224, v224, v114, v122
    v_fma_f32 v225, v225, v115, v123
    v_fma_f32 v226, v226, v116, v124
    v_fma_f32 v227, v227, v117, v125
    v_fma_f32 v228, v228, v118, v126
    v_fma_f32 v229, v229, v119, v127
    v_fma_f32 v230, v230, v120, v128
    v_fma_f32 v231, v231, v121, v129
    v_cvt_pk_bf16_f32 v136, v224, v225
    v_cvt_pk_bf16_f32 v137, v226, v227
    v_cvt_pk_bf16_f32 v138, v228, v229
    v_cvt_pk_bf16_f32 v139, v230, v231
    buffer_store_dwordx4 v[136:139], v1, s[8:11], s5 offen offset:1024 sc1
    v_fma_f32 v232, v232, v114, v122
    v_fma_f32 v233, v233, v115, v123
    v_fma_f32 v234, v234, v116, v124
    v_fma_f32 v235, v235, v117, v125
    v_fma_f32 v236, v236, v118, v126
    v_fma_f32 v237, v237, v119, v127
    v_fma_f32 v238, v238, v120, v128
    v_fma_f32 v239, v239, v121, v129
    v_cvt_pk_bf16_f32 v140, v232, v233
    v_cvt_pk_bf16_f32 v141, v234, v235
    v_cvt_pk_bf16_f32 v142, v236, v237
    v_cvt_pk_bf16_f32 v143, v238, v239
    buffer_store_dwordx4 v[140:143], v1, s[8:11], s5 offen offset:2048 sc1
    s_waitcnt lgkmcnt(0)
    v_mfma_f32_32x32x16_bf16 v[64:79], v[192:195], v[148:151], v[64:79]
    ds_read_b64_tr_b16 v[204:205], v8 offset:3072
    ds_read_b64_tr_b16 v[206:207], v8 offset:3840
    ds_read_b64_tr_b16 v[208:209], v8 offset:3136
    ds_read_b64_tr_b16 v[210:211], v8 offset:3904
    ds_read_b64_tr_b16 v[212:213], v8 offset:3200
    ds_read_b64_tr_b16 v[214:215], v8 offset:3968
    v_mfma_f32_32x32x16_bf16 v[16:31], v[192:195], v[144:147], v[16:31]
    s_add_u32 m0, s60, 0
    s_add_u32 s44, s61, 393216
    buffer_load_dwordx4 v240, s[16:19], s44 offen offset:0 lds
    v_mfma_f32_32x32x16_bf16 v[80:95], v[196:199], v[148:151], v[80:95]
    buffer_load_dwordx4 v241, s[16:19], s44 offen offset:1024 lds
    v_mfma_f32_32x32x16_bf16 v[32:47], v[196:199], v[144:147], v[32:47]
    buffer_load_dwordx4 v242, s[16:19], s44 offen offset:2048 lds
    v_mfma_f32_32x32x16_bf16 v[96:111], v[200:203], v[148:151], v[96:111]
    v_mfma_f32_32x32x16_bf16 v[48:63], v[200:203], v[144:147], v[48:63]
    s_waitcnt lgkmcnt(0)
    v_mfma_f32_32x32x16_bf16 v[64:79], v[204:207], v[156:159], v[64:79]
    ds_read_b64_tr_b16 v[192:193], v8 offset:6144
    ds_read_b64_tr_b16 v[194:195], v8 offset:6912
    ds_read_b64_tr_b16 v[196:197], v8 offset:6208
    ds_read_b64_tr_b16 v[198:199], v8 offset:6976
    ds_read_b64_tr_b16 v[200:201], v8 offset:6272
    ds_read_b64_tr_b16 v[202:203], v8 offset:7040
    v_mfma_f32_32x32x16_bf16 v[16:31], v[204:207], v[152:155], v[16:31]
    s_add_u32 m0, s60, 3072
    s_add_u32 s44, s61, 442368
    buffer_load_dwordx4 v240, s[16:19], s44 offen offset:0 lds
    v_mfma_f32_32x32x16_bf16 v[80:95], v[208:211], v[156:159], v[80:95]
    buffer_load_dwordx4 v241, s[16:19], s44 offen offset:1024 lds
    v_mfma_f32_32x32x16_bf16 v[32:47], v[208:211], v[152:155], v[32:47]
    buffer_load_dwordx4 v242, s[16:19], s44 offen offset:2048 lds
    v_mfma_f32_32x32x16_bf16 v[96:111], v[212:215], v[156:159], v[96:111]
    v_mfma_f32_32x32x16_bf16 v[48:63], v[212:215], v[152:155], v[48:63]
    s_waitcnt lgkmcnt(0)
    v_mfma_f32_32x32x16_bf16 v[64:79], v[192:195], v[164:167], v[64:79]
    ds_read_b64_tr_b16 v[204:205], v8 offset:9216
    ds_read_b64_tr_b16 v[206:207], v8 offset:9984
    ds_read_b64_tr_b16 v[208:209], v8 offset:9280
    ds_read_b64_tr_b16 v[210:211], v8 offset:10048
    ds_read_b64_tr_b16 v[212:213], v8 offset:9344
    ds_read_b64_tr_b16 v[214:215], v8 offset:10112
    v_mfma_f32_32x32x16_bf16 v[16:31], v[192:195], v[160:163], v[16:31]
    s_add_u32 m0, s48, 6144
    s_add_u32 s44, s57, 65536
    buffer_load_dwordx4 v2, s[20:23], s44 offen lds
    v_mfma_f32_32x32x16_bf16 v[80:95], v[196:199], v[164:167], v[80:95]
    s_add_u32 m0, s48, 7168
    s_add_u32 s44, s57, 98304
    buffer_load_dwordx4 v3, s[20:23], s44 offen lds
    v_mfma_f32_32x32x16_bf16 v[32:47], v[196:199], v[160:163], v[32:47]
    s_add_u32 s52, s52, 1
    s_and_b32 s52, s52, 7
    s_lshl_b32 s44, s52, 9
    s_add_u32 s56, s54, s44
    s_add_u32 s57, s55, s44
    s_add_u32 m0, s48, 8192
    s_add_u32 s44, s56, 0
    buffer_load_dwordx4 v2, s[20:23], s44 offen lds
    v_mfma_f32_32x32x16_bf16 v[96:111], v[200:203], v[164:167], v[96:111]
    s_add_u32 m0, s48, 9216
    s_add_u32 s44, s56, 32768
    buffer_load_dwordx4 v3, s[20:23], s44 offen lds
    v_mfma_f32_32x32x16_bf16 v[48:63], v[200:203], v[160:163], v[48:63]
    s_add_u32 m0, s48, 10240
    s_add_u32 s44, s56, 65536
    buffer_load_dwordx4 v2, s[20:23], s44 offen lds
    s_waitcnt lgkmcnt(0)
    s_waitcnt vmcnt(11)
    v_mov_b32 v12, 0
    v_mov_b32 v13, s43
    s_mov_b64 exec, 1
    buffer_store_dword v13, v12, s[8:11], s99 offen sc1
    s_mov_b64 exec, -1
    v_mfma_f32_32x32x16_bf16 v[64:79], v[204:207], v[172:175], v[64:79]
    s_waitcnt vmcnt(9)
    ds_read_b64_tr_b16 v[192:193], v8 offset:0
    ds_read_b64_tr_b16 v[194:195], v8 offset:768
    ds_read_b64_tr_b16 v[196:197], v8 offset:64
    ds_read_b64_tr_b16 v[198:199], v8 offset:832
    ds_read_b64_tr_b16 v[200:201], v8 offset:128
    ds_read_b64_tr_b16 v[202:203], v8 offset:896
    v_mfma_f32_32x32x16_bf16 v[16:31], v[204:207], v[168:171], v[16:31]
    s_add_u32 m0, s48, 11264
    s_add_u32 s44, s56, 98304
    buffer_load_dwordx4 v3, s[20:23], s44 offen lds
    v_mfma_f32_32x32x16_bf16 v[80:95], v[208:211], v[172:175], v[80:95]
    s_add_u32 m0, s48, 12288
    s_add_u32 s44, s57, 0
    buffer_load_dwordx4 v2, s[20:23], s44 offen lds
    v_mfma_f32_32x32x16_bf16 v[32:47], v[208:211], v[168:171], v[32:47]
    s_add_u32 m0, s48, 13312
    s_add_u32 s44, s57, 32768
    buffer_load_dwordx4 v3, s[20:23], s44 offen lds
    v_mfma_f32_32x32x16_bf16 v[96:111], v[212:215], v[172:175], v[96:111]
    s_add_u32 m0, s48, 14336
    s_add_u32 s44, s57, 65536
    buffer_load_dwordx4 v2, s[20:23], s44 offen lds
    v_mfma_f32_32x32x16_bf16 v[48:63], v[212:215], v[168:171], v[48:63]
    s_add_u32 m0, s48, 15360
    s_add_u32 s44, s57, 98304
    buffer_load_dwordx4 v3, s[20:23], s44 offen lds
    s_waitcnt lgkmcnt(0)
    v_mfma_f32_32x32x16_bf16 v[64:79], v[192:195], v[180:183], v[64:79]
    s_waitcnt vmcnt(11)
    ds_read_b64_tr_b16 v[204:205], v8 offset:3072
    ds_read_b64_tr_b16 v[206:207], v8 offset:3840
    ds_read_b64_tr_b16 v[208:209], v8 offset:3136
    ds_read_b64_tr_b16 v[210:211], v8 offset:3904
    ds_read_b64_tr_b16 v[212:213], v8 offset:3200
    ds_read_b64_tr_b16 v[214:215], v8 offset:3968
    v_mfma_f32_32x32x16_bf16 v[80:95], v[196:199], v[180:183], v[80:95]
    v_mfma_f32_32x32x16_bf16 v[96:111], v[200:203], v[180:183], v[96:111]
    s_waitcnt lgkmcnt(0)
    v_mfma_f32_32x32x16_bf16 v[64:79], v[204:207], v[188:191], v[64:79]
    v_mfma_f32_32x32x16_bf16 v[80:95], v[208:211], v[188:191], v[80:95]
    v_mfma_f32_32x32x16_bf16 v[96:111], v[212:215], v[188:191], v[96:111]
    v_mfma_f32_32x32x16_bf16 v[16:31], v[192:195], v[176:179], v[16:31]
    s_nop 8
    ds_write_b128 v247, v[64:67] offset:0
    ds_write_b128 v247, v[68:71] offset:1024
    v_mfma_f32_32x32x16_bf16 v[32:47], v[196:199], v[176:179], v[32:47]
    ds_write_b128 v247, v[72:75] offset:2048
    ds_write_b128 v247, v[76:79] offset:3072
    v_mfma_f32_32x32x16_bf16 v[48:63], v[200:203], v[176:179], v[48:63]
    ds_write_b128 v247, v[80:83] offset:4096
    ds_write_b128 v247, v[84:87] offset:5120
    v_mfma_f32_32x32x16_bf16 v[16:31], v[204:207], v[184:187], v[16:31]
    ds_write_b128 v247, v[88:91] offset:6144
    ds_write_b128 v247, v[92:95] offset:7168
    v_mfma_f32_32x32x16_bf16 v[32:47], v[208:211], v[184:187], v[32:47]
    ds_write_b128 v247, v[96:99] offset:8192
    ds_write_b128 v247, v[100:103] offset:9216
    v_mfma_f32_32x32x16_bf16 v[48:63], v[212:215], v[184:187], v[48:63]
    ds_write_b128 v247, v[104:107] offset:10240
    ds_write_b128 v247, v[108:111] offset:11264
    v_mov_b32 v9, 5
    s_mov_b64 exec, 1
    ds_write_b32 v254, v9 offset:0
    s_mov_b64 exec, -1
    s_mov_b32 s47, 0x40000
sbw_14:
    ds_read_b32 v9, v11 offset:0
    s_sub_u32 s47, s47, 1
    s_waitcnt lgkmcnt(0)
    v_cmp_gt_u32 vcc, 5, v9
    s_cbranch_scc1 sbw_14_x
    s_cbranch_vccnz sbw_14
sbw_14_x:
    ds_read_b32 v10, v10
    ds_read_b128 v[72:75], v245 offset:2048
    ds_read_b128 v[76:79], v245 offset:3072
    ds_read_b128 v[88:91], v245 offset:6144
    ds_read_b128 v[92:95], v245 offset:7168
    ds_read_b128 v[104:107], v245 offset:10240
    ds_read_b128 v[108:111], v245 offset:11264
    ds_read_b128 v[64:67], v245 offset:0
    ds_read_b128 v[68:71], v245 offset:1024
    ds_read_b128 v[80:83], v245 offset:4096
    ds_read_b128 v[84:87], v245 offset:5120
    ds_read_b128 v[96:99], v245 offset:8192
    ds_read_b128 v[100:103], v245 offset:9216
    s_waitcnt lgkmcnt(11)
    v_add_f32 v24, v72, v24
    v_add_f32 v25, v73, v25
    v_add_f32 v26, v74, v26
    v_add_f32 v27, v75, v27
    s_waitcnt lgkmcnt(10)
    v_add_f32 v28, v76, v28
    v_add_f32 v29, v77, v29
    v_add_f32 v30, v78, v30
    v_add_f32 v31, v79, v31
    s_waitcnt lgkmcnt(9)
    v_add_f32 v40, v88, v40
    v_add_f32 v41, v89, v41
    v_add_f32 v42, v90, v42
    v_add_f32 v43, v91, v43
    s_waitcnt lgkmcnt(8)
    v_add_f32 v44, v92, v44
    v_add_f32 v45, v93, v45
    v_add_f32 v46, v94, v46
    v_add_f32 v47, v95, v47
    s_waitcnt lgkmcnt(7)
    v_add_f32 v56, v104, v56
    v_add_f32 v57, v105, v57
    v_add_f32 v58, v106, v58
    v_add_f32 v59, v107, v59
    s_waitcnt lgkmcnt(6)
    v_add_f32 v60, v108, v60
    v_add_f32 v61, v109, v61
    v_add_f32 v62, v110, v62
    v_add_f32 v63, v111, v63
    ds_write_b128 v245, v[24:27] offset:2048
    ds_write_b128 v245, v[28:31] offset:3072
    ds_write_b128 v245, v[40:43] offset:6144
    ds_write_b128 v245, v[44:47] offset:7168
    ds_write_b128 v245, v[56:59] offset:10240
    ds_write_b128 v245, v[60:63] offset:11264
    v_mov_b32 v9, 6
    s_mov_b64 exec, 1
    ds_write_b32 v254, v9 offset:0
    s_mov_b64 exec, -1
    s_waitcnt lgkmcnt(7)
    v_add_f32 v16, v64, v16
    v_add_f32 v17, v65, v17
    v_add_f32 v18, v66, v18
    v_add_f32 v19, v67, v19
    v_add_f32 v20, v68, v20
    v_add_f32 v21, v69, v21
    v_add_f32 v22, v70, v22
    v_add_f32 v23, v71, v23
    v_add_f32 v32, v80, v32
    v_add_f32 v33, v81, v33
    v_add_f32 v34, v82, v34
    v_add_f32 v35, v83, v35
    v_add_f32 v36, v84, v36
    v_add_f32 v37, v85, v37
    v_add_f32 v38, v86, v38
    v_add_f32 v39, v87, v39
    v_add_f32 v48, v96, v48
    v_add_f32 v49, v97, v49
    v_add_f32 v50, v98, v50
    v_add_f32 v51, v99, v51
    v_add_f32 v52, v100, v52
    v_add_f32 v53, v101, v53
    v_add_f32 v54, v102, v54
    v_add_f32 v55, v103, v55
    s_mul_i32 s51, s50, 49152
    s_add_u32 s51, s51, s49
    s_lshl4_add_u32 s45, s50, s6
    s_sub_u32 s45, s45, 159760
    s_movk_i32 s47, 0x4000
poll_15:
    buffer_load_dword v15, v255, s[8:11], s45 offen sc1
    s_sub_u32 s47, s47, 1
    s_cbranch_scc1 poll_15_x
    s_waitcnt vmcnt(0)
    v_cmp_ne_u32 vcc, s43, v15
    s_cbranch_vccnz poll_15
poll_15_x:
    s_waitcnt vmcnt(0)
    buffer_load_dwordx4 v[112:115], v1, s[8:11], s51 offen offset:0 sc1
    buffer_load_dwordx4 v[116:119], v1, s[8:11], s51 offen offset:1024 sc1
    buffer_load_dwordx4 v[120:123], v1, s[8:11], s51 offen offset:2048 sc1
    s_add_u32 s51, s51, 3072
    buffer_load_dwordx4 v[124:127], v1, s[8:11], s51 offen offset:0 sc1
    buffer_load_dwordx4 v[128:131], v1, s[8:11], s51 offen offset:1024 sc1
    buffer_load_dwordx4 v[132:135], v1, s[8:11], s51 offen offset:2048 sc1
    s_add_u32 s51, s51, 3072
    buffer_load_dword v15, v14, s[8:11], s6 offen sc1
    s_mov_b32 s47, 0x40000
sbw_16:
    ds_read_b32 v9, v255 offset:0
    s_sub_u32 s47, s47, 1
    s_waitcnt lgkmcnt(0)
    v_cmp_gt_u32 vcc, 6, v9
    s_cbranch_scc1 sbw_16_x
    s_cbranch_vccnz sbw_16
sbw_16_x:
    ds_read_b128 v[24:27], v244 offset:2048
    ds_read_b128 v[28:31], v244 offset:3072
    ds_read_b128 v[40:43], v244 offset:6144
    ds_read_b128 v[44:47], v244 offset:7168
    ds_read_b128 v[56:59], v244 offset:10240
    ds_read_b128 v[60:63], v244 offset:11264
    s_waitcnt lgkmcnt(5)
    v_add_f32 v216, v24, v16
    v_add_f32 v217, v25, v17
    v_add_f32 v218, v26, v18
    v_add_f32 v219, v27, v19
    s_waitcnt lgkmcnt(4)
    v_add_f32 v220, v28, v20
    v_add_f32 v221, v29, v21
    v_add_f32 v222, v30, v22
    v_add_f32 v223, v31, v23
    s_waitcnt lgkmcnt(3)
    v_add_f32 v224, v40, v32
    v_add_f32 v225, v41, v33
    v_add_f32 v226, v42, v34
    v_add_f32 v227, v43, v35
    s_waitcnt lgkmcnt(2)
    v_add_f32 v228, v44, v36
    v_add_f32 v229, v45, v37
    v_add_f32 v230, v46, v38
    v_add_f32 v231, v47, v39
    s_waitcnt lgkmcnt(1)
    v_add_f32 v232, v56, v48
    v_add_f32 v233, v57, v49
    v_add_f32 v234, v58, v50
    v_add_f32 v235, v59, v51
    s_waitcnt lgkmcnt(0)
    v_add_f32 v236, v60, v52
    v_add_f32 v237, v61, v53
    v_add_f32 v238, v62, v54
    v_add_f32 v239, v63, v55
    v_mov_b32 v9, 7
    s_mov_b64 exec, 1
    ds_write_b32 v254, v9 offset:0
    s_mov_b64 exec, -1
    s_mov_b32 s44, 160256
    v_and_or_b32 v200, v0, 32, v243
    v_lshl_add_u32 v240, v0, 4, s44
    v_mov_b32 v214, v11
    ds_read_b64 v[250:251], v240 offset:1024
    ds_read_b64 v[246:247], v240 offset:1032
    v_lshlrev_b32 v241, 4, v0
    v_add_u32 v242, 4096, v14
    v_mov_b32 v202, 0x3e80
    v_mov_b32 v203, 0
    v_sub_f32 v10, 1.0, v10
    v_rcp_f32 v10, v10
    v_mfma_f32_32x32x8_bf16 v[16:31], v[202:203], v[248:249], 0
    v_mfma_f32_32x32x8_bf16 v[32:47], v[202:203], v[248:249], 0
    v_mfma_f32_32x32x8_bf16 v[48:63], v[202:203], v[248:249], 0
    v_min_f32 v170, 0x7149f2ca, v10
    v_mov_b32 v168, 0xc0135761
    v_mov_b32 v169, 0xc0135761
    s_waitcnt vmcnt(4)
    buffer_load_dwordx4 v[136:139], v1, s[8:11], s51 offen offset:0 sc1
    buffer_load_dwordx4 v[140:143], v1, s[8:11], s51 offen offset:1024 sc1
    buffer_load_dwordx4 v[144:147], v1, s[8:11], s51 offen offset:2048 sc1
    s_add_u32 s51, s51, 3072
    s_waitcnt vmcnt(4)
    buffer_load_dwordx4 v[148:151], v1, s[8:11], s51 offen offset:0 sc1
    buffer_load_dwordx4 v[152:155], v1, s[8:11], s51 offen offset:1024 sc1
    buffer_load_dwordx4 v[156:159], v1, s[8:11], s51 offen offset:2048 sc1
    s_mov_b32 s47, 0x40000
sbw_17:
    ds_read_b32 v252, v214 offset:0
    s_sub_u32 s47, s47, 1
    s_waitcnt lgkmcnt(0)
    v_cmp_gt_u32 vcc, 7, v252
    s_cbranch_scc1 sbw_17_x
    s_cbranch_vccnz sbw_17
sbw_17_x:
    v_add_u32 v204, s24, v1
    v_add_u32 v205, s25, v1
    v_add_u32 v206, s26, v1
    v_add_u32 v207, s27, v1
    v_lshlrev_b32 v200, 4, v200
    v_mov_b64 v[208:209], -1
    v_mov_b64 v[210:211], -1
    v_mov_b32 v215, s43
    v_lshrrev_b32 v201, 1, v1
    s_waitcnt vmcnt(6)
    v_cmp_ne_u32 vcc, s43, v15
    s_cbranch_vccz fc_18
    s_movk_i32 s47, 0x4000
poll_19:
    buffer_load_dword v15, v14, s[8:11], s6 offen sc1
    s_sub_u32 s47, s47, 1
    s_cbranch_scc1 poll_19_x
    s_waitcnt vmcnt(0)
    v_cmp_ne_u32 vcc, s43, v15
    s_cbranch_vccnz poll_19
poll_19_x:
    s_waitcnt vmcnt(0)
fc_18:
    ds_read_b128 v[8:11], v4 offset:0
    ds_read_b128 v[12:15], v4 offset:4096
    s_setprio 0
    s_mov_b32 exec_hi, 0x0fffffff
    buffer_load_dwordx4 v[172:175], v253, s[32:35], s12 offen
    s_cmp_ge_u32 s42, 2
    s_cselect_b32 exec_hi, 0xff, exec_hi
    buffer_load_dwordx4 v[176:179], v253, s[28:31], s13 offen
    s_mov_b32 exec_hi, -1
    s_add_u32 s50, s50, 1
    s_and_b32 s50, s50, 7
    s_mul_i32 s51, s50, 49152
    s_add_u32 s51, s51, s49
    s_waitcnt lgkmcnt(1)
    v_mfma_f32_32x32x16_bf16 v[16:31], v[112:115], v[8:11], v[16:31]
    v_mul_f32 v160, v216, v216
    v_mfma_f32_32x32x16_bf16 v[32:47], v[116:119], v[8:11], v[32:47]
    v_mul_f32 v161, v217, v217
    v_mul_f32 v162, v218, v218
    v_mfma_f32_32x32x16_bf16 v[48:63], v[120:123], v[8:11], v[48:63]
    v_mul_f32 v163, v219, v219
    ds_read_b128 v[8:11], v5 offset:0
    s_waitcnt lgkmcnt(1)
    v_mfma_f32_32x32x16_bf16 v[64:79], v[112:115], v[12:15], 0
    v_mul_f32 v164, v220, v220
    v_mul_f32 v165, v221, v221
    buffer_load_dwordx4 v[112:115], v1, s[8:11], s51 offen offset:0 sc1
    v_mfma_f32_32x32x16_bf16 v[80:95], v[116:119], v[12:15], 0
    v_mul_f32 v166, v222, v222
    buffer_load_dwordx4 v[116:119], v1, s[8:11], s51 offen offset:1024 sc1
    v_mfma_f32_32x32x16_bf16 v[96:111], v[120:123], v[12:15], 0
    v_mul_f32 v167, v223, v223
    v_fma_f32 v160, v160, s58, v168
    ds_read_b128 v[12:15], v5 offset:4096
    buffer_load_dwordx4 v[120:123], v1, s[8:11], s51 offen offset:2048 sc1
    s_add_u32 s51, s51, 3072
    s_waitcnt lgkmcnt(1)
    v_mfma_f32_32x32x16_bf16 v[16:31], v[124:127], v[8:11], v[16:31]
    v_fma_f32 v161, v161, s59, v169
    v_mfma_f32_32x32x16_bf16 v[32:47], v[128:131], v[8:11], v[32:47]
    v_fma_f32 v162, v162, s58, v168
    v_fma_f32 v163, v163, s59, v169
    v_mfma_f32_32x32x16_bf16 v[48:63], v[132:135], v[8:11], v[48:63]
    v_fma_f32 v164, v164, s58, v168
    ds_read_b128 v[8:11], v6 offset:0
    s_waitcnt lgkmcnt(1)
    v_mfma_f32_32x32x16_bf16 v[64:79], v[124:127], v[12:15], v[64:79]
    v_fma_f32 v165, v165, s59, v169
    v_fma_f32 v166, v166, s58, v168
    buffer_load_dwordx4 v[124:127], v1, s[8:11], s51 offen offset:0 sc1
    v_mfma_f32_32x32x16_bf16 v[80:95], v[128:131], v[12:15], v[80:95]
    v_fma_f32 v167, v167, s59, v169
    buffer_load_dwordx4 v[128:131], v1, s[8:11], s51 offen offset:1024 sc1
    v_mfma_f32_32x32x16_bf16 v[96:111], v[132:135], v[12:15], v[96:111]
    v_mul_f32 v160, v216, v160
    v_mul_f32 v161, v217, v161
    ds_read_b128 v[12:15], v6 offset:4096
    buffer_load_dwordx4 v[132:135], v1, s[8:11], s51 offen offset:2048 sc1
    s_add_u32 s51, s51, 3072
    s_waitcnt vmcnt(11)
    s_waitcnt lgkmcnt(1)
    v_mfma_f32_32x32x16_bf16 v[16:31], v[136:139], v[8:11], v[16:31]
    v_mul_f32 v162, v218, v162
    v_mfma_f32_32x32x16_bf16 v[32:47], v[140:143], v[8:11], v[32:47]
    v_mul_f32 v163, v219, v163
    v_mul_f32 v164, v220, v164
    v_mfma_f32_32x32x16_bf16 v[48:63], v[144:147], v[8:11], v[48:63]
    v_mul_f32 v165, v221, v165
    ds_read_b128 v[8:11], v7 offset:0
    s_waitcnt lgkmcnt(1)
    v_mfma_f32_32x32x16_bf16 v[64:79], v[136:139], v[12:15], v[64:79]
    v_mul_f32 v166, v222, v166
    v_mul_f32 v167, v223, v167
    buffer_load_dwordx4 v[136:139], v1, s[8:11], s51 offen offset:0 sc1
    v_mfma_f32_32x32x16_bf16 v[80:95], v[140:143], v[12:15], v[80:95]
    v_exp_f32 v160, v160
    buffer_load_dwordx4 v[140:143], v1, s[8:11], s51 offen offset:1024 sc1
    v_mfma_f32_32x32x16_bf16 v[96:111], v[144:147], v[12:15], v[96:111]
    v_exp_f32 v161, v161
    ds_read_b128 v[12:15], v7 offset:4096
    buffer_load_dwordx4 v[144:147], v1, s[8:11], s51 offen offset:2048 sc1
    s_add_u32 s51, s51, 3072
    s_waitcnt vmcnt(11)
    s_waitcnt lgkmcnt(1)
    v_mfma_f32_32x32x16_bf16 v[16:31], v[148:151], v[8:11], v[16:31]
    s_add_u32 s52, s52, 1
    s_and_b32 s52, s52, 7
    s_lshl_b32 s44, s52, 9
    s_add_u32 s56, s54, s44
    s_add_u32 s57, s55, s44
    s_add_u32 m0, s48, 0
    s_add_u32 s44, s56, 0
    buffer_load_dwordx4 v2, s[20:23], s44 offen lds
    v_mfma_f32_32x32x16_bf16 v[32:47], v[152:155], v[8:11], v[32:47]
    v_exp_f32 v162, v162
    s_add_u32 m0, s48, 1024
    s_add_u32 s44, s56, 32768
    buffer_load_dwordx4 v3, s[20:23], s44 offen lds
    v_mfma_f32_32x32x16_bf16 v[48:63], v[156:159], v[8:11], v[48:63]
    v_exp_f32 v163, v163
    ds_read_b128 v[8:11], v4 offset:8192
    s_add_u32 m0, s48, 2048
    s_add_u32 s44, s56, 65536
    buffer_load_dwordx4 v2, s[20:23], s44 offen lds
    s_waitcnt lgkmcnt(1)
    v_mfma_f32_32x32x16_bf16 v[64:79], v[148:151], v[12:15], v[64:79]
    v_exp_f32 v164, v164
    buffer_load_dwordx4 v[148:151], v1, s[8:11], s51 offen offset:0 sc1
    v_mfma_f32_32x32x16_bf16 v[80:95], v[152:155], v[12:15], v[80:95]
    buffer_load_dwordx4 v[152:155], v1, s[8:11], s51 offen offset:1024 sc1
    v_mfma_f32_32x32x16_bf16 v[96:111], v[156:159], v[12:15], v[96:111]
    v_exp_f32 v165, v165
    ds_read_b128 v[12:15], v4 offset:12288
    buffer_load_dwordx4 v[156:159], v1, s[8:11], s51 offen offset:2048 sc1
    s_add_u32 s50, s50, 1
    s_and_b32 s50, s50, 7
    s_mul_i32 s51, s50, 49152
    s_add_u32 s51, s51, s49
    s_waitcnt vmcnt(12)
    s_waitcnt lgkmcnt(1)
    v_mfma_f32_32x32x16_bf16 v[16:31], v[112:115], v[8:11], v[16:31]
    v_exp_f32 v166, v166
    s_mov_b32 exec_hi, 0x0fffffff
    buffer_store_dwordx4 v[172:175], v241, s[8:11], s96 offen sc1
    s_cmp_ge_u32 s42, 2
    s_cselect_b32 exec_hi, 0xff, exec_hi
    buffer_store_dwordx4 v[176:179], v241, s[8:11], s97 offen sc1
    s_mov_b32 exec_hi, -1
    s_add_u32 m0, s48, 3072
    s_add_u32 s44, s56, 98304
    buffer_load_dwordx4 v3, s[20:23], s44 offen lds
    v_mfma_f32_32x32x16_bf16 v[32:47], v[116:119], v[8:11], v[32:47]
    v_exp_f32 v167, v167
    s_add_u32 m0, s48, 4096
    s_add_u32 s44, s57, 0
    buffer_load_dwordx4 v2, s[20:23], s44 offen lds
    v_mfma_f32_32x32x16_bf16 v[48:63], v[120:123], v[8:11], v[48:63]
    ds_read_b128 v[8:11], v5 offset:8192
    s_add_u32 m0, s48, 5120
    s_add_u32 s44, s57, 32768
    buffer_load_dwordx4 v3, s[20:23], s44 offen lds
    s_waitcnt lgkmcnt(1)
    v_mfma_f32_32x32x16_bf16 v[64:79], v[112:115], v[12:15], v[64:79]
    v_fma_f32 v160, v160, v170, v170
    v_fma_f32 v161, v161, v170, v170
    buffer_load_dwordx4 v[112:115], v1, s[8:11], s51 offen offset:0 sc1
    v_mfma_f32_32x32x16_bf16 v[80:95], v[116:119], v[12:15], v[80:95]
    v_fma_f32 v162, v162, v170, v170
    buffer_load_dwordx4 v[116:119], v1, s[8:11], s51 offen offset:1024 sc1
    v_mfma_f32_32x32x16_bf16 v[96:111], v[120:123], v[12:15], v[96:111]
    v_fma_f32 v163, v163, v170, v170
    v_fma_f32 v164, v164, v170, v170
    ds_read_b128 v[12:15], v5 offset:12288
    buffer_load_dwordx4 v[120:123], v1, s[8:11], s51 offen offset:2048 sc1
    s_add_u32 s51, s51, 3072
    s_waitcnt vmcnt(17)
    s_waitcnt lgkmcnt(1)
    v_mfma_f32_32x32x16_bf16 v[16:31], v[124:127], v[8:11], v[16:31]
    v_fma_f32 v165, v165, v170, v170
    s_add_u32 m0, s48, 6144
    s_add_u32 s44, s57, 65536
    buffer_load_dwordx4 v2, s[20:23], s44 offen lds
    v_mfma_f32_32x32x16_bf16 v[32:47], v[128:131], v[8:11], v[32:47]
    v_fma_f32 v166, v166, v170, v170
    v_fma_f32 v167, v167, v170, v170
    s_add_u32 m0, s48, 7168
    s_add_u32 s44, s57, 98304
    buffer_load_dwordx4 v3, s[20:23], s44 offen lds
    v_mfma_f32_32x32x16_bf16 v[48:63], v[132:135], v[8:11], v[48:63]
    v_rcp_f32 v160, v160
    ds_read_b128 v[8:11], v6 offset:8192
    buffer_store_dwordx4 v[208:211], v1, s[8:11], s0 offen offset:2048 sc1
    s_waitcnt lgkmcnt(1)
    v_mfma_f32_32x32x16_bf16 v[64:79], v[124:127], v[12:15], v[64:79]
    v_rcp_f32 v161, v161
    buffer_load_dwordx4 v[124:127], v1, s[8:11], s51 offen offset:0 sc1
    v_mfma_f32_32x32x16_bf16 v[80:95], v[128:131], v[12:15], v[80:95]
    buffer_load_dwordx4 v[128:131], v1, s[8:11], s51 offen offset:1024 sc1
    v_mfma_f32_32x32x16_bf16 v[96:111], v[132:135], v[12:15], v[96:111]
    v_rcp_f32 v162, v162
    ds_read_b128 v[12:15], v6 offset:12288
    buffer_load_dwordx4 v[132:135], v1, s[8:11], s51 offen offset:2048 sc1
    s_add_u32 s51, s51, 3072
    s_waitcnt vmcnt(20)
    s_waitcnt lgkmcnt(1)
    v_mfma_f32_32x32x16_bf16 v[16:31], v[136:139], v[8:11], v[16:31]
    v_rcp_f32 v163, v163
    buffer_store_dwordx4 v[208:211], v1, s[8:11], s0 offen offset:0 sc1
    v_mfma_f32_32x32x16_bf16 v[32:47], v[140:143], v[8:11], v[32:47]
    v_rcp_f32 v164, v164
    v_mfma_f32_32x32x16_bf16 v[48:63], v[144:147], v[8:11], v[48:63]
    ds_read_b128 v[8:11], v7 offset:8192
    s_waitcnt lgkmcnt(1)
    v_mfma_f32_32x32x16_bf16 v[64:79], v[136:139], v[12:15], v[64:79]
    v_rcp_f32 v165, v165
    buffer_load_dwordx4 v[136:139], v1, s[8:11], s51 offen offset:0 sc1
    v_mfma_f32_32x32x16_bf16 v[80:95], v[140:143], v[12:15], v[80:95]
    v_rcp_f32 v166, v166
    buffer_load_dwordx4 v[140:143], v1, s[8:11], s51 offen offset:1024 sc1
    v_mfma_f32_32x32x16_bf16 v[96:111], v[144:147], v[12:15], v[96:111]
    v_rcp_f32 v167, v167
    ds_read_b128 v[12:15], v7 offset:12288
    buffer_load_dwordx4 v[144:147], v1, s[8:11], s51 offen offset:2048 sc1
    s_add_u32 s51, s51, 3072
    s_waitcnt vmcnt(18)
    s_waitcnt lgkmcnt(1)
    v_mfma_f32_32x32x16_bf16 v[16:31], v[148:151], v[8:11], v[16:31]
    s_add_u32 s52, s52, 1
    s_and_b32 s52, s52, 7
    s_lshl_b32 s44, s52, 9
    s_add_u32 s56, s54, s44
    s_add_u32 s57, s55, s44
    s_add_u32 m0, s48, 8192
    s_add_u32 s44, s56, 0
    buffer_load_dwordx4 v2, s[20:23], s44 offen lds
    v_mfma_f32_32x32x16_bf16 v[32:47], v[152:155], v[8:11], v[32:47]
    v_mul_f32 v216, v216, v160
    v_mul_f32 v217, v217, v161
    s_add_u32 m0, s48, 9216
    s_add_u32 s44, s56, 32768
    buffer_load_dwordx4 v3, s[20:23], s44 offen lds
    v_mfma_f32_32x32x16_bf16 v[48:63], v[156:159], v[8:11], v[48:63]
    v_mul_f32 v218, v218, v162
    s_waitcnt vmcnt(10)
    ds_read_b128 v[8:11], v4 offset:0
    s_add_u32 m0, s48, 10240
    s_add_u32 s44, s56, 65536
    buffer_load_dwordx4 v2, s[20:23], s44 offen lds
    s_waitcnt lgkmcnt(1)
    v_mfma_f32_32x32x16_bf16 v[64:79], v[148:151], v[12:15], v[64:79]
    v_mul_f32 v219, v219, v163
    v_mul_f32 v220, v220, v164
    buffer_load_dwordx4 v[148:151], v1, s[8:11], s51 offen offset:0 sc1
    v_mfma_f32_32x32x16_bf16 v[80:95], v[152:155], v[12:15], v[80:95]
    v_mul_f32 v221, v221, v165
    buffer_load_dwordx4 v[152:155], v1, s[8:11], s51 offen offset:1024 sc1
    v_mfma_f32_32x32x16_bf16 v[96:111], v[156:159], v[12:15], v[96:111]
    v_mul_f32 v222, v222, v166
    v_mul_f32 v223, v223, v167
    ds_read_b128 v[12:15], v4 offset:4096
    buffer_load_dwordx4 v[156:159], v1, s[8:11], s51 offen offset:2048 sc1
    s_add_u32 s50, s50, 1
    s_and_b32 s50, s50, 7
    s_mul_i32 s51, s50, 49152
    s_add_u32 s51, s51, s49
    s_waitcnt lgkmcnt(1)
    v_mfma_f32_32x32x16_bf16 v[16:31], v[112:115], v[8:11], v[16:31]
    v_mul_f32 v160, v224, v224
    s_add_u32 s44, s99, 4096
    s_mov_b64 exec, 1
    buffer_store_dword v215, v203, s[8:11], s44 offen sc1
    s_mov_b64 exec, -1
    s_add_u32 m0, s48, 11264
    s_add_u32 s44, s56, 98304
    buffer_load_dwordx4 v3, s[20:23], s44 offen lds
    v_mfma_f32_32x32x16_bf16 v[32:47], v[116:119], v[8:11], v[32:47]
    v_mul_f32 v161, v225, v225
    v_mul_f32 v162, v226, v226
    s_add_u32 m0, s48, 12288
    s_add_u32 s44, s57, 0
    buffer_load_dwordx4 v2, s[20:23], s44 offen lds
    v_mfma_f32_32x32x16_bf16 v[48:63], v[120:123], v[8:11], v[48:63]
    v_mul_f32 v163, v227, v227
    ds_read_b128 v[8:11], v5 offset:0
    s_add_u32 m0, s48, 13312
    s_add_u32 s44, s57, 32768
    buffer_load_dwordx4 v3, s[20:23], s44 offen lds
    s_waitcnt lgkmcnt(1)
    v_mfma_f32_32x32x16_bf16 v[64:79], v[112:115], v[12:15], v[64:79]
    v_mul_f32 v164, v228, v228
    v_mul_f32 v165, v229, v229
    buffer_load_dwordx4 v[112:115], v1, s[8:11], s51 offen offset:0 sc1
    v_mfma_f32_32x32x16_bf16 v[80:95], v[116:119], v[12:15], v[80:95]
    v_mul_f32 v166, v230, v230
    buffer_load_dwordx4 v[116:119], v1, s[8:11], s51 offen offset:1024 sc1
    v_mfma_f32_32x32x16_bf16 v[96:111], v[120:123], v[12:15], v[96:111]
    v_mul_f32 v167, v231, v231
    v_fma_f32 v160, v160, s58, v168
    ds_read_b128 v[12:15], v5 offset:4096
    buffer_load_dwordx4 v[120:123], v1, s[8:11], s51 offen offset:2048 sc1
    s_add_u32 s51, s51, 3072
    s_waitcnt vmcnt(17)
    s_waitcnt lgkmcnt(1)
    v_mfma_f32_32x32x16_bf16 v[16:31], v[124:127], v[8:11], v[16:31]
    v_fma_f32 v161, v161, s59, v169
    s_add_u32 m0, s48, 14336
    s_add_u32 s44, s57, 65536
    buffer_load_dwordx4 v2, s[20:23], s44 offen lds
    v_mfma_f32_32x32x16_bf16 v[32:47], v[128:131], v[8:11], v[32:47]
    v_fma_f32 v162, v162, s58, v168
    v_fma_f32 v163, v163, s59, v169
    s_add_u32 m0, s48, 15360
    s_add_u32 s44, s57, 98304
    buffer_load_dwordx4 v3, s[20:23], s44 offen lds
    v_mfma_f32_32x32x16_bf16 v[48:63], v[132:135], v[8:11], v[48:63]
    v_fma_f32 v164, v164, s58, v168
    ds_read_b128 v[8:11], v6 offset:0
    buffer_store_dwordx4 v[208:211], v1, s[8:11], s62 offen offset:0 sc1
    s_waitcnt lgkmcnt(1)
    v_mfma_f32_32x32x16_bf16 v[64:79], v[124:127], v[12:15], v[64:79]
    v_fma_f32 v165, v165, s59, v169
    v_fma_f32 v166, v166, s58, v168
    buffer_load_dwordx4 v[124:127], v1, s[8:11], s51 offen offset:0 sc1
    v_mfma_f32_32x32x16_bf16 v[80:95], v[128:131], v[12:15], v[80:95]
    v_fma_f32 v167, v167, s59, v169
    buffer_load_dwordx4 v[128:131], v1, s[8:11], s51 offen offset:1024 sc1
    v_mfma_f32_32x32x16_bf16 v[96:111], v[132:135], v[12:15], v[96:111]
    v_mul_f32 v160, v224, v160
    v_mul_f32 v161, v225, v161
    ds_read_b128 v[12:15], v6 offset:4096
    buffer_load_dwordx4 v[132:135], v1, s[8:11], s51 offen offset:2048 sc1
    s_add_u32 s51, s51, 3072
    s_waitcnt vmcnt(19)
    s_waitcnt lgkmcnt(1)
    v_mfma_f32_32x32x16_bf16 v[16:31], v[136:139], v[8:11], v[16:31]
    v_mul_f32 v162, v226, v162
    buffer_store_dwordx4 v[208:211], v1, s[8:11], s100 offen offset:0 sc1
    v_mfma_f32_32x32x16_bf16 v[32:47], v[140:143], v[8:11], v[32:47]
    v_mul_f32 v163, v227, v163
    v_mul_f32 v164, v228, v164
    v_mfma_f32_32x32x16_bf16 v[48:63], v[144:147], v[8:11], v[48:63]
    v_mul_f32 v165, v229, v165
    ds_read_b128 v[8:11], v7 offset:0
    s_waitcnt lgkmcnt(1)
    v_mfma_f32_32x32x16_bf16 v[64:79], v[136:139], v[12:15], v[64:79]
    v_mul_f32 v166, v230, v166
    v_mul_f32 v167, v231, v167
    buffer_load_dwordx4 v[136:139], v1, s[8:11], s51 offen offset:0 sc1
    v_mfma_f32_32x32x16_bf16 v[80:95], v[140:143], v[12:15], v[80:95]
    v_exp_f32 v160, v160
    buffer_load_dwordx4 v[140:143], v1, s[8:11], s51 offen offset:1024 sc1
    v_mfma_f32_32x32x16_bf16 v[96:111], v[144:147], v[12:15], v[96:111]
    v_exp_f32 v161, v161
    ds_read_b128 v[12:15], v7 offset:4096
    buffer_load_dwordx4 v[144:147], v1, s[8:11], s51 offen offset:2048 sc1
    s_add_u32 s51, s51, 3072
    s_waitcnt vmcnt(17)
    s_waitcnt lgkmcnt(1)
    v_mfma_f32_32x32x16_bf16 v[16:31], v[148:151], v[8:11], v[16:31]
    s_add_u32 s52, s52, 1
    s_and_b32 s52, s52, 7
    s_lshl_b32 s44, s52, 9
    s_add_u32 s56, s54, s44
    s_add_u32 s57, s55, s44
    s_add_u32 m0, s48, 0
    s_add_u32 s44, s56, 0
    buffer_load_dwordx4 v2, s[20:23], s44 offen lds
    v_mfma_f32_32x32x16_bf16 v[32:47], v[152:155], v[8:11], v[32:47]
    v_exp_f32 v162, v162
    s_add_u32 m0, s48, 1024
    s_add_u32 s44, s56, 32768
    buffer_load_dwordx4 v3, s[20:23], s44 offen lds
    v_mfma_f32_32x32x16_bf16 v[48:63], v[156:159], v[8:11], v[48:63]
    v_exp_f32 v163, v163
    s_waitcnt vmcnt(10)
    ds_read_b128 v[8:11], v4 offset:8192
    s_add_u32 m0, s48, 2048
    s_add_u32 s44, s56, 65536
    buffer_load_dwordx4 v2, s[20:23], s44 offen lds
    s_waitcnt lgkmcnt(1)
    v_mfma_f32_32x32x16_bf16 v[64:79], v[148:151], v[12:15], v[64:79]
    v_exp_f32 v164, v164
    buffer_load_dwordx4 v[148:151], v1, s[8:11], s51 offen offset:0 sc1
    v_mfma_f32_32x32x16_bf16 v[80:95], v[152:155], v[12:15], v[80:95]
    buffer_load_dwordx4 v[152:155], v1, s[8:11], s51 offen offset:1024 sc1
    v_mfma_f32_32x32x16_bf16 v[96:111], v[156:159], v[12:15], v[96:111]
    v_exp_f32 v165, v165
    ds_read_b128 v[12:15], v4 offset:12288
    buffer_load_dwordx4 v[156:159], v1, s[8:11], s51 offen offset:2048 sc1
    s_add_u32 s50, s50, 1
    s_and_b32 s50, s50, 7
    s_mul_i32 s51, s50, 49152
    s_add_u32 s51, s51, s49
    s_waitcnt lgkmcnt(1)
    v_mfma_f32_32x32x16_bf16 v[16:31], v[112:115], v[8:11], v[16:31]
    v_exp_f32 v166, v166
    s_add_u32 m0, s48, 3072
    s_add_u32 s44, s56, 98304
    buffer_load_dwordx4 v3, s[20:23], s44 offen lds
    v_mfma_f32_32x32x16_bf16 v[32:47], v[116:119], v[8:11], v[32:47]
    v_exp_f32 v167, v167
    s_add_u32 m0, s48, 4096
    s_add_u32 s44, s57, 0
    buffer_load_dwordx4 v2, s[20:23], s44 offen lds
    v_mfma_f32_32x32x16_bf16 v[48:63], v[120:123], v[8:11], v[48:63]
    ds_read_b128 v[8:11], v5 offset:8192
    s_add_u32 m0, s48, 5120
    s_add_u32 s44, s57, 32768
    buffer_load_dwordx4 v3, s[20:23], s44 offen lds
    s_waitcnt lgkmcnt(1)
    v_mfma_f32_32x32x16_bf16 v[64:79], v[112:115], v[12:15], v[64:79]
    v_fma_f32 v160, v160, v170, v170
    v_fma_f32 v161, v161, v170, v170
    buffer_load_dwordx4 v[112:115], v1, s[8:11], s51 offen offset:0 sc1
    v_mfma_f32_32x32x16_bf16 v[80:95], v[116:119], v[12:15], v[80:95]
    v_fma_f32 v162, v162, v170, v170
    buffer_load_dwordx4 v[116:119], v1, s[8:11], s51 offen offset:1024 sc1
    v_mfma_f32_32x32x16_bf16 v[96:111], v[120:123], v[12:15], v[96:111]
    v_fma_f32 v163, v163, v170, v170
    v_fma_f32 v164, v164, v170, v170
    ds_read_b128 v[12:15], v5 offset:12288
    buffer_load_dwordx4 v[120:123], v1, s[8:11], s51 offen offset:2048 sc1
    s_add_u32 s51, s51, 3072
    s_waitcnt vmcnt(16)
    s_waitcnt lgkmcnt(1)
    v_mfma_f32_32x32x16_bf16 v[16:31], v[124:127], v[8:11], v[16:31]
    v_fma_f32 v165, v165, v170, v170
    s_add_u32 m0, s48, 6144
    s_add_u32 s44, s57, 65536
    buffer_load_dwordx4 v2, s[20:23], s44 offen lds
    v_mfma_f32_32x32x16_bf16 v[32:47], v[128:131], v[8:11], v[32:47]
    v_fma_f32 v166, v166, v170, v170
    v_fma_f32 v167, v167, v170, v170
    s_add_u32 m0, s48, 7168
    s_add_u32 s44, s57, 98304
    buffer_load_dwordx4 v3, s[20:23], s44 offen lds
    v_mfma_f32_32x32x16_bf16 v[48:63], v[132:135], v[8:11], v[48:63]
    v_rcp_f32 v160, v160
    ds_read_b128 v[8:11], v6 offset:8192
    buffer_store_dwordx2 v[208:209], v201, s[8:11], s63 offen offset:0 sc1
    s_waitcnt lgkmcnt(1)
    v_mfma_f32_32x32x16_bf16 v[64:79], v[124:127], v[12:15], v[64:79]
    v_rcp_f32 v161, v161
    buffer_load_dwordx4 v[124:127], v1, s[8:11], s51 offen offset:0 sc1
    v_mfma_f32_32x32x16_bf16 v[80:95], v[128:131], v[12:15], v[80:95]
    buffer_load_dwordx4 v[128:131], v1, s[8:11], s51 offen offset:1024 sc1
    v_mfma_f32_32x32x16_bf16 v[96:111], v[132:135], v[12:15], v[96:111]
    v_rcp_f32 v162, v162
    ds_read_b128 v[12:15], v6 offset:12288
    buffer_load_dwordx4 v[132:135], v1, s[8:11], s51 offen offset:2048 sc1
    s_add_u32 s51, s51, 3072
    s_waitcnt vmcnt(18)
    s_waitcnt lgkmcnt(1)
    v_mfma_f32_32x32x16_bf16 v[16:31], v[136:139], v[8:11], v[16:31]
    v_rcp_f32 v163, v163
    buffer_store_dwordx4 v[208:211], v1, s[8:11], s62 offen offset:2048 sc1
    v_mfma_f32_32x32x16_bf16 v[32:47], v[140:143], v[8:11], v[32:47]
    v_rcp_f32 v164, v164
    v_mfma_f32_32x32x16_bf16 v[48:63], v[144:147], v[8:11], v[48:63]
    ds_read_b128 v[8:11], v7 offset:8192
    s_waitcnt lgkmcnt(1)
    v_mfma_f32_32x32x16_bf16 v[64:79], v[136:139], v[12:15], v[64:79]
    v_rcp_f32 v165, v165
    buffer_load_dwordx4 v[136:139], v1, s[8:11], s51 offen offset:0 sc1
    v_mfma_f32_32x32x16_bf16 v[80:95], v[140:143], v[12:15], v[80:95]
    v_rcp_f32 v166, v166
    buffer_load_dwordx4 v[140:143], v1, s[8:11], s51 offen offset:1024 sc1
    v_mfma_f32_32x32x16_bf16 v[96:111], v[144:147], v[12:15], v[96:111]
    v_rcp_f32 v167, v167
    ds_read_b128 v[12:15], v7 offset:12288
    buffer_load_dwordx4 v[144:147], v1, s[8:11], s51 offen offset:2048 sc1
    s_add_u32 s51, s51, 3072
    s_waitcnt vmcnt(16)
    s_waitcnt lgkmcnt(1)
    v_mfma_f32_32x32x16_bf16 v[16:31], v[148:151], v[8:11], v[16:31]
    s_add_u32 s52, s52, 1
    s_and_b32 s52, s52, 7
    s_lshl_b32 s44, s52, 9
    s_add_u32 s56, s54, s44
    s_add_u32 s57, s55, s44
    s_add_u32 m0, s48, 8192
    s_add_u32 s44, s56, 0
    buffer_load_dwordx4 v2, s[20:23], s44 offen lds
    v_mfma_f32_32x32x16_bf16 v[32:47], v[152:155], v[8:11], v[32:47]
    v_mul_f32 v224, v224, v160
    v_mul_f32 v225, v225, v161
    s_add_u32 m0, s48, 9216
    s_add_u32 s44, s56, 32768
    buffer_load_dwordx4 v3, s[20:23], s44 offen lds
    v_mfma_f32_32x32x16_bf16 v[48:63], v[156:159], v[8:11], v[48:63]
    v_mul_f32 v226, v226, v162
    s_waitcnt vmcnt(10)
    ds_read_b128 v[8:11], v4 offset:0
    s_add_u32 m0, s48, 10240
    s_add_u32 s44, s56, 65536
    buffer_load_dwordx4 v2, s[20:23], s44 offen lds
    s_waitcnt lgkmcnt(1)
    v_mfma_f32_32x32x16_bf16 v[64:79], v[148:151], v[12:15], v[64:79]
    v_mul_f32 v227, v227, v163
    v_mul_f32 v228, v228, v164
    buffer_load_dwordx4 v[148:151], v1, s[8:11], s51 offen offset:0 sc1
    v_mfma_f32_32x32x16_bf16 v[80:95], v[152:155], v[12:15], v[80:95]
    v_mul_f32 v229, v229, v165
    buffer_load_dwordx4 v[152:155], v1, s[8:11], s51 offen offset:1024 sc1
    v_mfma_f32_32x32x16_bf16 v[96:111], v[156:159], v[12:15], v[96:111]
    v_mul_f32 v230, v230, v166
    v_mul_f32 v231, v231, v167
    ds_read_b128 v[12:15], v4 offset:4096
    buffer_load_dwordx4 v[156:159], v1, s[8:11], s51 offen offset:2048 sc1
    s_add_u32 s50, s50, 1
    s_and_b32 s50, s50, 7
    s_mul_i32 s51, s50, 49152
    s_add_u32 s51, s51, s49
    s_waitcnt lgkmcnt(1)
    v_mfma_f32_32x32x16_bf16 v[16:31], v[112:115], v[8:11], v[16:31]
    v_mul_f32 v160, v232, v232
    s_add_u32 m0, s48, 11264
    s_add_u32 s44, s56, 98304
    buffer_load_dwordx4 v3, s[20:23], s44 offen lds
    v_mfma_f32_32x32x16_bf16 v[32:47], v[116:119], v[8:11], v[32:47]
    v_mul_f32 v161, v233, v233
    v_mul_f32 v162, v234, v234
    s_add_u32 m0, s48, 12288
    s_add_u32 s44, s57, 0
    buffer_load_dwordx4 v2, s[20:23], s44 offen lds
    v_mfma_f32_32x32x16_bf16 v[48:63], v[120:123], v[8:11], v[48:63]
    v_mul_f32 v163, v235, v235
    ds_read_b128 v[8:11], v5 offset:0
    s_add_u32 m0, s48, 13312
    s_add_u32 s44, s57, 32768
    buffer_load_dwordx4 v3, s[20:23], s44 offen lds
    s_waitcnt lgkmcnt(1)
    v_mfma_f32_32x32x16_bf16 v[64:79], v[112:115], v[12:15], v[64:79]
    v_mul_f32 v164, v236, v236
    v_mul_f32 v165, v237, v237
    buffer_load_dwordx4 v[112:115], v1, s[8:11], s51 offen offset:0 sc1
    v_mfma_f32_32x32x16_bf16 v[80:95], v[116:119], v[12:15], v[80:95]
    v_mul_f32 v166, v238, v238
    buffer_load_dwordx4 v[116:119], v1, s[8:11], s51 offen offset:1024 sc1
    v_mfma_f32_32x32x16_bf16 v[96:111], v[120:123], v[12:15], v[96:111]
    v_mul_f32 v167, v239, v239
    v_fma_f32 v160, v160, s58, v168
    ds_read_b128 v[12:15], v5 offset:4096
    buffer_load_dwordx4 v[120:123], v1, s[8:11], s51 offen offset:2048 sc1
    s_add_u32 s51, s51, 3072
    s_waitcnt vmcnt(16)
    s_waitcnt lgkmcnt(1)
    v_mfma_f32_32x32x16_bf16 v[16:31], v[124:127], v[8:11], v[16:31]
    v_fma_f32 v161, v161, s59, v169
    s_add_u32 m0, s48, 14336
    s_add_u32 s44, s57, 65536
    buffer_load_dwordx4 v2, s[20:23], s44 offen lds
    v_mfma_f32_32x32x16_bf16 v[32:47], v[128:131], v[8:11], v[32:47]
    v_fma_f32 v162, v162, s58, v168
    v_fma_f32 v163, v163, s59, v169
    s_add_u32 m0, s48, 15360
    s_add_u32 s44, s57, 98304
    buffer_load_dwordx4 v3, s[20:23], s44 offen lds
    v_mfma_f32_32x32x16_bf16 v[48:63], v[132:135], v[8:11], v[48:63]
    v_fma_f32 v164, v164, s58, v168
    ds_read_b128 v[8:11], v6 offset:0
    s_waitcnt lgkmcnt(1)
    v_mfma_f32_32x32x16_bf16 v[64:79], v[124:127], v[12:15], v[64:79]
    v_fma_f32 v165, v165, s59, v169
    v_fma_f32 v166, v166, s58, v168
    buffer_load_dwordx4 v[124:127], v1, s[8:11], s51 offen offset:0 sc1
    v_mfma_f32_32x32x16_bf16 v[80:95], v[128:131], v[12:15], v[80:95]
    v_fma_f32 v167, v167, s59, v169
    buffer_load_dwordx4 v[128:131], v1, s[8:11], s51 offen offset:1024 sc1
    v_mfma_f32_32x32x16_bf16 v[96:111], v[132:135], v[12:15], v[96:111]
    v_mul_f32 v160, v232, v160
    v_mul_f32 v161, v233, v161
    ds_read_b128 v[12:15], v6 offset:4096
    buffer_load_dwordx4 v[132:135], v1, s[8:11], s51 offen offset:2048 sc1
    s_add_u32 s51, s51, 3072
    s_waitcnt vmcnt(17)
    s_waitcnt lgkmcnt(1)
    v_mfma_f32_32x32x16_bf16 v[16:31], v[136:139], v[8:11], v[16:31]
    v_mul_f32 v162, v234, v162
    v_mfma_f32_32x32x16_bf16 v[32:47], v[140:143], v[8:11], v[32:47]
    v_mul_f32 v163, v235, v163
    v_mul_f32 v164, v236, v164
    v_mfma_f32_32x32x16_bf16 v[48:63], v[144:147], v[8:11], v[48:63]
    v_mul_f32 v165, v237, v165
    ds_read_b128 v[8:11], v7 offset:0
    s_waitcnt lgkmcnt(1)
    v_mfma_f32_32x32x16_bf16 v[64:79], v[136:139], v[12:15], v[64:79]
    v_mul_f32 v166, v238, v166
    v_mul_f32 v167, v239, v167
    buffer_load_dwordx4 v[136:139], v1, s[8:11], s51 offen offset:0 sc1
    v_mfma_f32_32x32x16_bf16 v[80:95], v[140:143], v[12:15], v[80:95]
    v_exp_f32 v160, v160
    buffer_load_dwordx4 v[140:143], v1, s[8:11], s51 offen offset:1024 sc1
    v_mfma_f32_32x32x16_bf16 v[96:111], v[144:147], v[12:15], v[96:111]
    v_exp_f32 v161, v161
    ds_read_b128 v[12:15], v7 offset:4096
    buffer_load_dwordx4 v[144:147], v1, s[8:11], s51 offen offset:2048 sc1
    s_add_u32 s51, s51, 3072
    s_waitcnt vmcnt(14)
    s_waitcnt lgkmcnt(1)
    v_mfma_f32_32x32x16_bf16 v[16:31], v[148:151], v[8:11], v[16:31]
    s_add_u32 s52, s52, 1
    s_and_b32 s52, s52, 7
    s_lshl_b32 s44, s52, 9
    s_add_u32 s56, s54, s44
    s_add_u32 s57, s55, s44
    s_add_u32 m0, s48, 0
    s_add_u32 s44, s56, 0
    buffer_load_dwordx4 v2, s[20:23], s44 offen lds
    v_mfma_f32_32x32x16_bf16 v[32:47], v[152:155], v[8:11], v[32:47]
    v_exp_f32 v162, v162
    s_add_u32 m0, s48, 1024
    s_add_u32 s44, s56, 32768
    buffer_load_dwordx4 v3, s[20:23], s44 offen lds
    v_mfma_f32_32x32x16_bf16 v[48:63], v[156:159], v[8:11], v[48:63]
    v_exp_f32 v163, v163
    s_waitcnt vmcnt(8)
    ds_read_b128 v[8:11], v4 offset:8192
    s_add_u32 m0, s48, 2048
    s_add_u32 s44, s56, 65536
    buffer_load_dwordx4 v2, s[20:23], s44 offen lds
    s_waitcnt lgkmcnt(1)
    v_mfma_f32_32x32x16_bf16 v[64:79], v[148:151], v[12:15], v[64:79]
    v_exp_f32 v164, v164
    buffer_load_dwordx4 v[148:151], v1, s[8:11], s51 offen offset:0 sc1
    v_mfma_f32_32x32x16_bf16 v[80:95], v[152:155], v[12:15], v[80:95]
    buffer_load_dwordx4 v[152:155], v1, s[8:11], s51 offen offset:1024 sc1
    v_mfma_f32_32x32x16_bf16 v[96:111], v[156:159], v[12:15], v[96:111]
    v_exp_f32 v165, v165
    ds_read_b128 v[12:15], v4 offset:12288
    buffer_load_dwordx4 v[156:159], v1, s[8:11], s51 offen offset:2048 sc1
    s_add_u32 s50, s50, 1
    s_and_b32 s50, s50, 7
    s_mul_i32 s51, s50, 49152
    s_add_u32 s51, s51, s49
    s_waitcnt lgkmcnt(1)
    v_mfma_f32_32x32x16_bf16 v[16:31], v[112:115], v[8:11], v[16:31]
    v_exp_f32 v166, v166
    buffer_load_dword v244, v242, s[8:11], s6 offen sc1
    s_add_u32 m0, s48, 3072
    s_add_u32 s44, s56, 98304
    buffer_load_dwordx4 v3, s[20:23], s44 offen lds
    v_mfma_f32_32x32x16_bf16 v[32:47], v[116:119], v[8:11], v[32:47]
    v_exp_f32 v167, v167
    s_add_u32 m0, s48, 4096
    s_add_u32 s44, s57, 0
    buffer_load_dwordx4 v2, s[20:23], s44 offen lds
    v_mfma_f32_32x32x16_bf16 v[48:63], v[120:123], v[8:11], v[48:63]
    ds_read_b128 v[8:11], v5 offset:8192
    s_add_u32 m0, s48, 5120
    s_add_u32 s44, s57, 32768
    buffer_load_dwordx4 v3, s[20:23], s44 offen lds
    s_waitcnt lgkmcnt(1)
    v_mfma_f32_32x32x16_bf16 v[64:79], v[112:115], v[12:15], v[64:79]
    v_fma_f32 v160, v160, v170, v170
    v_fma_f32 v161, v161, v170, v170
    buffer_load_dwordx4 v[112:115], v1, s[8:11], s51 offen offset:0 sc1
    v_mfma_f32_32x32x16_bf16 v[80:95], v[116:119], v[12:15], v[80:95]
    v_fma_f32 v162, v162, v170, v170
    buffer_load_dwordx4 v[116:119], v1, s[8:11], s51 offen offset:1024 sc1
    v_mfma_f32_32x32x16_bf16 v[96:111], v[120:123], v[12:15], v[96:111]
    v_fma_f32 v163, v163, v170, v170
    v_fma_f32 v164, v164, v170, v170
    ds_read_b128 v[12:15], v5 offset:12288
    buffer_load_dwordx4 v[120:123], v1, s[8:11], s51 offen offset:2048 sc1
    s_add_u32 s51, s51, 3072
    s_waitcnt vmcnt(16)
    s_waitcnt lgkmcnt(1)
    v_mfma_f32_32x32x16_bf16 v[16:31], v[124:127], v[8:11], v[16:31]
    v_fma_f32 v165, v165, v170, v170
    s_add_u32 m0, s48, 6144
    s_add_u32 s44, s57, 65536
    buffer_load_dwordx4 v2, s[20:23], s44 offen lds
    v_mfma_f32_32x32x16_bf16 v[32:47], v[128:131], v[8:11], v[32:47]
    v_fma_f32 v166, v166, v170, v170
    v_fma_f32 v167, v167, v170, v170
    s_add_u32 m0, s48, 7168
    s_add_u32 s44, s57, 98304
    buffer_load_dwordx4 v3, s[20:23], s44 offen lds
    v_mfma_f32_32x32x16_bf16 v[48:63], v[132:135], v[8:11], v[48:63]
    v_rcp_f32 v160, v160
    ds_read_b128 v[8:11], v6 offset:8192
    s_mov_b64 exec, 1
    buffer_store_dword v215, v203, s[8:11], s4 offen sc1
    s_mov_b64 exec, -1
    s_waitcnt lgkmcnt(1)
    v_mfma_f32_32x32x16_bf16 v[64:79], v[124:127], v[12:15], v[64:79]
    v_rcp_f32 v161, v161
    buffer_load_dwordx4 v[124:127], v1, s[8:11], s51 offen offset:0 sc1
    v_mfma_f32_32x32x16_bf16 v[80:95], v[128:131], v[12:15], v[80:95]
    buffer_load_dwordx4 v[128:131], v1, s[8:11], s51 offen offset:1024 sc1
    v_mfma_f32_32x32x16_bf16 v[96:111], v[132:135], v[12:15], v[96:111]
    v_rcp_f32 v162, v162
    ds_read_b128 v[12:15], v6 offset:12288
    buffer_load_dwordx4 v[132:135], v1, s[8:11], s51 offen offset:2048 sc1
    s_add_u32 s51, s51, 3072
    s_waitcnt vmcnt(19)
    s_waitcnt lgkmcnt(1)
    v_mfma_f32_32x32x16_bf16 v[16:31], v[136:139], v[8:11], v[16:31]
    v_rcp_f32 v163, v163
    v_mfma_f32_32x32x16_bf16 v[32:47], v[140:143], v[8:11], v[32:47]
    v_rcp_f32 v164, v164
    v_mfma_f32_32x32x16_bf16 v[48:63], v[144:147], v[8:11], v[48:63]
    ds_read_b128 v[8:11], v7 offset:8192
    s_waitcnt lgkmcnt(1)
    v_mfma_f32_32x32x16_bf16 v[64:79], v[136:139], v[12:15], v[64:79]
    v_rcp_f32 v165, v165
    buffer_load_dwordx4 v[136:139], v1, s[8:11], s51 offen offset:0 sc1
    v_mfma_f32_32x32x16_bf16 v[80:95], v[140:143], v[12:15], v[80:95]
    v_rcp_f32 v166, v166
    buffer_load_dwordx4 v[140:143], v1, s[8:11], s51 offen offset:1024 sc1
    v_mfma_f32_32x32x16_bf16 v[96:111], v[144:147], v[12:15], v[96:111]
    v_rcp_f32 v167, v167
    ds_read_b128 v[12:15], v7 offset:12288
    buffer_load_dwordx4 v[144:147], v1, s[8:11], s51 offen offset:2048 sc1
    s_add_u32 s51, s51, 3072
    s_waitcnt vmcnt(16)
    s_waitcnt lgkmcnt(1)
    v_mfma_f32_32x32x16_bf16 v[16:31], v[148:151], v[8:11], v[16:31]
    s_add_u32 s52, s52, 1
    s_and_b32 s52, s52, 7
    s_lshl_b32 s44, s52, 9
    s_add_u32 s56, s54, s44
    s_add_u32 s57, s55, s44
    s_add_u32 m0, s48, 8192
    s_add_u32 s44, s56, 0
    buffer_load_dwordx4 v2, s[20:23], s44 offen lds
    v_mfma_f32_32x32x16_bf16 v[32:47], v[152:155], v[8:11], v[32:47]
    v_mul_f32 v232, v232, v160
    v_mul_f32 v233, v233, v161
    s_add_u32 m0, s48, 9216
    s_add_u32 s44, s56, 32768
    buffer_load_dwordx4 v3, s[20:23], s44 offen lds
    v_mfma_f32_32x32x16_bf16 v[48:63], v[156:159], v[8:11], v[48:63]
    v_mul_f32 v234, v234, v162
    s_waitcnt vmcnt(9)
    ds_read_b128 v[8:11], v4 offset:0
    s_add_u32 m0, s48, 10240
    s_add_u32 s44, s56, 65536
    buffer_load_dwordx4 v2, s[20:23], s44 offen lds
    s_waitcnt lgkmcnt(1)
    v_mfma_f32_32x32x16_bf16 v[64:79], v[148:151], v[12:15], v[64:79]
    v_mul_f32 v235, v235, v163
    v_mul_f32 v236, v236, v164
    buffer_load_dwordx4 v[148:151], v1, s[8:11], s51 offen offset:0 sc1
    v_mfma_f32_32x32x16_bf16 v[80:95], v[152:155], v[12:15], v[80:95]
    v_mul_f32 v237, v237, v165
    buffer_load_dwordx4 v[152:155], v1, s[8:11], s51 offen offset:1024 sc1
    v_mfma_f32_32x32x16_bf16 v[96:111], v[156:159], v[12:15], v[96:111]
    v_mul_f32 v238, v238, v166
    v_mul_f32 v239, v239, v167
    ds_read_b128 v[12:15], v4 offset:4096
    buffer_load_dwordx4 v[156:159], v1, s[8:11], s51 offen offset:2048 sc1
    s_add_u32 s50, s50, 1
    s_and_b32 s50, s50, 7
    s_mul_i32 s51, s50, 49152
    s_add_u32 s51, s51, s49
    s_waitcnt lgkmcnt(1)
    v_mfma_f32_32x32x16_bf16 v[16:31], v[112:115], v[8:11], v[16:31]
    s_setprio 1
    v_cmp_ne_u32 vcc, s43, v244
    s_setprio 0
    s_cbranch_vccnz rt_20
rt_20_b:
    s_add_u32 m0, s48, 11264
    s_add_u32 s44, s56, 98304
    buffer_load_dwordx4 v3, s[20:23], s44 offen lds
    v_mfma_f32_32x32x16_bf16 v[32:47], v[116:119], v[8:11], v[32:47]
    s_add_u32 m0, s48, 12288
    s_add_u32 s44, s57, 0
    buffer_load_dwordx4 v2, s[20:23], s44 offen lds
    v_mfma_f32_32x32x16_bf16 v[48:63], v[120:123], v[8:11], v[48:63]
    ds_read_b128 v[8:11], v5 offset:0
    s_add_u32 m0, s48, 13312
    s_add_u32 s44, s57, 32768
    buffer_load_dwordx4 v3, s[20:23], s44 offen lds
    s_waitcnt lgkmcnt(1)
    v_mfma_f32_32x32x16_bf16 v[64:79], v[112:115], v[12:15], v[64:79]
    buffer_load_dwordx4 v[112:115], v1, s[8:11], s51 offen offset:0 sc1
    v_mfma_f32_32x32x16_bf16 v[80:95], v[116:119], v[12:15], v[80:95]
    buffer_load_dwordx4 v[116:119], v1, s[8:11], s51 offen offset:1024 sc1
    v_mfma_f32_32x32x16_bf16 v[96:111], v[120:123], v[12:15], v[96:111]
    ds_read_b128 v[12:15], v5 offset:4096
    buffer_load_dwordx4 v[120:123], v1, s[8:11], s51 offen offset:2048 sc1
    s_add_u32 s51, s51, 3072
    s_waitcnt vmcnt(15)
    s_waitcnt lgkmcnt(1)
    v_mfma_f32_32x32x16_bf16 v[16:31], v[124:127], v[8:11], v[16:31]
    s_add_u32 m0, s48, 14336
    s_add_u32 s44, s57, 65536
    buffer_load_dwordx4 v2, s[20:23], s44 offen lds
    v_mfma_f32_32x32x16_bf16 v[32:47], v[128:131], v[8:11], v[32:47]
    s_add_u32 m0, s48, 15360
    s_add_u32 s44, s57, 98304
    buffer_load_dwordx4 v3, s[20:23], s44 offen lds
    v_mfma_f32_32x32x16_bf16 v[48:63], v[132:135], v[8:11], v[48:63]
    ds_read_b128 v[8:11], v6 offset:0
    s_add_u32 m0, s101, 0
    s_add_u32 s44, s3, 0
    buffer_load_dwordx4 v241, s[8:11], s44 offen offset:0 sc1 lds
    s_waitcnt lgkmcnt(1)
    v_mfma_f32_32x32x16_bf16 v[64:79], v[124:127], v[12:15], v[64:79]
    buffer_load_dwordx4 v[124:127], v1, s[8:11], s51 offen offset:0 sc1
    v_mfma_f32_32x32x16_bf16 v[80:95], v[128:131], v[12:15], v[80:95]
    buffer_load_dwordx4 v[128:131], v1, s[8:11], s51 offen offset:1024 sc1
    v_mfma_f32_32x32x16_bf16 v[96:111], v[132:135], v[12:15], v[96:111]
    ds_read_b128 v[12:15], v6 offset:4096
    buffer_load_dwordx4 v[132:135], v1, s[8:11], s51 offen offset:2048 sc1
    s_add_u32 s51, s51, 3072
    s_waitcnt vmcnt(18)
    s_waitcnt lgkmcnt(1)
    v_mfma_f32_32x32x16_bf16 v[16:31], v[136:139], v[8:11], v[16:31]
    s_add_u32 m0, s101, 0
    s_add_u32 s44, s3, 0
    buffer_load_dwordx4 v241, s[8:11], s44 offen offset:1024 sc1 lds
    v_mfma_f32_32x32x16_bf16 v[32:47], v[140:143], v[8:11], v[32:47]
    s_add_u32 m0, s101, 0
    s_add_u32 s44, s3, 0
    buffer_load_dwordx4 v241, s[8:11], s44 offen offset:2048 sc1 lds
    v_mfma_f32_32x32x16_bf16 v[48:63], v[144:147], v[8:11], v[48:63]
    ds_read_b128 v[8:11], v7 offset:0
    s_add_u32 m0, s101, 0
    s_add_u32 s44, s3, 0
    buffer_load_dwordx4 v241, s[8:11], s44 offen offset:3072 sc1 lds
    s_waitcnt lgkmcnt(1)
    v_mfma_f32_32x32x16_bf16 v[64:79], v[136:139], v[12:15], v[64:79]
    buffer_load_dwordx4 v[136:139], v1, s[8:11], s51 offen offset:0 sc1
    v_mfma_f32_32x32x16_bf16 v[80:95], v[140:143], v[12:15], v[80:95]
    buffer_load_dwordx4 v[140:143], v1, s[8:11], s51 offen offset:1024 sc1
    v_mfma_f32_32x32x16_bf16 v[96:111], v[144:147], v[12:15], v[96:111]
    ds_read_b128 v[12:15], v7 offset:4096
    buffer_load_dwordx4 v[144:147], v1, s[8:11], s51 offen offset:2048 sc1
    s_add_u32 s51, s51, 3072
    s_waitcnt vmcnt(18)
    s_waitcnt lgkmcnt(1)
    v_mfma_f32_32x32x16_bf16 v[16:31], v[148:151], v[8:11], v[16:31]
    s_add_u32 m0, s101, 4096
    s_add_u32 s44, s3, 4096
    buffer_load_dwordx4 v241, s[8:11], s44 offen offset:0 sc1 lds
    v_mfma_f32_32x32x16_bf16 v[32:47], v[152:155], v[8:11], v[32:47]
    s_add_u32 m0, s101, 20480
    s_add_u32 s44, s3, 5120
    buffer_load_dwordx4 v241, s[8:11], s44 offen offset:0 sc1 lds
    v_mfma_f32_32x32x16_bf16 v[48:63], v[156:159], v[8:11], v[48:63]
    s_waitcnt vmcnt(12)
    ds_read_b128 v[8:11], v4 offset:8192
    s_add_u32 m0, s101, 20480
    s_add_u32 s44, s3, 5120
    buffer_load_dwordx4 v241, s[8:11], s44 offen offset:1024 sc1 lds
    s_waitcnt lgkmcnt(1)
    v_mfma_f32_32x32x16_bf16 v[64:79], v[148:151], v[12:15], v[64:79]
    buffer_load_dwordx4 v[148:151], v1, s[8:11], s51 offen offset:0 sc1
    v_mfma_f32_32x32x16_bf16 v[80:95], v[152:155], v[12:15], v[80:95]
    buffer_load_dwordx4 v[152:155], v1, s[8:11], s51 offen offset:1024 sc1
    v_mfma_f32_32x32x16_bf16 v[96:111], v[156:159], v[12:15], v[96:111]
    ds_read_b128 v[12:15], v4 offset:12288
    buffer_load_dwordx4 v[156:159], v1, s[8:11], s51 offen offset:2048 sc1
    s_waitcnt lgkmcnt(0)
    v_mfma_f32_32x32x16_bf16 v[64:79], v[112:115], v[12:15], v[64:79]
    buffer_load_dword v215, v214, s[8:11], s1 offen sc1
    v_mfma_f32_32x32x16_bf16 v[80:95], v[116:119], v[12:15], v[80:95]
    s_add_u32 m0, s101, 61440
    s_add_u32 s44, s3, 15360
    buffer_load_dwordx4 v241, s[8:11], s44 offen offset:0 sc1 lds
    v_mfma_f32_32x32x16_bf16 v[96:111], v[120:123], v[12:15], v[96:111]
    ds_read_b128 v[12:15], v5 offset:12288
    s_add_u32 m0, s101, 61440
    s_add_u32 s44, s3, 15360
    buffer_load_dwordx4 v241, s[8:11], s44 offen offset:1024 sc1 lds
    v_mfma_f32_32x32x16_bf16 v[16:31], v[112:115], v[8:11], v[16:31]
    s_add_u32 m0, s101, 61440
    s_add_u32 s44, s3, 15360
    buffer_load_dwordx4 v241, s[8:11], s44 offen offset:2048 sc1 lds
    v_mfma_f32_32x32x16_bf16 v[32:47], v[116:119], v[8:11], v[32:47]
    s_add_u32 m0, s101, 61440
    s_add_u32 s44, s3, 15360
    buffer_load_dwordx4 v241, s[8:11], s44 offen offset:3072 sc1 lds
    v_mfma_f32_32x32x16_bf16 v[48:63], v[120:123], v[8:11], v[48:63]
    ds_read_b128 v[8:11], v6 offset:12288
    s_add_u32 m0, s101, 65536
    s_add_u32 s44, s3, 19456
    buffer_load_dwordx4 v241, s[8:11], s44 offen offset:0 sc1 lds
    s_waitcnt vmcnt(18)
    s_waitcnt lgkmcnt(1)
    v_mfma_f32_32x32x16_bf16 v[64:79], v[124:127], v[12:15], v[64:79]
    s_add_u32 m0, s101, 20480
    s_add_u32 s44, s3, 5120
    buffer_load_dwordx4 v241, s[8:11], s44 offen offset:2048 sc1 lds
    v_mfma_f32_32x32x16_bf16 v[80:95], v[128:131], v[12:15], v[80:95]
    s_add_u32 m0, s101, 20480
    s_add_u32 s44, s3, 5120
    buffer_load_dwordx4 v241, s[8:11], s44 offen offset:3072 sc1 lds
    v_mfma_f32_32x32x16_bf16 v[96:111], v[132:135], v[12:15], v[96:111]
    ds_read_b128 v[12:15], v7 offset:12288
    s_add_u32 m0, s101, 24576
    s_add_u32 s44, s3, 9216
    buffer_load_dwordx4 v241, s[8:11], s44 offen offset:0 sc1 lds
    s_waitcnt vmcnt(15)
    s_waitcnt lgkmcnt(1)
    v_mfma_f32_32x32x16_bf16 v[64:79], v[136:139], v[8:11], v[64:79]
    s_add_u32 m0, s101, 40960
    s_add_u32 s44, s3, 10240
    buffer_load_dwordx4 v241, s[8:11], s44 offen offset:0 sc1 lds
    v_mfma_f32_32x32x16_bf16 v[80:95], v[140:143], v[8:11], v[80:95]
    s_add_u32 m0, s101, 40960
    s_add_u32 s44, s3, 10240
    buffer_load_dwordx4 v241, s[8:11], s44 offen offset:1024 sc1 lds
    v_mfma_f32_32x32x16_bf16 v[96:111], v[144:147], v[8:11], v[96:111]
    ds_read_b128 v[8:11], v5 offset:8192
    s_add_u32 m0, s101, 40960
    s_add_u32 s44, s3, 10240
    buffer_load_dwordx4 v241, s[8:11], s44 offen offset:2048 sc1 lds
    s_waitcnt vmcnt(12)
    s_waitcnt lgkmcnt(1)
    v_mfma_f32_32x32x16_bf16 v[64:79], v[148:151], v[12:15], v[64:79]
    s_add_u32 m0, s101, 40960
    s_add_u32 s44, s3, 10240
    buffer_load_dwordx4 v241, s[8:11], s44 offen offset:3072 sc1 lds
    ds_read_b64_tr_b16 v[160:161], v249 offset:0
    ds_read_b64_tr_b16 v[162:163], v249 offset:1280
    v_mfma_f32_32x32x16_bf16 v[80:95], v[152:155], v[12:15], v[80:95]
    s_add_u32 m0, s101, 45056
    s_add_u32 s44, s3, 14336
    buffer_load_dwordx4 v241, s[8:11], s44 offen offset:0 sc1 lds
    ds_read_b64_tr_b16 v[164:165], v249 offset:8
    ds_read_b64_tr_b16 v[166:167], v249 offset:1288
    v_mfma_f32_32x32x16_bf16 v[96:111], v[156:159], v[12:15], v[96:111]
    ds_read_b128 v[12:15], v6 offset:8192
    ds_read_b64_tr_b16 v[168:169], v249 offset:16
    ds_read_b64_tr_b16 v[170:171], v249 offset:1296
    s_waitcnt lgkmcnt(7)
    v_mfma_f32_32x32x16_bf16 v[16:31], v[124:127], v[8:11], v[16:31]
    ds_read_b64_tr_b16 v[172:173], v249 offset:24
    ds_read_b64_tr_b16 v[174:175], v249 offset:1304
    v_mfma_f32_32x32x16_bf16 v[32:47], v[128:131], v[8:11], v[32:47]
    ds_read_b64_tr_b16 v[176:177], v249 offset:32
    ds_read_b64_tr_b16 v[178:179], v249 offset:1312
    v_mfma_f32_32x32x16_bf16 v[48:63], v[132:135], v[8:11], v[48:63]
    ds_read_b128 v[8:11], v7 offset:8192
    s_waitcnt vmcnt(5)
    ds_read_b64_tr_b16 v[180:181], v249 offset:20480
    ds_read_b64_tr_b16 v[182:183], v249 offset:21760
    s_waitcnt lgkmcnt(9)
    v_mfma_f32_32x32x16_bf16 v[16:31], v[136:139], v[12:15], v[16:31]
    ds_read_b64_tr_b16 v[184:185], v249 offset:20488
    ds_read_b64_tr_b16 v[186:187], v249 offset:21768
    s_nop 3
    ds_write_b128 v204, v[64:67] offset:0
    ds_write_b128 v204, v[68:71] offset:1024
    v_mfma_f32_32x32x16_bf16 v[32:47], v[140:143], v[12:15], v[32:47]
    ds_read_b64_tr_b16 v[188:189], v249 offset:20496
    ds_read_b64_tr_b16 v[190:191], v249 offset:21776
    ds_write_b128 v204, v[72:75] offset:12288
    ds_write_b128 v204, v[76:79] offset:13312
    v_mfma_f32_32x32x16_bf16 v[48:63], v[144:147], v[12:15], v[48:63]
    ds_read_b64_tr_b16 v[192:193], v249 offset:20504
    ds_read_b64_tr_b16 v[194:195], v249 offset:21784
    ds_write_b128 v204, v[80:83] offset:2048
    ds_write_b128 v204, v[84:87] offset:3072
    s_waitcnt lgkmcnt(14)
    v_mfma_f32_32x32x16_bf16 v[16:31], v[148:151], v[8:11], v[16:31]
    ds_read_b64_tr_b16 v[196:197], v249 offset:20512
    ds_read_b64_tr_b16 v[198:199], v249 offset:21792
    ds_write_b128 v204, v[88:91] offset:14336
    ds_write_b128 v204, v[92:95] offset:15360
    v_mfma_f32_32x32x16_bf16 v[32:47], v[152:155], v[8:11], v[32:47]
    ds_write_b128 v204, v[96:99] offset:4096
    ds_write_b128 v204, v[100:103] offset:5120
    v_mfma_f32_32x32x16_bf16 v[48:63], v[156:159], v[8:11], v[48:63]
    ds_write_b128 v204, v[104:107] offset:16384
    ds_write_b128 v204, v[108:111] offset:17408
    s_setprio 1
    s_nop 7
    ds_write_b128 v204, v[24:27] offset:6144
    ds_write_b128 v204, v[28:31] offset:7168
    ds_write_b128 v204, v[40:43] offset:8192
    ds_write_b128 v204, v[44:47] offset:9216
    ds_write_b128 v204, v[56:59] offset:10240
    ds_write_b128 v204, v[60:63] offset:11264
    v_mov_b32 v252, 8
    s_mov_b64 exec, 1
    ds_write_b32 v254, v252 offset:0
    s_mov_b64 exec, -1
    s_and_b32 s44, s42, 1
    s_lshl_b32 s44, s44, 8
    s_mov_b32 s45, 160256
    v_or_b32 v10, s44, v246
    v_xor_b32 v11, 256, v10
    s_add_u32 m0, s101, 0
    s_add_u32 s44, s3, 20480
    buffer_load_dwordx4 v241, s[8:11], s44 offen offset:0 sc1 lds
    s_add_u32 m0, s101, 0
    s_add_u32 s44, s3, 20480
    buffer_load_dwordx4 v241, s[8:11], s44 offen offset:1024 sc1 lds
    s_add_u32 m0, s101, 0
    s_add_u32 s44, s3, 20480
    buffer_load_dwordx4 v241, s[8:11], s44 offen offset:2048 sc1 lds
    s_add_u32 m0, s101, 0
    s_add_u32 s44, s3, 20480
    buffer_load_dwordx4 v241, s[8:11], s44 offen offset:3072 sc1 lds
    s_add_u32 m0, s101, 4096
    s_add_u32 s44, s3, 24576
    buffer_load_dwordx4 v241, s[8:11], s44 offen offset:0 sc1 lds
    s_waitcnt lgkmcnt(13)
    s_add_u32 m0, s101, 20480
    s_add_u32 s44, s3, 25600
    buffer_load_dwordx4 v241, s[8:11], s44 offen offset:0 sc1 lds
    s_add_u32 m0, s101, 20480
    s_add_u32 s44, s3, 25600
    buffer_load_dwordx4 v241, s[8:11], s44 offen offset:1024 sc1 lds
    s_add_u32 m0, s101, 20480
    s_add_u32 s44, s3, 25600
    buffer_load_dwordx4 v241, s[8:11], s44 offen offset:2048 sc1 lds
    s_add_u32 m0, s101, 20480
    s_add_u32 s44, s3, 25600
    buffer_load_dwordx4 v241, s[8:11], s44 offen offset:3072 sc1 lds
    s_add_u32 m0, s101, 24576
    s_add_u32 s44, s3, 29696
    buffer_load_dwordx4 v241, s[8:11], s44 offen offset:0 sc1 lds
    s_mov_b32 s47, 0x40000
sbw_21:
    ds_read_b32 v252, v255 offset:0
    s_sub_u32 s47, s47, 1
    s_waitcnt lgkmcnt(0)
    v_cmp_gt_u32 vcc, 8, v252
    s_cbranch_scc1 sbw_21_x
    s_cbranch_vccnz sbw_21
sbw_21_x:
    ds_read_b128 v[24:27], v205 offset:6144
    ds_read_b128 v[28:31], v205 offset:7168
    ds_read_b128 v[40:43], v205 offset:8192
    ds_read_b128 v[44:47], v205 offset:9216
    ds_read_b128 v[56:59], v205 offset:10240
    ds_read_b128 v[60:63], v205 offset:11264
    ds_read_b128 v[64:67], v206 offset:0
    ds_read_b128 v[68:71], v206 offset:1024
    ds_read_b128 v[80:83], v206 offset:2048
    ds_read_b128 v[84:87], v206 offset:3072
    ds_read_b128 v[96:99], v206 offset:4096
    ds_read_b128 v[100:103], v206 offset:5120
    ds_read_b128 v[72:75], v207 offset:12288
    ds_read_b128 v[76:79], v207 offset:13312
    ds_read_b128 v[88:91], v207 offset:14336
    ds_read_b128 v[92:95], v207 offset:15360
    ds_read_b128 v[104:107], v207 offset:16384
    ds_read_b128 v[108:111], v207 offset:17408
    v_mov_b32 v252, 9
    s_mov_b64 exec, 1
    ds_write_b32 v254, v252 offset:0
    s_mov_b64 exec, -1
    s_waitcnt lgkmcnt(15)
    v_add_f32 v16, v24, v16
    v_add_f32 v17, v25, v17
    v_add_f32 v18, v26, v18
    v_add_f32 v19, v27, v19
    v_add_f32 v20, v28, v20
    v_add_f32 v21, v29, v21
    v_add_f32 v22, v30, v22
    v_add_f32 v23, v31, v23
    v_add_f32 v32, v40, v32
    v_add_f32 v33, v41, v33
    v_add_f32 v34, v42, v34
    v_add_f32 v35, v43, v35
    v_add_f32 v36, v44, v36
    v_add_f32 v37, v45, v37
    v_add_f32 v38, v46, v38
    v_add_f32 v39, v47, v39
    s_waitcnt lgkmcnt(13)
    v_add_f32 v48, v56, v48
    v_add_f32 v49, v57, v49
    v_add_f32 v50, v58, v50
    v_add_f32 v51, v59, v51
    v_add_f32 v52, v60, v52
    v_add_f32 v53, v61, v53
    v_add_f32 v54, v62, v54
    v_add_f32 v55, v63, v55
    s_waitcnt lgkmcnt(11)
    v_add_f32 v16, v64, v16
    v_add_f32 v17, v65, v17
    v_add_f32 v18, v66, v18
    v_add_f32 v19, v67, v19
    v_add_f32 v20, v68, v20
    v_add_f32 v21, v69, v21
    v_add_f32 v22, v70, v22
    v_add_f32 v23, v71, v23
    s_waitcnt lgkmcnt(9)
    v_add_f32 v32, v80, v32
    v_add_f32 v33, v81, v33
    v_add_f32 v34, v82, v34
    v_add_f32 v35, v83, v35
    v_add_f32 v36, v84, v36
    v_add_f32 v37, v85, v37
    v_add_f32 v38, v86, v38
    v_add_f32 v39, v87, v39
    s_waitcnt lgkmcnt(7)
    v_add_f32 v48, v96, v48
    v_add_f32 v49, v97, v49
    v_add_f32 v50, v98, v50
    v_add_f32 v51, v99, v51
    v_add_f32 v52, v100, v52
    v_add_f32 v53, v101, v53
    v_add_f32 v54, v102, v54
    v_add_f32 v55, v103, v55
    s_waitcnt lgkmcnt(5)
    v_add_f32 v112, v72, v16
    v_add_f32 v113, v73, v17
    v_add_f32 v114, v74, v18
    v_add_f32 v115, v75, v19
    v_add_f32 v116, v76, v20
    v_add_f32 v117, v77, v21
    v_add_f32 v118, v78, v22
    v_add_f32 v119, v79, v23
    s_waitcnt lgkmcnt(3)
    v_add_f32 v120, v88, v32
    v_add_f32 v121, v89, v33
    v_add_f32 v122, v90, v34
    v_add_f32 v123, v91, v35
    v_add_f32 v124, v92, v36
    v_add_f32 v125, v93, v37
    v_add_f32 v126, v94, v38
    v_add_f32 v127, v95, v39
    s_waitcnt lgkmcnt(1)
    v_add_f32 v128, v104, v48
    v_add_f32 v129, v105, v49
    v_add_f32 v130, v106, v50
    v_add_f32 v131, v107, v51
    v_add_f32 v132, v108, v52
    v_add_f32 v133, v109, v53
    v_add_f32 v134, v110, v54
    v_add_f32 v135, v111, v55
    v_mul_f32 v112, v216, v112
    v_mul_f32 v113, v217, v113
    v_mul_f32 v114, v218, v114
    v_mul_f32 v115, v219, v115
    v_mul_f32 v116, v220, v116
    v_mul_f32 v117, v221, v117
    v_mul_f32 v118, v222, v118
    v_mul_f32 v119, v223, v119
    v_cvt_pk_bf16_f32 v16, v112, v113
    v_cvt_pk_bf16_f32 v17, v114, v115
    v_cvt_pk_bf16_f32 v18, v116, v117
    v_cvt_pk_bf16_f32 v19, v118, v119
    buffer_store_dwordx4 v[16:19], v200, s[8:11], s0 offen offset:0 sc1
    v_mul_f32 v120, v224, v120
    v_mul_f32 v121, v225, v121
    v_mul_f32 v122, v226, v122
    v_mul_f32 v123, v227, v123
    v_mul_f32 v124, v228, v124
    v_mul_f32 v125, v229, v125
    v_mul_f32 v126, v230, v126
    v_mul_f32 v127, v231, v127
    v_cvt_pk_bf16_f32 v20, v120, v121
    v_cvt_pk_bf16_f32 v21, v122, v123
    v_cvt_pk_bf16_f32 v22, v124, v125
    v_cvt_pk_bf16_f32 v23, v126, v127
    buffer_store_dwordx4 v[20:23], v200, s[8:11], s0 offen offset:2048 sc1
    v_mul_f32 v128, v232, v128
    v_mul_f32 v129, v233, v129
    v_mul_f32 v130, v234, v130
    v_mul_f32 v131, v235, v131
    v_mul_f32 v132, v236, v132
    v_mul_f32 v133, v237, v133
    v_mul_f32 v134, v238, v134
    v_mul_f32 v135, v239, v135
    v_cvt_pk_bf16_f32 v24, v128, v129
    v_cvt_pk_bf16_f32 v25, v130, v131
    v_cvt_pk_bf16_f32 v26, v132, v133
    v_cvt_pk_bf16_f32 v27, v134, v135
    buffer_store_dwordx4 v[24:27], v200, s[8:11], s100 offen offset:0 sc1
    v_lshlrev_b32 v1, 4, v0
    s_xor_b32 s44, s42, 0
    s_mul_i32 s44, s44, 5120
    s_add_u32 s44, s44, 73728
    v_add_u32 v12, s44, v1
    s_xor_b32 s44, s42, 1
    s_mul_i32 s44, s44, 5120
    s_add_u32 s44, s44, 73728
    v_add_u32 v13, s44, v1
    s_xor_b32 s44, s42, 2
    s_mul_i32 s44, s44, 5120
    s_add_u32 s44, s44, 73728
    v_add_u32 v14, s44, v1
    s_xor_b32 s44, s42, 3
    s_mul_i32 s44, s44, 5120
    s_add_u32 s44, s44, 73728
    v_add_u32 v15, s44, v1
    v_cmp_ne_u32 vcc, s43, v215
    s_cbranch_vccz fc_22
    s_movk_i32 s47, 0x4000
poll_23:
    buffer_load_dword v215, v214, s[8:11], s1 offen sc1
    s_sub_u32 s47, s47, 1
    s_cbranch_scc1 poll_23_x
    s_waitcnt vmcnt(0)
    v_cmp_ne_u32 vcc, s43, v215
    s_cbranch_vccnz poll_23
poll_23_x:
    s_waitcnt vmcnt(0)
fc_22:
    s_waitcnt vmcnt(13)
    ds_read_b64_tr_b16 v[200:201], v249 offset:40960
    ds_read_b64_tr_b16 v[202:203], v249 offset:42240
    ds_read_b64_tr_b16 v[204:205], v249 offset:40968
    ds_read_b64_tr_b16 v[206:207], v249 offset:42248
    ds_read_b64_tr_b16 v[208:209], v249 offset:40976
    ds_read_b64_tr_b16 v[210:211], v249 offset:42256
    ds_read_b64_tr_b16 v[212:213], v249 offset:40984
    ds_read_b64_tr_b16 v[214:215], v249 offset:42264
    ds_read_b64_tr_b16 v[216:217], v249 offset:40992
    ds_read_b64_tr_b16 v[218:219], v249 offset:42272
    ds_read_b64_tr_b16 v[220:221], v249 offset:61440
    ds_read_b64_tr_b16 v[222:223], v249 offset:62720
    ds_read_b64_tr_b16 v[224:225], v249 offset:61448
    ds_read_b64_tr_b16 v[226:227], v249 offset:62728
    ds_read_b64_tr_b16 v[228:229], v249 offset:61456
    ds_read_b64_tr_b16 v[230:231], v249 offset:62736
    ds_read_b64_tr_b16 v[232:233], v249 offset:61464
    ds_read_b64_tr_b16 v[234:235], v249 offset:62744
    ds_read_b64_tr_b16 v[236:237], v249 offset:61472
    ds_read_b64_tr_b16 v[238:239], v249 offset:62752
    s_lshl2_add_u32 s44, s40, s42
    s_mul_i32 s0, s44, 20480
    s_add_u32 s45, s7, 22528
    s_cmp_ge_u32 s42, 2
    s_cselect_b32 s62, s45, s7
    s_cselect_b32 s63, s7, s45
    s_add_u32 s7, s7, 14336
    s_mul_i32 s46, s41, 160
    s_add_u32 s0, s0, s46
    s_waitcnt lgkmcnt(0)
    s_add_u32 m0, s101, 40960
    s_add_u32 s44, s3, 30720
    buffer_load_dwordx4 v241, s[8:11], s44 offen offset:0 sc1 lds
    s_add_u32 m0, s101, 40960
    s_add_u32 s44, s3, 30720
    buffer_load_dwordx4 v241, s[8:11], s44 offen offset:1024 sc1 lds
    s_add_u32 m0, s101, 40960
    s_add_u32 s44, s3, 30720
    buffer_load_dwordx4 v241, s[8:11], s44 offen offset:2048 sc1 lds
    s_add_u32 m0, s101, 40960
    s_add_u32 s44, s3, 30720
    buffer_load_dwordx4 v241, s[8:11], s44 offen offset:3072 sc1 lds
    s_add_u32 m0, s101, 45056
    s_add_u32 s44, s3, 34816
    buffer_load_dwordx4 v241, s[8:11], s44 offen offset:0 sc1 lds
    s_add_u32 m0, s101, 61440
    s_add_u32 s44, s3, 35840
    buffer_load_dwordx4 v241, s[8:11], s44 offen offset:0 sc1 lds
    s_add_u32 m0, s101, 61440
    s_add_u32 s44, s3, 35840
    buffer_load_dwordx4 v241, s[8:11], s44 offen offset:1024 sc1 lds
    s_add_u32 m0, s101, 61440
    s_add_u32 s44, s3, 35840
    buffer_load_dwordx4 v241, s[8:11], s44 offen offset:2048 sc1 lds
    s_add_u32 m0, s101, 61440
    s_add_u32 s44, s3, 35840
    buffer_load_dwordx4 v241, s[8:11], s44 offen offset:3072 sc1 lds
    s_add_u32 m0, s101, 65536
    s_add_u32 s44, s3, 39936
    buffer_load_dwordx4 v241, s[8:11], s44 offen offset:0 sc1 lds
sp_24:
    buffer_load_dword v252, v250, s[8:11], s7 offen sc1
    s_cmp_eq_u32 s98, 0
    s_cbranch_scc1 sp_24_x
    s_sub_u32 s98, s98, 1
    s_waitcnt vmcnt(0)
    v_cmp_eq_u32 vcc, -1, v252
    s_cbranch_vccnz sp_24
sp_24_x:
    s_waitcnt vmcnt(0)
    s_add_u32 s45, s62, 10240
    buffer_load_dwordx4 v[96:99], v10, s[8:11], s45 offen sc1
    s_add_u32 s45, s62, 10240
    buffer_load_dwordx4 v[100:103], v11, s[8:11], s45 offen sc1
    s_add_u32 s45, s63, 10240
    buffer_load_dwordx4 v[104:107], v10, s[8:11], s45 offen sc1
    s_add_u32 s45, s63, 10240
    buffer_load_dwordx4 v[108:111], v11, s[8:11], s45 offen sc1
    s_add_u32 s45, s62, 12288
    buffer_load_dwordx4 v[112:115], v10, s[8:11], s45 offen sc1
    s_add_u32 s45, s62, 12288
    buffer_load_dwordx4 v[116:119], v11, s[8:11], s45 offen sc1
    s_add_u32 s45, s63, 12288
    buffer_load_dwordx4 v[120:123], v10, s[8:11], s45 offen sc1
    s_add_u32 s45, s63, 12288
    buffer_load_dwordx4 v[124:127], v11, s[8:11], s45 offen sc1
    s_add_u32 s45, s62, 14336
    buffer_load_dwordx4 v[128:131], v10, s[8:11], s45 offen sc1
    s_add_u32 s45, s62, 14336
    buffer_load_dwordx4 v[132:135], v11, s[8:11], s45 offen sc1
    s_setprio 0
    s_waitcnt vmcnt(9)
    s_setprio 1
    v_cmp_eq_u32 vcc, -1, v96
    s_setprio 0
    s_cbranch_vccnz rt_25
rt_25_b:
    v_mfma_f32_16x16x32_bf16 v[16:19], v[160:163], v[96:99], 0
    s_add_u32 s45, s63, 14336
    buffer_load_dwordx4 v[136:139], v10, s[8:11], s45 offen sc1
    v_mfma_f32_16x16x32_bf16 v[20:23], v[164:167], v[96:99], 0
    v_mfma_f32_16x16x32_bf16 v[24:27], v[168:171], v[96:99], 0
    v_mfma_f32_16x16x32_bf16 v[28:31], v[172:175], v[96:99], 0
    s_add_u32 s45, s63, 14336
    buffer_load_dwordx4 v[140:143], v11, s[8:11], s45 offen sc1
    s_waitcnt vmcnt(10)
    s_setprio 1
    v_cmp_eq_u32 vcc, -1, v100
    s_setprio 0
    v_mfma_f32_16x16x32_bf16 v[32:35], v[176:179], v[96:99], 0
    s_cbranch_vccnz rt_26
rt_26_b:
    v_mfma_f32_16x16x32_bf16 v[36:39], v[160:163], v[100:103], 0
    v_mfma_f32_16x16x32_bf16 v[40:43], v[164:167], v[100:103], 0
    s_add_u32 s45, s62, 16384
    buffer_load_dwordx4 v[144:147], v10, s[8:11], s45 offen sc1
    v_mfma_f32_16x16x32_bf16 v[44:47], v[168:171], v[100:103], 0
    v_mfma_f32_16x16x32_bf16 v[48:51], v[172:175], v[100:103], 0
    s_waitcnt vmcnt(10)
    s_setprio 1
    v_cmp_eq_u32 vcc, -1, v104
    s_setprio 0
    v_mfma_f32_16x16x32_bf16 v[52:55], v[176:179], v[100:103], 0
    s_cbranch_vccnz rt_27
rt_27_b:
    s_add_u32 s45, s62, 16384
    buffer_load_dwordx4 v[148:151], v11, s[8:11], s45 offen sc1
    v_mfma_f32_16x16x32_bf16 v[56:59], v[160:163], v[104:107], 0
    v_mfma_f32_16x16x32_bf16 v[60:63], v[164:167], v[104:107], 0
    v_mfma_f32_16x16x32_bf16 v[64:67], v[168:171], v[104:107], 0
    s_add_u32 s45, s63, 16384
    buffer_load_dwordx4 v[152:155], v10, s[8:11], s45 offen sc1
    v_mfma_f32_16x16x32_bf16 v[68:71], v[172:175], v[104:107], 0
    s_waitcnt vmcnt(11)
    s_setprio 1
    v_cmp_eq_u32 vcc, -1, v108
    s_setprio 0
    v_mfma_f32_16x16x32_bf16 v[72:75], v[176:179], v[104:107], 0
    s_cbranch_vccnz rt_28
rt_28_b:
    v_mfma_f32_16x16x32_bf16 v[76:79], v[160:163], v[108:111], 0
    s_add_u32 s45, s63, 16384
    buffer_load_dwordx4 v[156:159], v11, s[8:11], s45 offen sc1
    v_mfma_f32_16x16x32_bf16 v[80:83], v[164:167], v[108:111], 0
    v_mfma_f32_16x16x32_bf16 v[84:87], v[168:171], v[108:111], 0
    v_mfma_f32_16x16x32_bf16 v[88:91], v[172:175], v[108:111], 0
    s_waitcnt vmcnt(11)
    s_setprio 1
    v_cmp_eq_u32 vcc, -1, v112
    s_setprio 0
    v_mfma_f32_16x16x32_bf16 v[92:95], v[176:179], v[108:111], 0
    s_cbranch_vccnz rt_29
rt_29_b:
    v_mfma_f32_16x16x32_bf16 v[16:19], v[180:183], v[112:115], v[16:19]
    v_mfma_f32_16x16x32_bf16 v[20:23], v[184:187], v[112:115], v[20:23]
    s_add_u32 s45, s62, 18432
    buffer_load_dwordx4 v[96:99], v10, s[8:11], s45 offen sc1
    v_mfma_f32_16x16x32_bf16 v[24:27], v[188:191], v[112:115], v[24:27]
    v_mfma_f32_16x16x32_bf16 v[28:31], v[192:195], v[112:115], v[28:31]
    s_add_u32 s45, s62, 18432
    buffer_load_dwordx4 v[100:103], v11, s[8:11], s45 offen sc1
    s_waitcnt vmcnt(12)
    s_setprio 1
    v_cmp_eq_u32 vcc, -1, v116
    s_setprio 0
    v_mfma_f32_16x16x32_bf16 v[32:35], v[196:199], v[112:115], v[32:35]
    s_cbranch_vccnz rt_30
rt_30_b:
    ds_read_b64_tr_b16 v[160:161], v249 offset:0
    v_mfma_f32_16x16x32_bf16 v[36:39], v[180:183], v[116:119], v[36:39]
    s_add_u32 s45, s63, 18432
    buffer_load_dwordx4 v[104:107], v10, s[8:11], s45 offen sc1
    ds_read_b64_tr_b16 v[162:163], v249 offset:1280
    v_mfma_f32_16x16x32_bf16 v[40:43], v[184:187], v[116:119], v[40:43]
    ds_read_b64_tr_b16 v[164:165], v249 offset:8
    v_mfma_f32_16x16x32_bf16 v[44:47], v[188:191], v[116:119], v[44:47]
    s_add_u32 s45, s63, 18432
    buffer_load_dwordx4 v[108:111], v11, s[8:11], s45 offen sc1
    ds_read_b64_tr_b16 v[166:167], v249 offset:1288
    v_mfma_f32_16x16x32_bf16 v[48:51], v[192:195], v[116:119], v[48:51]
    ds_read_b64_tr_b16 v[168:169], v249 offset:16
    s_waitcnt vmcnt(13)
    s_setprio 1
    v_cmp_eq_u32 vcc, -1, v120
    s_setprio 0
    v_mfma_f32_16x16x32_bf16 v[52:55], v[196:199], v[116:119], v[52:55]
    s_cbranch_vccnz rt_31
rt_31_b:
    ds_read_b64_tr_b16 v[170:171], v249 offset:1296
    v_mfma_f32_16x16x32_bf16 v[56:59], v[180:183], v[120:123], v[56:59]
    ds_read_b64_tr_b16 v[172:173], v249 offset:24
    v_mfma_f32_16x16x32_bf16 v[60:63], v[184:187], v[120:123], v[60:63]
    ds_read_b64_tr_b16 v[174:175], v249 offset:1304
    v_mfma_f32_16x16x32_bf16 v[64:67], v[188:191], v[120:123], v[64:67]
    ds_read_b64_tr_b16 v[176:177], v249 offset:32
    v_mfma_f32_16x16x32_bf16 v[68:71], v[192:195], v[120:123], v[68:71]
    ds_read_b64_tr_b16 v[178:179], v249 offset:1312
    s_waitcnt vmcnt(12)
    s_setprio 1
    v_cmp_eq_u32 vcc, -1, v124
    s_setprio 0
    v_mfma_f32_16x16x32_bf16 v[72:75], v[196:199], v[120:123], v[72:75]
    s_cbranch_vccnz rt_32
rt_32_b:
    v_mfma_f32_16x16x32_bf16 v[76:79], v[180:183], v[124:127], v[76:79]
    v_mfma_f32_16x16x32_bf16 v[80:83], v[184:187], v[124:127], v[80:83]
    v_mfma_f32_16x16x32_bf16 v[84:87], v[188:191], v[124:127], v[84:87]
    v_mfma_f32_16x16x32_bf16 v[88:91], v[192:195], v[124:127], v[88:91]
    s_waitcnt vmcnt(11)
    s_setprio 1
    v_cmp_eq_u32 vcc, -1, v128
    s_setprio 0
    v_mfma_f32_16x16x32_bf16 v[92:95], v[196:199], v[124:127], v[92:95]
    s_cbranch_vccnz rt_33
rt_33_b:
    v_mfma_f32_16x16x32_bf16 v[16:19], v[200:203], v[128:131], v[16:19]
    v_mfma_f32_16x16x32_bf16 v[20:23], v[204:207], v[128:131], v[20:23]
    s_add_u32 s45, s62, 20480
    buffer_load_dwordx4 v[112:115], v10, s[8:11], s45 offen sc1
    v_mfma_f32_16x16x32_bf16 v[24:27], v[208:211], v[128:131], v[24:27]
    v_mfma_f32_16x16x32_bf16 v[28:31], v[212:215], v[128:131], v[28:31]
    s_add_u32 s45, s62, 20480
    buffer_load_dwordx4 v[116:119], v11, s[8:11], s45 offen sc1
    s_waitcnt vmcnt(12)
    s_setprio 1
    v_cmp_eq_u32 vcc, -1, v132
    s_setprio 0
    v_mfma_f32_16x16x32_bf16 v[32:35], v[216:219], v[128:131], v[32:35]
    s_cbranch_vccnz rt_34
rt_34_b:
    ds_read_b64_tr_b16 v[180:181], v249 offset:20480
    v_mfma_f32_16x16x32_bf16 v[36:39], v[200:203], v[132:135], v[36:39]
    s_add_u32 s45, s63, 20480
    buffer_load_dwordx4 v[120:123], v10, s[8:11], s45 offen sc1
    ds_read_b64_tr_b16 v[182:183], v249 offset:21760
    v_mfma_f32_16x16x32_bf16 v[40:43], v[204:207], v[132:135], v[40:43]
    ds_read_b64_tr_b16 v[184:185], v249 offset:20488
    v_mfma_f32_16x16x32_bf16 v[44:47], v[208:211], v[132:135], v[44:47]
    s_add_u32 s45, s63, 20480
    buffer_load_dwordx4 v[124:127], v11, s[8:11], s45 offen sc1
    ds_read_b64_tr_b16 v[186:187], v249 offset:21768
    v_mfma_f32_16x16x32_bf16 v[48:51], v[212:215], v[132:135], v[48:51]
    ds_read_b64_tr_b16 v[188:189], v249 offset:20496
    s_waitcnt vmcnt(13)
    s_setprio 1
    v_cmp_eq_u32 vcc, -1, v136
    s_setprio 0
    v_mfma_f32_16x16x32_bf16 v[52:55], v[216:219], v[132:135], v[52:55]
    s_cbranch_vccnz rt_35
rt_35_b:
    s_waitcnt lgkmcnt(5)
    s_add_u32 m0, s101, 0
    s_add_u32 s44, s3, 40960
    buffer_load_dwordx4 v241, s[8:11], s44 offen offset:0 sc1 lds
    ds_read_b64_tr_b16 v[190:191], v249 offset:21776
    v_mfma_f32_16x16x32_bf16 v[56:59], v[200:203], v[136:139], v[56:59]
    ds_read_b64_tr_b16 v[192:193], v249 offset:20504
    v_mfma_f32_16x16x32_bf16 v[60:63], v[204:207], v[136:139], v[60:63]
    s_add_u32 m0, s101, 0
    s_add_u32 s44, s3, 40960
    buffer_load_dwordx4 v241, s[8:11], s44 offen offset:1024 sc1 lds
    ds_read_b64_tr_b16 v[194:195], v249 offset:21784
    v_mfma_f32_16x16x32_bf16 v[64:67], v[208:211], v[136:139], v[64:67]
    ds_read_b64_tr_b16 v[196:197], v249 offset:20512
    v_mfma_f32_16x16x32_bf16 v[68:71], v[212:215], v[136:139], v[68:71]
    s_add_u32 m0, s101, 0
    s_add_u32 s44, s3, 40960
    buffer_load_dwordx4 v241, s[8:11], s44 offen offset:2048 sc1 lds
    ds_read_b64_tr_b16 v[198:199], v249 offset:21792
    s_waitcnt vmcnt(15)
    s_setprio 1
    v_cmp_eq_u32 vcc, -1, v140
    s_setprio 0
    v_mfma_f32_16x16x32_bf16 v[72:75], v[216:219], v[136:139], v[72:75]
    s_cbranch_vccnz rt_36
rt_36_b:
    v_mfma_f32_16x16x32_bf16 v[76:79], v[200:203], v[140:143], v[76:79]
    s_add_u32 m0, s101, 0
    s_add_u32 s44, s3, 40960
    buffer_load_dwordx4 v241, s[8:11], s44 offen offset:3072 sc1 lds
    v_mfma_f32_16x16x32_bf16 v[80:83], v[204:207], v[140:143], v[80:83]
    v_mfma_f32_16x16x32_bf16 v[84:87], v[208:211], v[140:143], v[84:87]
    s_add_u32 m0, s101, 4096
    s_add_u32 s44, s3, 45056
    buffer_load_dwordx4 v241, s[8:11], s44 offen offset:0 sc1 lds
    v_mfma_f32_16x16x32_bf16 v[88:91], v[212:215], v[140:143], v[88:91]
    s_waitcnt vmcnt(16)
    s_setprio 1
    v_cmp_eq_u32 vcc, -1, v144
    s_setprio 0
    v_mfma_f32_16x16x32_bf16 v[92:95], v[216:219], v[140:143], v[92:95]
    s_cbranch_vccnz rt_37
rt_37_b:
    v_mfma_f32_16x16x32_bf16 v[16:19], v[220:223], v[144:147], v[16:19]
    v_mfma_f32_16x16x32_bf16 v[20:23], v[224:227], v[144:147], v[20:23]
    s_waitcnt lgkmcnt(0)
    s_add_u32 m0, s101, 20480
    s_add_u32 s44, s3, 46080
    buffer_load_dwordx4 v241, s[8:11], s44 offen offset:0 sc1 lds
    v_mfma_f32_16x16x32_bf16 v[24:27], v[228:231], v[144:147], v[24:27]
    v_mfma_f32_16x16x32_bf16 v[28:31], v[232:235], v[144:147], v[28:31]
    s_add_u32 m0, s101, 20480
    s_add_u32 s44, s3, 46080
    buffer_load_dwordx4 v241, s[8:11], s44 offen offset:1024 sc1 lds
    s_waitcnt vmcnt(17)
    s_setprio 1
    v_cmp_eq_u32 vcc, -1, v148
    s_setprio 0
    v_mfma_f32_16x16x32_bf16 v[32:35], v[236:239], v[144:147], v[32:35]
    s_cbranch_vccnz rt_38
rt_38_b:
    ds_read_b64_tr_b16 v[200:201], v249 offset:40960
    v_mfma_f32_16x16x32_bf16 v[36:39], v[220:223], v[148:151], v[36:39]
    s_add_u32 m0, s101, 20480
    s_add_u32 s44, s3, 46080
    buffer_load_dwordx4 v241, s[8:11], s44 offen offset:2048 sc1 lds
    ds_read_b64_tr_b16 v[202:203], v249 offset:42240
    v_mfma_f32_16x16x32_bf16 v[40:43], v[224:227], v[148:151], v[40:43]
    ds_read_b64_tr_b16 v[204:205], v249 offset:40968
    v_mfma_f32_16x16x32_bf16 v[44:47], v[228:231], v[148:151], v[44:47]
    s_add_u32 m0, s101, 20480
    s_add_u32 s44, s3, 46080
    buffer_load_dwordx4 v241, s[8:11], s44 offen offset:3072 sc1 lds
    ds_read_b64_tr_b16 v[206:207], v249 offset:42248
    v_mfma_f32_16x16x32_bf16 v[48:51], v[232:235], v[148:151], v[48:51]
    ds_read_b64_tr_b16 v[208:209], v249 offset:40976
    s_waitcnt vmcnt(18)
    s_setprio 1
    v_cmp_eq_u32 vcc, -1, v152
    s_setprio 0
    v_mfma_f32_16x16x32_bf16 v[52:55], v[236:239], v[148:151], v[52:55]
    s_cbranch_vccnz rt_39
rt_39_b:
    s_add_u32 m0, s101, 24576
    s_add_u32 s44, s3, 50176
    buffer_load_dwordx4 v241, s[8:11], s44 offen offset:0 sc1 lds
    ds_read_b64_tr_b16 v[210:211], v249 offset:42256
    v_mfma_f32_16x16x32_bf16 v[56:59], v[220:223], v[152:155], v[56:59]
    ds_read_b64_tr_b16 v[212:213], v249 offset:40984
    v_mfma_f32_16x16x32_bf16 v[60:63], v[224:227], v[152:155], v[60:63]
    ds_read_b64_tr_b16 v[214:215], v249 offset:42264
    v_mfma_f32_16x16x32_bf16 v[64:67], v[228:231], v[152:155], v[64:67]
    ds_read_b64_tr_b16 v[216:217], v249 offset:40992
    v_mfma_f32_16x16x32_bf16 v[68:71], v[232:235], v[152:155], v[68:71]
    ds_read_b64_tr_b16 v[218:219], v249 offset:42272
    s_waitcnt vmcnt(18)
    s_setprio 1
    v_cmp_eq_u32 vcc, -1, v156
    s_setprio 0
    v_mfma_f32_16x16x32_bf16 v[72:75], v[236:239], v[152:155], v[72:75]
    s_cbranch_vccnz rt_40
rt_40_b:
    v_mfma_f32_16x16x32_bf16 v[76:79], v[220:223], v[156:159], v[76:79]
    v_mfma_f32_16x16x32_bf16 v[80:83], v[224:227], v[156:159], v[80:83]
    v_mfma_f32_16x16x32_bf16 v[84:87], v[228:231], v[156:159], v[84:87]
    v_mfma_f32_16x16x32_bf16 v[88:91], v[232:235], v[156:159], v[88:91]
    s_waitcnt vmcnt(17)
    s_setprio 1
    v_cmp_eq_u32 vcc, -1, v96
    s_setprio 0
    v_mfma_f32_16x16x32_bf16 v[92:95], v[236:239], v[156:159], v[92:95]
    s_cbranch_vccnz rt_41
rt_41_b:
    v_mfma_f32_16x16x32_bf16 v[16:19], v[160:163], v[96:99], v[16:19]
    v_mfma_f32_16x16x32_bf16 v[20:23], v[164:167], v[96:99], v[20:23]
    s_waitcnt lgkmcnt(0)
    s_add_u32 m0, s101, 40960
    s_add_u32 s44, s3, 51200
    buffer_load_dwordx4 v241, s[8:11], s44 offen offset:0 sc1 lds
    v_mfma_f32_16x16x32_bf16 v[24:27], v[168:171], v[96:99], v[24:27]
    v_mfma_f32_16x16x32_bf16 v[28:31], v[172:175], v[96:99], v[28:31]
    s_add_u32 m0, s101, 40960
    s_add_u32 s44, s3, 51200
    buffer_load_dwordx4 v241, s[8:11], s44 offen offset:1024 sc1 lds
    s_waitcnt vmcnt(18)
    s_setprio 1
    v_cmp_eq_u32 vcc, -1, v100
    s_setprio 0
    v_mfma_f32_16x16x32_bf16 v[32:35], v[176:179], v[96:99], v[32:35]
    s_cbranch_vccnz rt_42
rt_42_b:
    ds_read_b64_tr_b16 v[220:221], v249 offset:61440
    v_mfma_f32_16x16x32_bf16 v[36:39], v[160:163], v[100:103], v[36:39]
    s_add_u32 m0, s101, 40960
    s_add_u32 s44, s3, 51200
    buffer_load_dwordx4 v241, s[8:11], s44 offen offset:2048 sc1 lds
    ds_read_b64_tr_b16 v[222:223], v249 offset:62720
    v_mfma_f32_16x16x32_bf16 v[40:43], v[164:167], v[100:103], v[40:43]
    ds_read_b64_tr_b16 v[224:225], v249 offset:61448
    v_mfma_f32_16x16x32_bf16 v[44:47], v[168:171], v[100:103], v[44:47]
    s_add_u32 m0, s101, 40960
    s_add_u32 s44, s3, 51200
    buffer_load_dwordx4 v241, s[8:11], s44 offen offset:3072 sc1 lds
    ds_read_b64_tr_b16 v[226:227], v249 offset:62728
    v_mfma_f32_16x16x32_bf16 v[48:51], v[172:175], v[100:103], v[48:51]
    ds_read_b64_tr_b16 v[228:229], v249 offset:61456
    s_waitcnt vmcnt(19)
    s_setprio 1
    v_cmp_eq_u32 vcc, -1, v104
    s_setprio 0
    v_mfma_f32_16x16x32_bf16 v[52:55], v[176:179], v[100:103], v[52:55]
    s_cbranch_vccnz rt_43
rt_43_b:
    s_add_u32 m0, s101, 45056
    s_add_u32 s44, s3, 55296
    buffer_load_dwordx4 v241, s[8:11], s44 offen offset:0 sc1 lds
    ds_read_b64_tr_b16 v[230:231], v249 offset:62736
    v_mfma_f32_16x16x32_bf16 v[56:59], v[160:163], v[104:107], v[56:59]
    ds_read_b64_tr_b16 v[232:233], v249 offset:61464
    v_mfma_f32_16x16x32_bf16 v[60:63], v[164:167], v[104:107], v[60:63]
    ds_read_b64_tr_b16 v[234:235], v249 offset:62744
    v_mfma_f32_16x16x32_bf16 v[64:67], v[168:171], v[104:107], v[64:67]
    ds_read_b64_tr_b16 v[236:237], v249 offset:61472
    v_mfma_f32_16x16x32_bf16 v[68:71], v[172:175], v[104:107], v[68:71]
    ds_read_b64_tr_b16 v[238:239], v249 offset:62752
    s_waitcnt vmcnt(19)
    s_setprio 1
    v_cmp_eq_u32 vcc, -1, v108
    s_setprio 0
    v_mfma_f32_16x16x32_bf16 v[72:75], v[176:179], v[104:107], v[72:75]
    s_cbranch_vccnz rt_44
rt_44_b:
    v_mfma_f32_16x16x32_bf16 v[76:79], v[160:163], v[108:111], v[76:79]
    v_mfma_f32_16x16x32_bf16 v[80:83], v[164:167], v[108:111], v[80:83]
    v_mfma_f32_16x16x32_bf16 v[84:87], v[168:171], v[108:111], v[84:87]
    v_mfma_f32_16x16x32_bf16 v[88:91], v[172:175], v[108:111], v[88:91]
    s_waitcnt vmcnt(18)
    s_setprio 1
    v_cmp_eq_u32 vcc, -1, v112
    s_setprio 0
    v_mfma_f32_16x16x32_bf16 v[92:95], v[176:179], v[108:111], v[92:95]
    s_cbranch_vccnz rt_45
rt_45_b:
    v_mfma_f32_16x16x32_bf16 v[16:19], v[180:183], v[112:115], v[16:19]
    v_mfma_f32_16x16x32_bf16 v[20:23], v[184:187], v[112:115], v[20:23]
    v_mfma_f32_16x16x32_bf16 v[24:27], v[188:191], v[112:115], v[24:27]
    v_mfma_f32_16x16x32_bf16 v[28:31], v[192:195], v[112:115], v[28:31]
    s_waitcnt vmcnt(17)
    s_setprio 1
    v_cmp_eq_u32 vcc, -1, v116
    s_setprio 0
    v_mfma_f32_16x16x32_bf16 v[32:35], v[196:199], v[112:115], v[32:35]
    s_cbranch_vccnz rt_46
rt_46_b:
    s_waitcnt vmcnt(10)
    ds_read_b64_tr_b16 v[160:161], v249 offset:0
    v_mfma_f32_16x16x32_bf16 v[36:39], v[180:183], v[116:119], v[36:39]
    ds_read_b64_tr_b16 v[162:163], v249 offset:1280
    v_mfma_f32_16x16x32_bf16 v[40:43], v[184:187], v[116:119], v[40:43]
    ds_read_b64_tr_b16 v[164:165], v249 offset:8
    v_mfma_f32_16x16x32_bf16 v[44:47], v[188:191], v[116:119], v[44:47]
    ds_read_b64_tr_b16 v[166:167], v249 offset:1288
    v_mfma_f32_16x16x32_bf16 v[48:51], v[192:195], v[116:119], v[48:51]
    ds_read_b64_tr_b16 v[168:169], v249 offset:16
    s_setprio 1
    v_cmp_eq_u32 vcc, -1, v120
    s_setprio 0
    v_mfma_f32_16x16x32_bf16 v[52:55], v[196:199], v[116:119], v[52:55]
    s_cbranch_vccnz rt_47
rt_47_b:
    ds_read_b64_tr_b16 v[170:171], v249 offset:1296
    v_mfma_f32_16x16x32_bf16 v[56:59], v[180:183], v[120:123], v[56:59]
    ds_read_b64_tr_b16 v[172:173], v249 offset:24
    v_mfma_f32_16x16x32_bf16 v[60:63], v[184:187], v[120:123], v[60:63]
    ds_read_b64_tr_b16 v[174:175], v249 offset:1304
    v_mfma_f32_16x16x32_bf16 v[64:67], v[188:191], v[120:123], v[64:67]
    ds_read_b64_tr_b16 v[176:177], v249 offset:32
    v_mfma_f32_16x16x32_bf16 v[68:71], v[192:195], v[120:123], v[68:71]
    ds_read_b64_tr_b16 v[178:179], v249 offset:1312
    s_setprio 1
    v_cmp_eq_u32 vcc, -1, v124
    s_setprio 0
    v_mfma_f32_16x16x32_bf16 v[72:75], v[196:199], v[120:123], v[72:75]
    s_cbranch_vccnz rt_48
rt_48_b:
    v_mfma_f32_16x16x32_bf16 v[76:79], v[180:183], v[124:127], v[76:79]
    v_mfma_f32_16x16x32_bf16 v[80:83], v[184:187], v[124:127], v[80:83]
    v_mfma_f32_16x16x32_bf16 v[84:87], v[188:191], v[124:127], v[84:87]
    v_mfma_f32_16x16x32_bf16 v[88:91], v[192:195], v[124:127], v[88:91]
    v_mfma_f32_16x16x32_bf16 v[92:95], v[196:199], v[124:127], v[92:95]
    s_setprio 1
    v_mov_b32 v250, v247
    s_sub_u32 s7, s7, 5632
    s_waitcnt vmcnt(5)
    ds_read_b64_tr_b16 v[180:181], v249 offset:20480
    ds_read_b64_tr_b16 v[182:183], v249 offset:21760
    ds_read_b64_tr_b16 v[184:185], v249 offset:20488
    ds_read_b64_tr_b16 v[186:187], v249 offset:21768
    ds_read_b64_tr_b16 v[188:189], v249 offset:20496
    ds_read_b64_tr_b16 v[190:191], v249 offset:21776
    ds_read_b64_tr_b16 v[192:193], v249 offset:20504
    ds_read_b64_tr_b16 v[194:195], v249 offset:21784
    ds_read_b64_tr_b16 v[196:197], v249 offset:20512
    ds_read_b64_tr_b16 v[198:199], v249 offset:21792
sp_49:
    buffer_load_dword v252, v250, s[8:11], s7 offen sc1
    s_add_u32 s45, s62, 0
    buffer_load_dwordx4 v[128:131], v10, s[8:11], s45 offen sc1
    s_add_u32 s45, s62, 0
    buffer_load_dwordx4 v[132:135], v11, s[8:11], s45 offen sc1
    s_add_u32 s45, s63, 0
    buffer_load_dwordx4 v[136:139], v10, s[8:11], s45 offen sc1
    s_add_u32 s45, s63, 0
    buffer_load_dwordx4 v[140:143], v11, s[8:11], s45 offen sc1
    s_add_u32 s45, s62, 2048
    buffer_load_dwordx4 v[148:151], v11, s[8:11], s45 offen sc1
    s_add_u32 s45, s62, 4096
    buffer_load_dwordx4 v[100:103], v11, s[8:11], s45 offen sc1
    s_cmp_eq_u32 s98, 0
    s_cbranch_scc1 sp_49_x
    s_sub_u32 s98, s98, 1
    s_waitcnt vmcnt(6)
    v_cmp_eq_u32 vcc, -1, v252
    s_cbranch_vccnz sp_49
sp_49_x:
    s_waitcnt vmcnt(6)
    s_waitcnt vmcnt(5)
    v_cmp_eq_u32 vcc, -1, v128
    s_cbranch_vccnz rt_50
rt_50_b:
    v_mfma_f32_16x16x32_bf16 v[16:19], v[200:203], v[128:131], v[16:19]
    s_add_u32 s45, s62, 6144
    buffer_load_dwordx4 v[116:119], v11, s[8:11], s45 offen sc1
    v_mfma_f32_16x16x32_bf16 v[20:23], v[204:207], v[128:131], v[20:23]
    v_mfma_f32_16x16x32_bf16 v[24:27], v[208:211], v[128:131], v[24:27]
    s_add_u32 s45, s62, 8192
    buffer_load_dwordx4 v[6:9], v11, s[8:11], s45 offen sc1
    v_mfma_f32_16x16x32_bf16 v[28:31], v[212:215], v[128:131], v[28:31]
    s_waitcnt vmcnt(6)
    v_cmp_eq_u32 vcc, -1, v132
    v_mfma_f32_16x16x32_bf16 v[32:35], v[216:219], v[128:131], v[32:35]
    s_cbranch_vccnz rt_51
rt_51_b:
    s_add_u32 s45, s63, 2048
    buffer_load_dwordx4 v[152:155], v10, s[8:11], s45 offen sc1
    v_mfma_f32_16x16x32_bf16 v[36:39], v[200:203], v[132:135], v[36:39]
    v_mfma_f32_16x16x32_bf16 v[40:43], v[204:207], v[132:135], v[40:43]
    s_add_u32 s45, s63, 4096
    buffer_load_dwordx4 v[104:107], v10, s[8:11], s45 offen sc1
    v_mfma_f32_16x16x32_bf16 v[44:47], v[208:211], v[132:135], v[44:47]
    v_mfma_f32_16x16x32_bf16 v[48:51], v[212:215], v[132:135], v[48:51]
    s_add_u32 s45, s63, 6144
    buffer_load_dwordx4 v[120:123], v10, s[8:11], s45 offen sc1
    s_waitcnt vmcnt(8)
    v_cmp_eq_u32 vcc, -1, v136
    v_mfma_f32_16x16x32_bf16 v[52:55], v[216:219], v[132:135], v[52:55]
    s_cbranch_vccnz rt_52
rt_52_b:
    v_mfma_f32_16x16x32_bf16 v[56:59], v[200:203], v[136:139], v[56:59]
    s_add_u32 s45, s63, 8192
    buffer_load_dwordx4 v[240:243], v10, s[8:11], s45 offen sc1
    v_mfma_f32_16x16x32_bf16 v[60:63], v[204:207], v[136:139], v[60:63]
    v_mfma_f32_16x16x32_bf16 v[64:67], v[208:211], v[136:139], v[64:67]
    s_add_u32 s45, s63, 2048
    buffer_load_dwordx4 v[156:159], v11, s[8:11], s45 offen sc1
    v_mfma_f32_16x16x32_bf16 v[68:71], v[212:215], v[136:139], v[68:71]
    s_waitcnt vmcnt(9)
    v_cmp_eq_u32 vcc, -1, v140
    v_mfma_f32_16x16x32_bf16 v[72:75], v[216:219], v[136:139], v[72:75]
    s_cbranch_vccnz rt_53
rt_53_b:
    s_add_u32 s45, s63, 4096
    buffer_load_dwordx4 v[108:111], v11, s[8:11], s45 offen sc1
    v_mfma_f32_16x16x32_bf16 v[76:79], v[200:203], v[140:143], v[76:79]
    v_mfma_f32_16x16x32_bf16 v[80:83], v[204:207], v[140:143], v[80:83]
    s_add_u32 s45, s63, 6144
    buffer_load_dwordx4 v[124:127], v11, s[8:11], s45 offen sc1
    v_mfma_f32_16x16x32_bf16 v[84:87], v[208:211], v[140:143], v[84:87]
    v_mfma_f32_16x16x32_bf16 v[88:91], v[212:215], v[140:143], v[88:91]
    s_add_u32 s45, s63, 8192
    buffer_load_dwordx4 v[244:247], v11, s[8:11], s45 offen sc1
    s_waitcnt vmcnt(11)
    v_cmp_eq_u32 vcc, -1, v148
    v_mfma_f32_16x16x32_bf16 v[92:95], v[216:219], v[140:143], v[92:95]
    s_cbranch_vccnz rt_54
rt_54_b:
    s_waitcnt lgkmcnt(15)
    v_mfma_f32_16x16x32_bf16 v[36:39], v[220:223], v[148:151], v[36:39]
    s_add_u32 s45, s62, 2048
    buffer_load_dwordx4 v[144:147], v10, s[8:11], s45 offen sc1
    v_mfma_f32_16x16x32_bf16 v[40:43], v[224:227], v[148:151], v[40:43]
    v_mfma_f32_16x16x32_bf16 v[44:47], v[228:231], v[148:151], v[44:47]
    ds_read_b64_tr_b16 v[200:201], v249 offset:40960
    s_add_u32 s45, s62, 4096
    buffer_load_dwordx4 v[96:99], v10, s[8:11], s45 offen sc1
    v_mfma_f32_16x16x32_bf16 v[48:51], v[232:235], v[148:151], v[48:51]
    ds_read_b64_tr_b16 v[202:203], v249 offset:42240
    s_waitcnt vmcnt(12)
    v_cmp_eq_u32 vcc, -1, v100
    v_mfma_f32_16x16x32_bf16 v[52:55], v[236:239], v[148:151], v[52:55]
    s_cbranch_vccnz rt_55
rt_55_b:
    ds_read_b64_tr_b16 v[204:205], v249 offset:40968
    s_add_u32 s45, s62, 6144
    buffer_load_dwordx4 v[112:115], v10, s[8:11], s45 offen sc1
    s_waitcnt lgkmcnt(13)
    v_mfma_f32_16x16x32_bf16 v[36:39], v[160:163], v[100:103], v[36:39]
    ds_read_b64_tr_b16 v[206:207], v249 offset:42248
    v_mfma_f32_16x16x32_bf16 v[40:43], v[164:167], v[100:103], v[40:43]
    ds_read_b64_tr_b16 v[208:209], v249 offset:40976
    s_add_u32 s45, s62, 8192
    buffer_load_dwordx4 v[2:5], v10, s[8:11], s45 offen sc1
    v_mfma_f32_16x16x32_bf16 v[44:47], v[168:171], v[100:103], v[44:47]
    ds_read_b64_tr_b16 v[210:211], v249 offset:42256
    v_mfma_f32_16x16x32_bf16 v[48:51], v[172:175], v[100:103], v[48:51]
    ds_read_b64_tr_b16 v[212:213], v249 offset:40984
    s_waitcnt vmcnt(13)
    v_cmp_eq_u32 vcc, -1, v116
    v_mfma_f32_16x16x32_bf16 v[52:55], v[176:179], v[100:103], v[52:55]
    s_cbranch_vccnz rt_56
rt_56_b:
    ds_read_b64_tr_b16 v[214:215], v249 offset:42264
    s_waitcnt lgkmcnt(8)
    v_mfma_f32_16x16x32_bf16 v[36:39], v[180:183], v[116:119], v[36:39]
    ds_read_b64_tr_b16 v[216:217], v249 offset:40992
    v_mfma_f32_16x16x32_bf16 v[40:43], v[184:187], v[116:119], v[40:43]
    ds_read_b64_tr_b16 v[218:219], v249 offset:42272
    v_mfma_f32_16x16x32_bf16 v[44:47], v[188:191], v[116:119], v[44:47]
    v_mfma_f32_16x16x32_bf16 v[48:51], v[192:195], v[116:119], v[48:51]
    s_waitcnt vmcnt(12)
    v_max_u32 v252, v6, v8
    v_cmp_eq_u32 vcc, -1, v252
    v_mfma_f32_16x16x32_bf16 v[52:55], v[196:199], v[116:119], v[52:55]
    s_cbranch_vccnz rt_57
rt_57_b:
    s_waitcnt lgkmcnt(0)
    v_mfma_f32_16x16x32_bf16 v[36:39], v[200:203], v[6:9], v[36:39]
    v_mfma_f32_16x16x32_bf16 v[40:43], v[204:207], v[6:9], v[40:43]
    v_mfma_f32_16x16x32_bf16 v[44:47], v[208:211], v[6:9], v[44:47]
    v_mfma_f32_16x16x32_bf16 v[48:51], v[212:215], v[6:9], v[48:51]
    s_waitcnt vmcnt(11)
    v_cmp_eq_u32 vcc, -1, v152
    v_mfma_f32_16x16x32_bf16 v[52:55], v[216:219], v[6:9], v[52:55]
    s_cbranch_vccnz rt_58
rt_58_b:
    v_mfma_f32_16x16x32_bf16 v[56:59], v[220:223], v[152:155], v[56:59]
    v_mfma_f32_16x16x32_bf16 v[60:63], v[224:227], v[152:155], v[60:63]
    ds_write_b128 v12, v[36:39] offset:0
    v_mfma_f32_16x16x32_bf16 v[64:67], v[228:231], v[152:155], v[64:67]
    ds_write_b128 v12, v[40:43] offset:1024
    v_mfma_f32_16x16x32_bf16 v[68:71], v[232:235], v[152:155], v[68:71]
    ds_write_b128 v12, v[44:47] offset:2048
    s_waitcnt vmcnt(10)
    v_cmp_eq_u32 vcc, -1, v104
    v_mfma_f32_16x16x32_bf16 v[72:75], v[236:239], v[152:155], v[72:75]
    s_cbranch_vccnz rt_59
rt_59_b:
    ds_write_b128 v12, v[48:51] offset:3072
    v_mfma_f32_16x16x32_bf16 v[56:59], v[160:163], v[104:107], v[56:59]
    ds_write_b128 v12, v[52:55] offset:4096
    v_mfma_f32_16x16x32_bf16 v[60:63], v[164:167], v[104:107], v[60:63]
    v_mfma_f32_16x16x32_bf16 v[64:67], v[168:171], v[104:107], v[64:67]
    v_mfma_f32_16x16x32_bf16 v[68:71], v[172:175], v[104:107], v[68:71]
    s_waitcnt vmcnt(9)
    v_cmp_eq_u32 vcc, -1, v120
    v_mfma_f32_16x16x32_bf16 v[72:75], v[176:179], v[104:107], v[72:75]
    s_cbranch_vccnz rt_60
rt_60_b:
    v_mfma_f32_16x16x32_bf16 v[56:59], v[180:183], v[120:123], v[56:59]
    v_mfma_f32_16x16x32_bf16 v[60:63], v[184:187], v[120:123], v[60:63]
    v_mfma_f32_16x16x32_bf16 v[64:67], v[188:191], v[120:123], v[64:67]
    v_mfma_f32_16x16x32_bf16 v[68:71], v[192:195], v[120:123], v[68:71]
    s_waitcnt vmcnt(8)
    v_max_u32 v252, v240, v242
    v_cmp_eq_u32 vcc, -1, v252
    v_mfma_f32_16x16x32_bf16 v[72:75], v[196:199], v[120:123], v[72:75]
    s_cbranch_vccnz rt_61
rt_61_b:
    v_mfma_f32_16x16x32_bf16 v[56:59], v[200:203], v[240:243], v[56:59]
    v_mfma_f32_16x16x32_bf16 v[60:63], v[204:207], v[240:243], v[60:63]
    v_mfma_f32_16x16x32_bf16 v[64:67], v[208:211], v[240:243], v[64:67]
    v_mfma_f32_16x16x32_bf16 v[68:71], v[212:215], v[240:243], v[68:71]
    s_waitcnt vmcnt(7)
    v_cmp_eq_u32 vcc, -1, v156
    v_mfma_f32_16x16x32_bf16 v[72:75], v[216:219], v[240:243], v[72:75]
    s_cbranch_vccnz rt_62
rt_62_b:
    v_mfma_f32_16x16x32_bf16 v[76:79], v[220:223], v[156:159], v[76:79]
    v_mfma_f32_16x16x32_bf16 v[80:83], v[224:227], v[156:159], v[80:83]
    ds_write_b128 v12, v[56:59] offset:20480
    v_mfma_f32_16x16x32_bf16 v[84:87], v[228:231], v[156:159], v[84:87]
    ds_write_b128 v12, v[60:63] offset:21504
    v_mfma_f32_16x16x32_bf16 v[88:91], v[232:235], v[156:159], v[88:91]
    ds_write_b128 v12, v[64:67] offset:22528
    s_waitcnt vmcnt(6)
    v_cmp_eq_u32 vcc, -1, v108
    v_mfma_f32_16x16x32_bf16 v[92:95], v[236:239], v[156:159], v[92:95]
    s_cbranch_vccnz rt_63
rt_63_b:
    ds_write_b128 v12, v[68:71] offset:23552
    v_mfma_f32_16x16x32_bf16 v[76:79], v[160:163], v[108:111], v[76:79]
    ds_write_b128 v12, v[72:75] offset:24576
    v_mfma_f32_16x16x32_bf16 v[80:83], v[164:167], v[108:111], v[80:83]
    v_mfma_f32_16x16x32_bf16 v[84:87], v[168:171], v[108:111], v[84:87]
    v_mfma_f32_16x16x32_bf16 v[88:91], v[172:175], v[108:111], v[88:91]
    s_waitcnt vmcnt(5)
    v_cmp_eq_u32 vcc, -1, v124
    v_mfma_f32_16x16x32_bf16 v[92:95], v[176:179], v[108:111], v[92:95]
    s_cbranch_vccnz rt_64
rt_64_b:
    v_mfma_f32_16x16x32_bf16 v[76:79], v[180:183], v[124:127], v[76:79]
    v_mfma_f32_16x16x32_bf16 v[80:83], v[184:187], v[124:127], v[80:83]
    v_mfma_f32_16x16x32_bf16 v[84:87], v[188:191], v[124:127], v[84:87]
    v_mfma_f32_16x16x32_bf16 v[88:91], v[192:195], v[124:127], v[88:91]
    s_waitcnt vmcnt(4)
    v_max_u32 v252, v244, v246
    v_cmp_eq_u32 vcc, -1, v252
    v_mfma_f32_16x16x32_bf16 v[92:95], v[196:199], v[124:127], v[92:95]
    s_cbranch_vccnz rt_65
rt_65_b:
    v_mfma_f32_16x16x32_bf16 v[76:79], v[200:203], v[244:247], v[76:79]
    v_mfma_f32_16x16x32_bf16 v[80:83], v[204:207], v[244:247], v[80:83]
    v_mfma_f32_16x16x32_bf16 v[84:87], v[208:211], v[244:247], v[84:87]
    v_mfma_f32_16x16x32_bf16 v[88:91], v[212:215], v[244:247], v[88:91]
    s_waitcnt vmcnt(3)
    v_cmp_eq_u32 vcc, -1, v144
    v_mfma_f32_16x16x32_bf16 v[92:95], v[216:219], v[244:247], v[92:95]
    s_cbranch_vccnz rt_66
rt_66_b:
    v_mfma_f32_16x16x32_bf16 v[16:19], v[220:223], v[144:147], v[16:19]
    v_mfma_f32_16x16x32_bf16 v[20:23], v[224:227], v[144:147], v[20:23]
    ds_write_b128 v12, v[76:79] offset:40960
    v_mfma_f32_16x16x32_bf16 v[24:27], v[228:231], v[144:147], v[24:27]
    ds_write_b128 v12, v[80:83] offset:41984
    v_mfma_f32_16x16x32_bf16 v[28:31], v[232:235], v[144:147], v[28:31]
    ds_write_b128 v12, v[84:87] offset:43008
    s_waitcnt vmcnt(2)
    v_cmp_eq_u32 vcc, -1, v96
    v_mfma_f32_16x16x32_bf16 v[32:35], v[236:239], v[144:147], v[32:35]
    s_cbranch_vccnz rt_67
rt_67_b:
    ds_write_b128 v12, v[88:91] offset:44032
    v_mfma_f32_16x16x32_bf16 v[16:19], v[160:163], v[96:99], v[16:19]
    ds_write_b128 v12, v[92:95] offset:45056
    v_mov_b32 v252, 10
    s_mov_b64 exec, 1
    ds_write_b32 v254, v252 offset:0
    s_mov_b64 exec, -1
    v_mfma_f32_16x16x32_bf16 v[20:23], v[164:167], v[96:99], v[20:23]
    v_mfma_f32_16x16x32_bf16 v[24:27], v[168:171], v[96:99], v[24:27]
    v_mfma_f32_16x16x32_bf16 v[28:31], v[172:175], v[96:99], v[28:31]
    s_waitcnt vmcnt(1)
    v_cmp_eq_u32 vcc, -1, v112
    v_mfma_f32_16x16x32_bf16 v[32:35], v[176:179], v[96:99], v[32:35]
    s_cbranch_vccnz rt_68
rt_68_b:
    v_mfma_f32_16x16x32_bf16 v[16:19], v[180:183], v[112:115], v[16:19]
    v_mfma_f32_16x16x32_bf16 v[20:23], v[184:187], v[112:115], v[20:23]
    v_mfma_f32_16x16x32_bf16 v[24:27], v[188:191], v[112:115], v[24:27]
    v_mfma_f32_16x16x32_bf16 v[28:31], v[192:195], v[112:115], v[28:31]
    s_waitcnt vmcnt(0)
    v_max_u32 v252, v2, v4
    v_cmp_eq_u32 vcc, -1, v252
    v_mfma_f32_16x16x32_bf16 v[32:35], v[196:199], v[112:115], v[32:35]
    s_cbranch_vccnz rt_69
rt_69_b:
    v_mfma_f32_16x16x32_bf16 v[16:19], v[200:203], v[2:5], v[16:19]
    ds_read_b32 v250, v255
    v_mfma_f32_16x16x32_bf16 v[20:23], v[204:207], v[2:5], v[20:23]
    v_mfma_f32_16x16x32_bf16 v[24:27], v[208:211], v[2:5], v[24:27]
    v_mfma_f32_16x16x32_bf16 v[28:31], v[212:215], v[2:5], v[28:31]
    v_mfma_f32_16x16x32_bf16 v[32:35], v[216:219], v[2:5], v[32:35]
    s_waitcnt lgkmcnt(0)
    v_cmp_gt_u32 vcc, 10, v250
    s_cbranch_vccnz lc_70
lc_70_b:
    ds_read_b128 v[36:39], v13 offset:0
    ds_read_b128 v[40:43], v13 offset:1024
    ds_read_b128 v[44:47], v13 offset:2048
    ds_read_b128 v[48:51], v13 offset:3072
    ds_read_b128 v[52:55], v13 offset:4096
    ds_read_b128 v[56:59], v14 offset:20480
    ds_read_b128 v[60:63], v14 offset:21504
    ds_read_b128 v[64:67], v14 offset:22528
    ds_read_b128 v[68:71], v14 offset:23552
    ds_read_b128 v[72:75], v14 offset:24576
    ds_read_b128 v[76:79], v15 offset:40960
    ds_read_b128 v[80:83], v15 offset:41984
    ds_read_b128 v[84:87], v15 offset:43008
    ds_read_b128 v[88:91], v15 offset:44032
    ds_read_b128 v[92:95], v15 offset:45056
    s_or_b32 s46, s42, s2
    s_waitcnt lgkmcnt(5)
    v_pk_add_f32 v[36:37], v[36:37], v[56:57]
    v_pk_add_f32 v[38:39], v[38:39], v[58:59]
    v_pk_add_f32 v[40:41], v[40:41], v[60:61]
    v_pk_add_f32 v[42:43], v[42:43], v[62:63]
    v_pk_add_f32 v[44:45], v[44:45], v[64:65]
    v_pk_add_f32 v[46:47], v[46:47], v[66:67]
    v_pk_add_f32 v[48:49], v[48:49], v[68:69]
    v_pk_add_f32 v[50:51], v[50:51], v[70:71]
    v_pk_add_f32 v[52:53], v[52:53], v[72:73]
    v_pk_add_f32 v[54:55], v[54:55], v[74:75]
    v_pk_add_f32 v[16:17], v[16:17], v[36:37]
    v_pk_add_f32 v[18:19], v[18:19], v[38:39]
    v_pk_add_f32 v[20:21], v[20:21], v[40:41]
    v_pk_add_f32 v[22:23], v[22:23], v[42:43]
    v_pk_add_f32 v[24:25], v[24:25], v[44:45]
    v_pk_add_f32 v[26:27], v[26:27], v[46:47]
    v_pk_add_f32 v[28:29], v[28:29], v[48:49]
    v_pk_add_f32 v[30:31], v[30:31], v[50:51]
    v_pk_add_f32 v[32:33], v[32:33], v[52:53]
    v_pk_add_f32 v[34:35], v[34:35], v[54:55]
    s_waitcnt lgkmcnt(0)
    v_pk_add_f32 v[16:17], v[16:17], v[76:77]
    v_pk_add_f32 v[18:19], v[18:19], v[78:79]
    v_pk_add_f32 v[20:21], v[20:21], v[80:81]
    v_pk_add_f32 v[22:23], v[22:23], v[82:83]
    v_pk_add_f32 v[24:25], v[24:25], v[84:85]
    v_pk_add_f32 v[26:27], v[26:27], v[86:87]
    v_pk_add_f32 v[28:29], v[28:29], v[88:89]
    v_pk_add_f32 v[30:31], v[30:31], v[90:91]
    v_pk_add_f32 v[32:33], v[32:33], v[92:93]
    v_pk_add_f32 v[34:35], v[34:35], v[94:95]
    v_cvt_pk_bf16_f32 v96, v16, v17
    v_cvt_pk_bf16_f32 v97, v18, v19
    v_cvt_pk_bf16_f32 v98, v20, v21
    v_cvt_pk_bf16_f32 v99, v22, v23
    v_cvt_pk_bf16_f32 v100, v24, v25
    v_cvt_pk_bf16_f32 v101, v26, v27
    v_cvt_pk_bf16_f32 v102, v28, v29
    v_cvt_pk_bf16_f32 v103, v30, v31
    v_cvt_pk_bf16_f32 v104, v32, v33
    v_cvt_pk_bf16_f32 v105, v34, v35
    buffer_store_dwordx4 v[96:99], v251, s[36:39], s0 offen
    buffer_store_dwordx4 v[100:103], v251, s[36:39], s0 offen offset:16
    buffer_store_dwordx2 v[104:105], v251, s[36:39], s0 offen offset:32
    s_cmp_lg_u32 s46, 0
    s_cbranch_scc1 G_end
    s_mov_b32 s44, 196608
    v_mov_b32 v252, 0
    v_mov_b32 v253, s43
    s_mov_b64 exec, 1
    buffer_store_dword v253, v252, s[8:11], s44 offen sc1
    s_mov_b64 exec, -1
G_end:
    s_endpgm
rt_20:
    s_cmp_eq_u32 s98, 0
    s_cbranch_scc1 rt_20_b
    s_sub_u32 s98, s98, 1
    buffer_load_dword v244, v242, s[8:11], s6 offen sc1
    s_waitcnt vmcnt(0)
    v_cmp_ne_u32 vcc, s43, v244
    s_cbranch_vccnz rt_20
    s_branch rt_20_b
rt_25:
    s_cmp_eq_u32 s98, 0
    s_cbranch_scc1 rt_25_b
    s_sub_u32 s98, s98, 1
    s_add_u32 s45, s62, 10240
    buffer_load_dwordx4 v[96:99], v10, s[8:11], s45 offen sc1
    s_waitcnt vmcnt(0)
    s_setprio 1
    v_cmp_eq_u32 vcc, -1, v96
    s_setprio 0
    s_cbranch_vccnz rt_25
    s_branch rt_25_b
rt_26:
    s_cmp_eq_u32 s98, 0
    s_cbranch_scc1 rt_26_b
    s_sub_u32 s98, s98, 1
    s_add_u32 s45, s62, 10240
    buffer_load_dwordx4 v[100:103], v11, s[8:11], s45 offen sc1
    s_waitcnt vmcnt(0)
    s_setprio 1
    v_cmp_eq_u32 vcc, -1, v100
    s_setprio 0
    s_cbranch_vccnz rt_26
    s_branch rt_26_b
rt_27:
    s_cmp_eq_u32 s98, 0
    s_cbranch_scc1 rt_27_b
    s_sub_u32 s98, s98, 1
    s_add_u32 s45, s63, 10240
    buffer_load_dwordx4 v[104:107], v10, s[8:11], s45 offen sc1
    s_waitcnt vmcnt(0)
    s_setprio 1
    v_cmp_eq_u32 vcc, -1, v104
    s_setprio 0
    s_cbranch_vccnz rt_27
    s_branch rt_27_b
rt_28:
    s_cmp_eq_u32 s98, 0
    s_cbranch_scc1 rt_28_b
    s_sub_u32 s98, s98, 1
    s_add_u32 s45, s63, 10240
    buffer_load_dwordx4 v[108:111], v11, s[8:11], s45 offen sc1
    s_waitcnt vmcnt(0)
    s_setprio 1
    v_cmp_eq_u32 vcc, -1, v108
    s_setprio 0
    s_cbranch_vccnz rt_28
    s_branch rt_28_b
rt_29:
    s_cmp_eq_u32 s98, 0
    s_cbranch_scc1 rt_29_b
    s_sub_u32 s98, s98, 1
    s_add_u32 s45, s62, 12288
    buffer_load_dwordx4 v[112:115], v10, s[8:11], s45 offen sc1
    s_waitcnt vmcnt(0)
    s_setprio 1
    v_cmp_eq_u32 vcc, -1, v112
    s_setprio 0
    s_cbranch_vccnz rt_29
    s_branch rt_29_b
rt_30:
    s_cmp_eq_u32 s98, 0
    s_cbranch_scc1 rt_30_b
    s_sub_u32 s98, s98, 1
    s_add_u32 s45, s62, 12288
    buffer_load_dwordx4 v[116:119], v11, s[8:11], s45 offen sc1
    s_waitcnt vmcnt(0)
    s_setprio 1
    v_cmp_eq_u32 vcc, -1, v116
    s_setprio 0
    s_cbranch_vccnz rt_30
    s_branch rt_30_b
rt_31:
    s_cmp_eq_u32 s98, 0
    s_cbranch_scc1 rt_31_b
    s_sub_u32 s98, s98, 1
    s_add_u32 s45, s63, 12288
    buffer_load_dwordx4 v[120:123], v10, s[8:11], s45 offen sc1
    s_waitcnt vmcnt(0)
    s_setprio 1
    v_cmp_eq_u32 vcc, -1, v120
    s_setprio 0
    s_cbranch_vccnz rt_31
    s_branch rt_31_b
rt_32:
    s_cmp_eq_u32 s98, 0
    s_cbranch_scc1 rt_32_b
    s_sub_u32 s98, s98, 1
    s_add_u32 s45, s63, 12288
    buffer_load_dwordx4 v[124:127], v11, s[8:11], s45 offen sc1
    s_waitcnt vmcnt(0)
    s_setprio 1
    v_cmp_eq_u32 vcc, -1, v124
    s_setprio 0
    s_cbranch_vccnz rt_32
    s_branch rt_32_b
rt_33:
    s_cmp_eq_u32 s98, 0
    s_cbranch_scc1 rt_33_b
    s_sub_u32 s98, s98, 1
    s_add_u32 s45, s62, 14336
    buffer_load_dwordx4 v[128:131], v10, s[8:11], s45 offen sc1
    s_waitcnt vmcnt(0)
    s_setprio 1
    v_cmp_eq_u32 vcc, -1, v128
    s_setprio 0
    s_cbranch_vccnz rt_33
    s_branch rt_33_b
rt_34:
    s_cmp_eq_u32 s98, 0
    s_cbranch_scc1 rt_34_b
    s_sub_u32 s98, s98, 1
    s_add_u32 s45, s62, 14336
    buffer_load_dwordx4 v[132:135], v11, s[8:11], s45 offen sc1
    s_waitcnt vmcnt(0)
    s_setprio 1
    v_cmp_eq_u32 vcc, -1, v132
    s_setprio 0
    s_cbranch_vccnz rt_34
    s_branch rt_34_b
rt_35:
    s_cmp_eq_u32 s98, 0
    s_cbranch_scc1 rt_35_b
    s_sub_u32 s98, s98, 1
    s_add_u32 s45, s63, 14336
    buffer_load_dwordx4 v[136:139], v10, s[8:11], s45 offen sc1
    s_waitcnt vmcnt(0)
    s_setprio 1
    v_cmp_eq_u32 vcc, -1, v136
    s_setprio 0
    s_cbranch_vccnz rt_35
    s_branch rt_35_b
rt_36:
    s_cmp_eq_u32 s98, 0
    s_cbranch_scc1 rt_36_b
    s_sub_u32 s98, s98, 1
    s_add_u32 s45, s63, 14336
    buffer_load_dwordx4 v[140:143], v11, s[8:11], s45 offen sc1
    s_waitcnt vmcnt(0)
    s_setprio 1
    v_cmp_eq_u32 vcc, -1, v140
    s_setprio 0
    s_cbranch_vccnz rt_36
    s_branch rt_36_b
rt_37:
    s_cmp_eq_u32 s98, 0
    s_cbranch_scc1 rt_37_b
    s_sub_u32 s98, s98, 1
    s_add_u32 s45, s62, 16384
    buffer_load_dwordx4 v[144:147], v10, s[8:11], s45 offen sc1
    s_waitcnt vmcnt(0)
    s_setprio 1
    v_cmp_eq_u32 vcc, -1, v144
    s_setprio 0
    s_cbranch_vccnz rt_37
    s_branch rt_37_b
rt_38:
    s_cmp_eq_u32 s98, 0
    s_cbranch_scc1 rt_38_b
    s_sub_u32 s98, s98, 1
    s_add_u32 s45, s62, 16384
    buffer_load_dwordx4 v[148:151], v11, s[8:11], s45 offen sc1
    s_waitcnt vmcnt(0)
    s_setprio 1
    v_cmp_eq_u32 vcc, -1, v148
    s_setprio 0
    s_cbranch_vccnz rt_38
    s_branch rt_38_b
rt_39:
    s_cmp_eq_u32 s98, 0
    s_cbranch_scc1 rt_39_b
    s_sub_u32 s98, s98, 1
    s_add_u32 s45, s63, 16384
    buffer_load_dwordx4 v[152:155], v10, s[8:11], s45 offen sc1
    s_waitcnt vmcnt(0)
    s_setprio 1
    v_cmp_eq_u32 vcc, -1, v152
    s_setprio 0
    s_cbranch_vccnz rt_39
    s_branch rt_39_b
rt_40:
    s_cmp_eq_u32 s98, 0
    s_cbranch_scc1 rt_40_b
    s_sub_u32 s98, s98, 1
    s_add_u32 s45, s63, 16384
    buffer_load_dwordx4 v[156:159], v11, s[8:11], s45 offen sc1
    s_waitcnt vmcnt(0)
    s_setprio 1
    v_cmp_eq_u32 vcc, -1, v156
    s_setprio 0
    s_cbranch_vccnz rt_40
    s_branch rt_40_b
rt_41:
    s_cmp_eq_u32 s98, 0
    s_cbranch_scc1 rt_41_b
    s_sub_u32 s98, s98, 1
    s_add_u32 s45, s62, 18432
    buffer_load_dwordx4 v[96:99], v10, s[8:11], s45 offen sc1
    s_waitcnt vmcnt(0)
    s_setprio 1
    v_cmp_eq_u32 vcc, -1, v96
    s_setprio 0
    s_cbranch_vccnz rt_41
    s_branch rt_41_b
rt_42:
    s_cmp_eq_u32 s98, 0
    s_cbranch_scc1 rt_42_b
    s_sub_u32 s98, s98, 1
    s_add_u32 s45, s62, 18432
    buffer_load_dwordx4 v[100:103], v11, s[8:11], s45 offen sc1
    s_waitcnt vmcnt(0)
    s_setprio 1
    v_cmp_eq_u32 vcc, -1, v100
    s_setprio 0
    s_cbranch_vccnz rt_42
    s_branch rt_42_b
rt_43:
    s_cmp_eq_u32 s98, 0
    s_cbranch_scc1 rt_43_b
    s_sub_u32 s98, s98, 1
    s_add_u32 s45, s63, 18432
    buffer_load_dwordx4 v[104:107], v10, s[8:11], s45 offen sc1
    s_waitcnt vmcnt(0)
    s_setprio 1
    v_cmp_eq_u32 vcc, -1, v104
    s_setprio 0
    s_cbranch_vccnz rt_43
    s_branch rt_43_b
rt_44:
    s_cmp_eq_u32 s98, 0
    s_cbranch_scc1 rt_44_b
    s_sub_u32 s98, s98, 1
    s_add_u32 s45, s63, 18432
    buffer_load_dwordx4 v[108:111], v11, s[8:11], s45 offen sc1
    s_waitcnt vmcnt(0)
    s_setprio 1
    v_cmp_eq_u32 vcc, -1, v108
    s_setprio 0
    s_cbranch_vccnz rt_44
    s_branch rt_44_b
rt_45:
    s_cmp_eq_u32 s98, 0
    s_cbranch_scc1 rt_45_b
    s_sub_u32 s98, s98, 1
    s_add_u32 s45, s62, 20480
    buffer_load_dwordx4 v[112:115], v10, s[8:11], s45 offen sc1
    s_waitcnt vmcnt(0)
    s_setprio 1
    v_cmp_eq_u32 vcc, -1, v112
    s_setprio 0
    s_cbranch_vccnz rt_45
    s_branch rt_45_b
rt_46:
    s_cmp_eq_u32 s98, 0
    s_cbranch_scc1 rt_46_b
    s_sub_u32 s98, s98, 1
    s_add_u32 s45, s62, 20480
    buffer_load_dwordx4 v[116:119], v11, s[8:11], s45 offen sc1
    s_waitcnt vmcnt(0)
    s_setprio 1
    v_cmp_eq_u32 vcc, -1, v116
    s_setprio 0
    s_cbranch_vccnz rt_46
    s_branch rt_46_b
rt_47:
    s_cmp_eq_u32 s98, 0
    s_cbranch_scc1 rt_47_b
    s_sub_u32 s98, s98, 1
    s_add_u32 s45, s63, 20480
    buffer_load_dwordx4 v[120:123], v10, s[8:11], s45 offen sc1
    s_waitcnt vmcnt(0)
    s_setprio 1
    v_cmp_eq_u32 vcc, -1, v120
    s_setprio 0
    s_cbranch_vccnz rt_47
    s_branch rt_47_b
rt_48:
    s_cmp_eq_u32 s98, 0
    s_cbranch_scc1 rt_48_b
    s_sub_u32 s98, s98, 1
    s_add_u32 s45, s63, 20480
    buffer_load_dwordx4 v[124:127], v11, s[8:11], s45 offen sc1
    s_waitcnt vmcnt(0)
    s_setprio 1
    v_cmp_eq_u32 vcc, -1, v124
    s_setprio 0
    s_cbranch_vccnz rt_48
    s_branch rt_48_b
rt_50:
    s_cmp_eq_u32 s98, 0
    s_cbranch_scc1 rt_50_b
    s_sub_u32 s98, s98, 1
    s_add_u32 s45, s62, 0
    buffer_load_dwordx4 v[128:131], v10, s[8:11], s45 offen sc1
    s_waitcnt vmcnt(0)
    v_cmp_eq_u32 vcc, -1, v128
    s_cbranch_vccnz rt_50
    s_branch rt_50_b
rt_51:
    s_cmp_eq_u32 s98, 0
    s_cbranch_scc1 rt_51_b
    s_sub_u32 s98, s98, 1
    s_add_u32 s45, s62, 0
    buffer_load_dwordx4 v[132:135], v11, s[8:11], s45 offen sc1
    s_waitcnt vmcnt(0)
    v_cmp_eq_u32 vcc, -1, v132
    s_cbranch_vccnz rt_51
    s_branch rt_51_b
rt_52:
    s_cmp_eq_u32 s98, 0
    s_cbranch_scc1 rt_52_b
    s_sub_u32 s98, s98, 1
    s_add_u32 s45, s63, 0
    buffer_load_dwordx4 v[136:139], v10, s[8:11], s45 offen sc1
    s_waitcnt vmcnt(0)
    v_cmp_eq_u32 vcc, -1, v136
    s_cbranch_vccnz rt_52
    s_branch rt_52_b
rt_53:
    s_cmp_eq_u32 s98, 0
    s_cbranch_scc1 rt_53_b
    s_sub_u32 s98, s98, 1
    s_add_u32 s45, s63, 0
    buffer_load_dwordx4 v[140:143], v11, s[8:11], s45 offen sc1
    s_waitcnt vmcnt(0)
    v_cmp_eq_u32 vcc, -1, v140
    s_cbranch_vccnz rt_53
    s_branch rt_53_b
rt_54:
    s_cmp_eq_u32 s98, 0
    s_cbranch_scc1 rt_54_b
    s_sub_u32 s98, s98, 1
    s_add_u32 s45, s62, 2048
    buffer_load_dwordx4 v[148:151], v11, s[8:11], s45 offen sc1
    s_waitcnt vmcnt(0)
    v_cmp_eq_u32 vcc, -1, v148
    s_cbranch_vccnz rt_54
    s_branch rt_54_b
rt_55:
    s_cmp_eq_u32 s98, 0
    s_cbranch_scc1 rt_55_b
    s_sub_u32 s98, s98, 1
    s_add_u32 s45, s62, 4096
    buffer_load_dwordx4 v[100:103], v11, s[8:11], s45 offen sc1
    s_waitcnt vmcnt(0)
    v_cmp_eq_u32 vcc, -1, v100
    s_cbranch_vccnz rt_55
    s_branch rt_55_b
rt_56:
    s_cmp_eq_u32 s98, 0
    s_cbranch_scc1 rt_56_b
    s_sub_u32 s98, s98, 1
    s_add_u32 s45, s62, 6144
    buffer_load_dwordx4 v[116:119], v11, s[8:11], s45 offen sc1
    s_waitcnt vmcnt(0)
    v_cmp_eq_u32 vcc, -1, v116
    s_cbranch_vccnz rt_56
    s_branch rt_56_b
rt_57:
    s_cmp_eq_u32 s98, 0
    s_cbranch_scc1 rt_57_b
    s_sub_u32 s98, s98, 1
    s_add_u32 s45, s62, 8192
    buffer_load_dwordx4 v[6:9], v11, s[8:11], s45 offen sc1
    s_waitcnt vmcnt(0)
    v_max_u32 v252, v6, v8
    v_cmp_eq_u32 vcc, -1, v252
    s_cbranch_vccnz rt_57
    s_branch rt_57_b
rt_58:
    s_cmp_eq_u32 s98, 0
    s_cbranch_scc1 rt_58_b
    s_sub_u32 s98, s98, 1
    s_add_u32 s45, s63, 2048
    buffer_load_dwordx4 v[152:155], v10, s[8:11], s45 offen sc1
    s_waitcnt vmcnt(0)
    v_cmp_eq_u32 vcc, -1, v152
    s_cbranch_vccnz rt_58
    s_branch rt_58_b
rt_59:
    s_cmp_eq_u32 s98, 0
    s_cbranch_scc1 rt_59_b
    s_sub_u32 s98, s98, 1
    s_add_u32 s45, s63, 4096
    buffer_load_dwordx4 v[104:107], v10, s[8:11], s45 offen sc1
    s_waitcnt vmcnt(0)
    v_cmp_eq_u32 vcc, -1, v104
    s_cbranch_vccnz rt_59
    s_branch rt_59_b
rt_60:
    s_cmp_eq_u32 s98, 0
    s_cbranch_scc1 rt_60_b
    s_sub_u32 s98, s98, 1
    s_add_u32 s45, s63, 6144
    buffer_load_dwordx4 v[120:123], v10, s[8:11], s45 offen sc1
    s_waitcnt vmcnt(0)
    v_cmp_eq_u32 vcc, -1, v120
    s_cbranch_vccnz rt_60
    s_branch rt_60_b
rt_61:
    s_cmp_eq_u32 s98, 0
    s_cbranch_scc1 rt_61_b
    s_sub_u32 s98, s98, 1
    s_add_u32 s45, s63, 8192
    buffer_load_dwordx4 v[240:243], v10, s[8:11], s45 offen sc1
    s_waitcnt vmcnt(0)
    v_max_u32 v252, v240, v242
    v_cmp_eq_u32 vcc, -1, v252
    s_cbranch_vccnz rt_61
    s_branch rt_61_b
rt_62:
    s_cmp_eq_u32 s98, 0
    s_cbranch_scc1 rt_62_b
    s_sub_u32 s98, s98, 1
    s_add_u32 s45, s63, 2048
    buffer_load_dwordx4 v[156:159], v11, s[8:11], s45 offen sc1
    s_waitcnt vmcnt(0)
    v_cmp_eq_u32 vcc, -1, v156
    s_cbranch_vccnz rt_62
    s_branch rt_62_b
rt_63:
    s_cmp_eq_u32 s98, 0
    s_cbranch_scc1 rt_63_b
    s_sub_u32 s98, s98, 1
    s_add_u32 s45, s63, 4096
    buffer_load_dwordx4 v[108:111], v11, s[8:11], s45 offen sc1
    s_waitcnt vmcnt(0)
    v_cmp_eq_u32 vcc, -1, v108
    s_cbranch_vccnz rt_63
    s_branch rt_63_b
rt_64:
    s_cmp_eq_u32 s98, 0
    s_cbranch_scc1 rt_64_b
    s_sub_u32 s98, s98, 1
    s_add_u32 s45, s63, 6144
    buffer_load_dwordx4 v[124:127], v11, s[8:11], s45 offen sc1
    s_waitcnt vmcnt(0)
    v_cmp_eq_u32 vcc, -1, v124
    s_cbranch_vccnz rt_64
    s_branch rt_64_b
rt_65:
    s_cmp_eq_u32 s98, 0
    s_cbranch_scc1 rt_65_b
    s_sub_u32 s98, s98, 1
    s_add_u32 s45, s63, 8192
    buffer_load_dwordx4 v[244:247], v11, s[8:11], s45 offen sc1
    s_waitcnt vmcnt(0)
    v_max_u32 v252, v244, v246
    v_cmp_eq_u32 vcc, -1, v252
    s_cbranch_vccnz rt_65
    s_branch rt_65_b
rt_66:
    s_cmp_eq_u32 s98, 0
    s_cbranch_scc1 rt_66_b
    s_sub_u32 s98, s98, 1
    s_add_u32 s45, s62, 2048
    buffer_load_dwordx4 v[144:147], v10, s[8:11], s45 offen sc1
    s_waitcnt vmcnt(0)
    v_cmp_eq_u32 vcc, -1, v144
    s_cbranch_vccnz rt_66
    s_branch rt_66_b
rt_67:
    s_cmp_eq_u32 s98, 0
    s_cbranch_scc1 rt_67_b
    s_sub_u32 s98, s98, 1
    s_add_u32 s45, s62, 4096
    buffer_load_dwordx4 v[96:99], v10, s[8:11], s45 offen sc1
    s_waitcnt vmcnt(0)
    v_cmp_eq_u32 vcc, -1, v96
    s_cbranch_vccnz rt_67
    s_branch rt_67_b
rt_68:
    s_cmp_eq_u32 s98, 0
    s_cbranch_scc1 rt_68_b
    s_sub_u32 s98, s98, 1
    s_add_u32 s45, s62, 6144
    buffer_load_dwordx4 v[112:115], v10, s[8:11], s45 offen sc1
    s_waitcnt vmcnt(0)
    v_cmp_eq_u32 vcc, -1, v112
    s_cbranch_vccnz rt_68
    s_branch rt_68_b
rt_69:
    s_cmp_eq_u32 s98, 0
    s_cbranch_scc1 rt_69_b
    s_sub_u32 s98, s98, 1
    s_add_u32 s45, s62, 8192
    buffer_load_dwordx4 v[2:5], v10, s[8:11], s45 offen sc1
    s_waitcnt vmcnt(0)
    v_max_u32 v252, v2, v4
    v_cmp_eq_u32 vcc, -1, v252
    s_cbranch_vccnz rt_69
    s_branch rt_69_b
lc_70:
    s_mov_b32 s47, 0x40000
lc_70_l:
    ds_read_b32 v250, v255
    s_sub_u32 s47, s47, 1
    s_waitcnt lgkmcnt(0)
    v_cmp_gt_u32 vcc, 10, v250
    s_cbranch_scc1 lc_70_b
    s_cbranch_vccnz lc_70_l
    s_branch lc_70_b
F_end:
.section .rodata,"a"
.p2align 6
.amdhsa_kernel gated_mix__grouped_kv_mqa__mixer_gmlp__prompt_kernel
  .amdhsa_next_free_vgpr 256
  .amdhsa_next_free_sgpr 102
  .amdhsa_accum_offset 256
  .amdhsa_group_segment_fixed_size 0
  .amdhsa_kernarg_size 112
  .amdhsa_user_sgpr_count 2
  .amdhsa_user_sgpr_kernarg_segment_ptr 1
  .amdhsa_system_sgpr_workgroup_id_x 1
.end_amdhsa_kernel
```
